```python
import torch

def _softmax(x, axis=-1):
    return torch.softmax(x, dim=axis)
def _gelu(x):
    return torch.nn.functional.gelu(x, approximate="tanh")
def _silu(x):
    return torch.nn.functional.silu(x)
def _sigmoid(x):
    return torch.sigmoid(x)
def _layernorm(x, axis=-1, eps=1e-5):
    m = x.mean(dim=axis, keepdim=True)
    v = x.var(dim=axis, keepdim=True, unbiased=False)
    return (x - m) / torch.sqrt(v + eps)
def _scatter_add(tgt, idx, src, axis=0):
    return tgt.clone().index_add_(axis, idx, src)
def _segment_sum(src, seg, n):
    out = torch.zeros((n,) + src.shape[1:], dtype=src.dtype)
    return out.index_add_(0, seg, src)
def _pad(x, pw):
    flat = tuple(v for pair in reversed(pw) for v in pair)
    return torch.nn.functional.pad(x, flat)

kernel_name = 'concat_heads__grouped_kv_mqa__ssm_conv_s5__prompt'

def setup_inputs():

    _w = (lambda a: (lambda t: t.to(torch.bfloat16) if t.is_floating_point() else t)(torch.as_tensor(a)))
    def _A_setup():
        B, S, D, H = 1, 2048, 640, 32
        Dh = D // H
        return {
            "x": _w((lambda *s: torch.randn(*s, dtype=torch.bfloat16) * 0.05)(B, S, D)),
            "wq": _w((lambda *s: torch.randn(*s, dtype=torch.bfloat16) * 0.8)(D, H * Dh)),
            "wk": _w((lambda *s: torch.randn(*s, dtype=torch.bfloat16) * 0.8)(D, Dh)),
            "wv": _w((lambda *s: torch.randn(*s, dtype=torch.bfloat16) * 0.05)(D, Dh)),
            "wo": _w((lambda *s: torch.randn(*s, dtype=torch.bfloat16) * 0.05)(H * Dh, D)),
        }
    _A_in = _A_setup()

    def _B_setup():
        B, S, D = 1, 2048, 640
        P = D
        Lambda_re = -0.5 * (lambda _x: torch.exp(torch.as_tensor(_x)))((lambda *s: torch.randn(*s, dtype=torch.bfloat16) * 0.2)(P))
        Lambda_im = (lambda *s: torch.randn(*s, dtype=torch.bfloat16) * 0.4)(P) * 1.0
        B_re = (lambda *s: torch.randn(*s, dtype=torch.bfloat16) * 0.2)(P, D) * (D ** -0.5)
        B_im = (lambda *s: torch.randn(*s, dtype=torch.bfloat16) * 0.2)(P, D) * (D ** -0.5)
        C_re = (lambda *s: torch.randn(*s, dtype=torch.bfloat16) * 0.2)(D, P) * (P ** -0.5)
        C_im = (lambda *s: torch.randn(*s, dtype=torch.bfloat16) * 0.2)(D, P) * (P ** -0.5)
        log_dt = (lambda *s: torch.randn(*s, dtype=torch.bfloat16) * 0.2)(P) * 0.3 - 2.0
        Dskip = (lambda *s: torch.randn(*s, dtype=torch.bfloat16) * 0.05)(D)
        return {
            "x": _w((lambda *s: torch.randn(*s, dtype=torch.bfloat16) * 0.05)(B, S, D)),
            "Lambda_re": _w(Lambda_re),
            "Lambda_im": _w(Lambda_im),
            "B_re": _w(B_re),
            "B_im": _w(B_im),
            "C_re": _w(C_re),
            "C_im": _w(C_im),
            "log_dt": _w(log_dt),
            "Dskip": _w(Dskip),
        }
    _B_in = _B_setup()

    return {
        "A_x": _A_in["x"],
        "A_wq": _A_in["wq"],
        "A_wk": _A_in["wk"],
        "A_wv": _A_in["wv"],
        "A_wo": _A_in["wo"],
        "B_x": _B_in["x"],
        "B_Lambda_re": _B_in["Lambda_re"],
        "B_Lambda_im": _B_in["Lambda_im"],
        "B_B_re": _B_in["B_re"],
        "B_B_im": _B_in["B_im"],
        "B_C_re": _B_in["C_re"],
        "B_C_im": _B_in["C_im"],
        "B_log_dt": _B_in["log_dt"],
        "B_Dskip": _B_in["Dskip"],
    }

def reference(A_x, A_wq, A_wk, A_wv, A_wo, B_x, B_Lambda_re, B_Lambda_im, B_B_re, B_B_im, B_C_re, B_C_im, B_log_dt, B_Dskip):
    def _A_ref(x, wq, wk, wv, wo):
        B, S, D = x.shape
        H = 32
        Dh = D // H
        q = (lambda x, *d: x.permute(*d))((x @ wq).reshape(B, S, H, Dh), 0, 2, 1, 3)
        k = x @ wk
        v = x @ wv
        scores = torch.einsum("bhqd,bkd->bhqk", q, k) * (Dh ** -0.5)
        p = _softmax(scores, axis=-1)
        o = torch.einsum("bhqk,bkd->bhqd", p, v)
        return (lambda x, *d: x.permute(*d))(o, 0, 2, 1, 3).reshape(B, S, H * Dh) @ wo

    def _B_ref(x, Lambda_re, Lambda_im, B_re, B_im, C_re, C_im, log_dt, Dskip):
        Bsz, L, H = x.shape
        Lam = Lambda_re + 1j * Lambda_im
        Bmat = B_re + 1j * B_im
        Cmat = C_re + 1j * C_im
        dt = torch.exp(log_dt)
        Lam_bar = torch.exp(dt * Lam)
        B_bar = ((Lam_bar - 1.0) / Lam)[:, None] * Bmat
        Bu = torch.einsum("bld,pd->blp", x + 0j, B_bar)
        h = torch.zeros_like(Bu[:, 0, :])
        hs = []
        for t in range(L):
            h = Lam_bar[None, :] * h + Bu[:, t, :]
            hs.append(h)
        hseq = torch.stack(hs, 1)
        y = 2.0 * torch.einsum("blp,dp->bld", hseq, Cmat).real + x * Dskip[None, None, :]
        return y

    a = _A_ref(A_x, A_wq, A_wk, A_wv, A_wo)
    b = _B_ref(B_x, B_Lambda_re, B_Lambda_im, B_B_re, B_B_im, B_C_re, B_C_im, B_log_dt, B_Dskip)
    return torch.concatenate([a, b], axis=-1)
```

```asm
; @launch grid=(512,1,1) block=(256,1,1) lds=81920
.amdgcn_target "amdgcn-amd-amdhsa--gfx950"
.text
.globl concat_heads__grouped_kv_mqa__ssm_conv_s5__prompt_kernel
.p2align 8
.type concat_heads__grouped_kv_mqa__ssm_conv_s5__prompt_kernel,@function
concat_heads__grouped_kv_mqa__ssm_conv_s5__prompt_kernel:
    s_cmp_ge_u32 s2, 512
    s_cbranch_scc1 L_exit
    s_load_dwordx16 s[4:19], s[0:1], 0
    s_load_dwordx16 s[20:35], s[0:1], 64
    s_load_dwordx2 s[36:37], s[0:1], 128
    s_cmp_lt_u32 s2, 256
    s_cbranch_scc1 L_att
    s_setprio 3
    v_lshrrev_b32 v1, 6, v0
    v_and_b32_e64 v255, 63, v0
    s_and_b32 s60, s2, 7
    v_readfirstlane_b32 s38, v1
    s_bfe_u32 s61, s2, 0x50003
    v_lshrrev_b32 v1, 3, v255
    v_lshrrev_b32 v2, 4, v255
    v_and_b32_e64 v3, 7, v255
    v_mul_u32_u24 v1, 1280, v1
    v_xor_b32_e64 v3, v3, v2
    v_lshl_add_u32 v254, v3, 4, v1
    v_lshlrev_b32 v248, 4, v255
    v_xor_b32 v253, 64, v254
    v_add_u32 v253, 9216, v253
    s_getpc_b64 s[70:71]
L_pc:
    s_sub_u32 s70, s70, L_pc-concat_heads__grouped_kv_mqa__ssm_conv_s5__prompt_kernel
    s_subb_u32 s71, s71, 0
    s_lshl_b32 s72, s61, 2
    s_add_u32 s72, s72, s38
    s_mul_i32 s72, s72, 3
    v_min_u32 v1, 2, v255
    v_add_lshl_u32 v1, v1, s72, 7
    v_min_u32 v1, L_rowmax-concat_heads__grouped_kv_mqa__ssm_conv_s5__prompt_kernel, v1
    global_load_dword v247, v1, s[70:71]
    s_lshr_b32 s62, s61, 1
    s_xor_b32 s67, s62, s61
    s_and_b32 s67, s67, 1
    s_mul_i32 s67, s67, 5
    s_lshl_b32 s39, s60, 4
    s_add_u32 s62, s62, s39
    s_cmp_lt_u32 s38, 2
    s_cselect_b32 s68, 8, 4
    s_add_u32 s68, s68, s38
    s_nop 0
    s_mul_i32 s66, s62, 20480
    s_mov_b32 s42, 2621440
    s_mov_b32 s43, 0x20000
    s_mov_b32 s46, 25600
    s_mov_b32 s47, 0x20000
    s_mov_b32 s54, 9437184
    s_mov_b32 s55, 0x20000
    v_mov_b32 v4, 0
    v_mov_b32 v5, 0
    v_mov_b32 v6, 0
    v_mov_b32_e64 v7, 0
    s_lshr_b32 s70, s60, 1
    s_and_b32 s71, s70, 1
    s_sub_u32 s71, 28, s71
    s_sub_u32 s72, 31, s61
    s_cmp_lt_u32 s72, s71
    s_cselect_b32 s101, 1, 0
    s_lshl_b32 s70, s70, 3
    s_lshr_b32 s70, 0x53371c00, s70
    s_and_b32 s70, s70, 0xff
    s_add_u32 s72, s72, s70
    s_mul_i32 s74, s72, 205
    s_lshr_b32 s74, s74, 10
    s_mul_i32 s70, s74, 5
    s_sub_u32 s72, s72, s70
    s_add_u32 s100, s72, s74
    s_mul_i32 s70, s100, 205
    s_lshr_b32 s70, s70, 10
    s_mul_i32 s70, s70, 5
    s_sub_u32 s100, s100, s70
    s_lshl_b32 s100, s100, 8
    s_and_b32 s70, s60, 1
    s_mul_i32 s70, s70, 5
    s_add_u32 s75, s72, s70
    s_lshl_b32 s75, s75, 2
    s_add_u32 s75, s75, s38
    s_waitcnt lgkmcnt(0)
    s_mov_b32 s52, s36
    s_mov_b32 s53, s37
    s_cmp_lg_u32 s2, 257
    s_cbranch_scc1 L_kv_noclr
    s_lshl_b32 s70, s38, 12
    s_nop 0
    buffer_store_dwordx4 v[4:7], v248, s[52:55], s70 offen offset:0 sc1
    buffer_store_dwordx4 v[4:7], v248, s[52:55], s70 offen offset:1024 sc1
    buffer_store_dwordx4 v[4:7], v248, s[52:55], s70 offen offset:2048 sc1
    buffer_store_dwordx4 v[4:7], v248, s[52:55], s70 offen offset:3072 sc1
L_kv_noclr:
    s_and_b32 s63, s61, 1
    s_cselect_b32 s44, s10, s8
    s_cselect_b32 s45, s11, s9
    s_mov_b32 s40, s4
    s_mov_b32 s41, s5
L_kv_issue:
    s_add_u32 s64, s68, s67
    s_cmp_ge_u32 s64, 10
    s_cselect_b32 s65, 10, 0
    s_sub_u32 s64, s64, s65
    s_mul_i32 s69, s68, 4608
    s_lshl_b32 s65, s64, 7
    s_mov_b32 m0, s69
    s_add_u32 s65, s65, s66
    buffer_load_dwordx4 v254, s[40:43], s65 offen lds
    buffer_load_dwordx4 v253, s[40:43], s65 offen offset:1024 lds
    s_add_u32 m0, s69, 2048
    s_mul_i32 s64, s64, 2560
    buffer_load_dwordx4 v248, s[44:47], s64 offen lds
    buffer_load_dwordx4 v248, s[44:47], s64 offen offset:1024 lds
    s_mov_b32 exec_hi, 0
    buffer_load_dwordx4 v248, s[44:47], s64 offen offset:2048 lds
    s_mov_b32 exec_hi, -1
    s_sub_u32 s68, s68, 4
    s_cbranch_scc0 L_kv_issue
    s_lshl_b32 s72, s75, 5
    v_and_b32 v1, 15, v255
    v_lshl_add_u32 v1, v1, 1, s72
    global_load_ushort v164, v1, s[16:17]
    global_load_ushort v165, v1, s[18:19]
    global_load_ushort v166, v1, s[28:29]
    s_mov_b32 s56, s34
    s_mov_b32 s57, s35
    s_mov_b32 s58, 0x100
    s_mov_b32 s59, 0x20000
    s_add_u32 s48, s36, 0x40000
    s_addc_u32 s49, s37, 0
    s_mov_b32 s50, 0x2a000
    s_mov_b32 s51, 0x20000
    v_and_b32_e64 v1, 31, v255
    v_lshrrev_b32 v2, 5, v255
    v_bfe_u32 v3, v255, 1, 3
    v_xor_b32 v2, v2, v3
    v_lshlrev_b32 v1, 7, v1
    v_lshl_add_u32 v249, v2, 4, v1
    v_xor_b32 v250, 32, v249
    v_xor_b32 v251, 64, v249
    v_xor_b32 v252, 0x60, v249
    v_lshrrev_b32 v1, 5, v255
    v_bfe_u32 v2, v255, 2, 2
    v_lshl_add_u32 v1, v1, 3, v2
    v_mul_u32_u24 v1, 40, v1
    v_and_b32 v2, 19, v255
    v_min_u32 v2, 4, v2
    v_lshl_add_u32 v52, v2, 3, v1
    v_and_b32 v48, 0x7ff, v249
    v_add_u32_e64 v48, s69, v48
    v_and_b32 v49, 0x7ff, v250
    v_add_u32_e64 v49, s69, v49
    v_and_b32 v50, 0x7ff, v251
    v_add_u32_e64 v50, s69, v50
    v_and_b32 v51, 0x7ff, v252
    v_add_u32 v51, s69, v51
    v_add_u32 v52, s69, v52
    v_add_u32 v53, s69, v248
    v_mov_b32 v105, 0
    v_mov_b32 v23, 0x7fff0000
    s_lshr_b32 s70, s62, 2
    s_mul_i32 s70, s70, 5376
    s_bfe_u32 s71, s62, 0x10001
    s_and_b32 s65, s62, 1
    s_lshr_b32 s66, s62, 1
    s_lshl_b32 s66, s66, 7
    s_and_b32 s39, s61, 3
    s_lshl_b32 s39, s39, 2
    s_add_u32 s66, s66, s39
    v_mov_b64 v[0:1], 0
    v_mov_b64 v[2:3], 0
    v_mov_b64 v[4:5], 0
    v_mov_b64 v[6:7], 0
    v_mov_b64 v[8:9], 0
    v_mov_b64 v[10:11], 0
    v_mov_b64 v[12:13], 0
    v_mov_b64 v[14:15], 0
    s_cmp_lg_u32 s2, 257
    s_cbranch_scc1 L_kv_nosig
    s_waitcnt vmcnt(13)
    s_mov_b64 exec, 1
    v_mov_b32 v105, 0
    v_mov_b32 v106, 1
    buffer_atomic_add v106, v105, s[56:59], 0 offen
    s_mov_b64 exec, -1
L_kv_nosig:
    s_cmp_eq_u32 s63, 1
    s_cbranch_scc1 L_kv_v
    v_and_b32 v20, 0x23, v255
    v_bfe_u32 v21, v255, 2, 1
    v_bfe_u32 v22, v255, 3, 1
    v_lshl_add_u32 v20, v21, 3, v20
    v_lshl_add_u32 v20, v22, 2, v20
    v_and_b32_e64 v21, 16, v255
    v_cmp_lt_u32 s[72:73], 31, v255
    v_cmp_eq_u32_e64 vcc, 0, v21
    v_lshl_add_u32 v20, s65, 4, v20
    v_lshlrev_b32 v54, 4, v20
    v_lshlrev_b32 v55, 2, v20
    v_cndmask_b32 v54, v23, v54, vcc
    v_cndmask_b32_e64 v55, v23, v55, vcc
    s_lshl_b32 s67, s71, 10
    s_add_u32 s67, s67, s70
    s_lshl_b32 s68, s71, 8
    s_add_u32 s68, s68, s70
    s_cmp_ge_u32 s38, 2
    s_cbranch_scc1 L_kv_twok
    s_waitcnt vmcnt(13)
    ds_read_b128 v[16:19], v48 offset:36864
    ds_read_b64_tr_b16 v[32:33], v52 offset:38912
    ds_read_b64_tr_b16 v[34:35], v52 offset:39072
    ds_read_b128 v[20:23], v49 offset:36864
    ds_read_b64_tr_b16 v[36:37], v52 offset:39552
    ds_read_b64_tr_b16 v[38:39], v52 offset:39712
    ds_read_b128 v[24:27], v50 offset:36864
    ds_read_b64_tr_b16 v[40:41], v52 offset:40192
    ds_read_b64_tr_b16 v[42:43], v52 offset:40352
    ds_read_b128 v[28:31], v51 offset:36864
    ds_read_b64_tr_b16 v[44:45], v52 offset:40832
    ds_read_b64_tr_b16 v[46:47], v52 offset:40992
    s_waitcnt lgkmcnt(9)
    v_mfma_f32_32x32x16_bf16 v[0:15], v[32:35], v[16:19], v[0:15]
    s_waitcnt lgkmcnt(6)
    v_mfma_f32_32x32x16_bf16 v[0:15], v[36:39], v[20:23], v[0:15]
    s_waitcnt lgkmcnt(3)
    v_mfma_f32_32x32x16_bf16 v[0:15], v[40:43], v[24:27], v[0:15]
    s_waitcnt lgkmcnt(0)
    v_mfma_f32_32x32x16_bf16 v[0:15], v[44:47], v[28:31], v[0:15]
L_kv_twok:
    s_waitcnt vmcnt(8)
    s_nop 0
    ds_read_b128 v[16:19], v48 offset:18432
    ds_read_b64_tr_b16 v[32:33], v52 offset:20480
    ds_read_b64_tr_b16 v[34:35], v52 offset:20640
    ds_read_b128 v[20:23], v49 offset:18432
    ds_read_b64_tr_b16 v[36:37], v52 offset:21120
    ds_read_b64_tr_b16 v[38:39], v52 offset:21280
    ds_read_b128 v[24:27], v50 offset:18432
    ds_read_b64_tr_b16 v[40:41], v52 offset:21760
    ds_read_b64_tr_b16 v[42:43], v52 offset:21920
    ds_read_b128 v[28:31], v51 offset:18432
    ds_read_b64_tr_b16 v[44:45], v52 offset:22400
    ds_read_b64_tr_b16 v[46:47], v52 offset:22560
    s_waitcnt lgkmcnt(9)
    v_mfma_f32_32x32x16_bf16 v[0:15], v[32:35], v[16:19], v[0:15]
    s_waitcnt lgkmcnt(6)
    v_mfma_f32_32x32x16_bf16 v[0:15], v[36:39], v[20:23], v[0:15]
    s_waitcnt lgkmcnt(3)
    v_mfma_f32_32x32x16_bf16 v[0:15], v[40:43], v[24:27], v[0:15]
    s_waitcnt lgkmcnt(0)
    v_mfma_f32_32x32x16_bf16 v[0:15], v[44:47], v[28:31], v[0:15]
    s_waitcnt vmcnt(3)
    s_nop 0
    ds_read_b128 v[16:19], v48 offset:0
    ds_read_b64_tr_b16 v[32:33], v52 offset:2048
    ds_read_b64_tr_b16 v[34:35], v52 offset:2208
    ds_read_b128 v[20:23], v49 offset:0
    ds_read_b64_tr_b16 v[36:37], v52 offset:2688
    ds_read_b64_tr_b16 v[38:39], v52 offset:2848
    ds_read_b128 v[24:27], v50 offset:0
    ds_read_b64_tr_b16 v[40:41], v52 offset:3328
    ds_read_b64_tr_b16 v[42:43], v52 offset:3488
    ds_read_b128 v[28:31], v51 offset:0
    ds_read_b64_tr_b16 v[44:45], v52 offset:3968
    ds_read_b64_tr_b16 v[46:47], v52 offset:4128
    s_waitcnt lgkmcnt(9)
    v_mfma_f32_32x32x16_bf16 v[0:15], v[32:35], v[16:19], v[0:15]
    s_waitcnt lgkmcnt(6)
    v_mfma_f32_32x32x16_bf16 v[0:15], v[36:39], v[20:23], v[0:15]
    s_waitcnt lgkmcnt(3)
    v_mfma_f32_32x32x16_bf16 v[0:15], v[40:43], v[24:27], v[0:15]
    s_waitcnt lgkmcnt(0)
    v_mfma_f32_32x32x16_bf16 v[0:15], v[44:47], v[28:31], v[0:15]
    s_nop 11
    s_nop 0
    ds_write_b128 v53, v[0:3] offset:0
    ds_write_b128 v53, v[4:7] offset:1024
    ds_write_b128 v53, v[8:11] offset:2048
    s_cmp_lg_u32 s38, 0
    s_waitcnt lgkmcnt(0)
    s_barrier
    s_cbranch_scc1 L_kv_end
    ds_read_b128 v[56:59], v53 offset:4608
    ds_read_b128 v[72:75], v53 offset:9216
    ds_read_b128 v[88:91], v53 offset:13824
    ds_read_b128 v[60:63], v53 offset:5632
    ds_read_b128 v[76:79], v53 offset:10240
    ds_read_b128 v[92:95], v53 offset:14848
    ds_read_b128 v[64:67], v53 offset:6656
    ds_read_b128 v[80:83], v53 offset:11264
    ds_read_b128 v[96:99], v53 offset:15872
    s_waitcnt lgkmcnt(6)
    s_nop 0
    v_pk_add_f32 v[0:1], v[0:1], v[56:57]
    v_pk_add_f32 v[72:73], v[72:73], v[88:89]
    v_pk_add_f32 v[2:3], v[2:3], v[58:59]
    v_pk_add_f32 v[74:75], v[74:75], v[90:91]
    v_pk_add_f32 v[0:1], v[0:1], v[72:73]
    v_pk_add_f32 v[2:3], v[2:3], v[74:75]
    v_cvt_pk_bf16_f32 v16, v0, v1
    v_cvt_pk_bf16_f32 v17, v2, v3
    s_waitcnt lgkmcnt(3)
    s_nop 0
    v_pk_add_f32 v[4:5], v[4:5], v[60:61]
    v_pk_add_f32 v[76:77], v[76:77], v[92:93]
    v_pk_add_f32 v[6:7], v[6:7], v[62:63]
    v_pk_add_f32 v[78:79], v[78:79], v[94:95]
    v_pk_add_f32 v[4:5], v[4:5], v[76:77]
    v_pk_add_f32 v[6:7], v[6:7], v[78:79]
    v_cvt_pk_bf16_f32 v18, v4, v5
    v_cvt_pk_bf16_f32 v19, v6, v7
    buffer_store_dwordx4 v[16:19], v54, s[48:51], s67 offen sc1
    s_waitcnt lgkmcnt(0)
    s_nop 0
    v_pk_add_f32 v[8:9], v[8:9], v[64:65]
    v_pk_add_f32 v[80:81], v[80:81], v[96:97]
    v_pk_add_f32 v[10:11], v[10:11], v[66:67]
    v_pk_add_f32 v[82:83], v[82:83], v[98:99]
    v_pk_add_f32 v[8:9], v[8:9], v[80:81]
    v_pk_add_f32 v[10:11], v[10:11], v[82:83]
    v_cvt_pk_bf16_f32 v20, v8, v9
    v_cvt_pk_bf16_f32 v21, v10, v11
    v_cndmask_b32 v20, v20, v21, s[72:73]
    buffer_store_dword v20, v55, s[48:51], s68 offen offset:2048 sc1
    buffer_load_dword v106, v105, s[56:59], 0 offen sc1
    v_cndmask_b32 v8, v8, v10, s[72:73]
    v_cndmask_b32 v9, v9, v11, s[72:73]
    v_mul_f32 v30, v0, v0
    v_fmac_f32 v30, v1, v1
    v_fmac_f32 v30, v2, v2
    v_fmac_f32 v30, v3, v3
    v_fmac_f32 v30, v4, v4
    v_fmac_f32 v30, v5, v5
    v_fmac_f32 v30, v6, v6
    v_fmac_f32 v30, v7, v7
    v_fmac_f32 v30, v8, v8
    v_fmac_f32 v30, v9, v9
    v_mov_b32 v31, v30
    s_nop 1
    v_permlane32_swap_b32 v30, v31
    v_add_f32_e64 v30, v30, v31
    s_nop 1
    v_max_f32_dpp v30, v30, v30 row_ror:8 row_mask:0xf bank_mask:0xf
    s_nop 1
    v_max_f32_dpp v30, v30, v30 row_ror:4 row_mask:0xf bank_mask:0xf
    s_nop 1
    v_max_f32_dpp v30, v30, v30 row_ror:2 row_mask:0xf bank_mask:0xf
    s_nop 1
    v_max_f32_dpp v30, v30, v30 row_ror:1 row_mask:0xf bank_mask:0xf
    v_mov_b32 v31, v30
    s_nop 1
    v_permlane16_swap_b32 v30, v31
    v_max_f32 v30, v30, v31
    v_or_b32 v30, 1, v30
    s_branch L_kv_flag
L_kv_v:
    v_and_b32_e64 v20, 31, v255
    v_lshrrev_b32 v21, 5, v255
    v_cmp_lt_u32 s[72:73], 19, v20
    v_mul_u32_u24 v21, 352, v21
    v_sub_u32 v22, 21, v20
    v_mul_u32_u24 v22, 0x3f80, v22
    v_lshl_add_u32 v104, v22, 16, v22
    v_mov_b32 v24, v20
    v_cmp_eq_u32_e64 vcc, 15, v24
    v_cmp_eq_u32 s[76:77], 21, v24
    v_and_b32_e64 v25, 28, v24
    s_mov_b32 s39, 0x523104
    v_bfe_u32 v25, s39, v25, 4
    v_and_b32_e64 v24, 3, v24
    v_lshl_add_u32 v24, v25, 2, v24
    v_cndmask_b32 v24, v24, 21, vcc
    v_cndmask_b32 v24, v24, 15, s[76:77]
    v_cmp_lt_u32 vcc, 21, v20
    v_lshl_add_u32 v54, v24, 4, v21
    s_nop 0
    v_cndmask_b32 v54, v54, v23, vcc
    s_and_b32 s67, s62, 3
    s_mul_i32 s67, s67, 704
    s_add_u32 s67, s67, s70
    s_add_u32 s67, s67, 2560
    s_cmp_ge_u32 s38, 2
    s_cbranch_scc1 L_kv_twov
    s_waitcnt vmcnt(13)
    ds_read_b128 v[16:19], v48 offset:36864
    ds_read_b64_tr_b16 v[32:33], v52 offset:38912
    ds_read_b64_tr_b16 v[34:35], v52 offset:39072
    ds_read_b128 v[20:23], v49 offset:36864
    ds_read_b64_tr_b16 v[36:37], v52 offset:39552
    ds_read_b64_tr_b16 v[38:39], v52 offset:39712
    ds_read_b128 v[24:27], v50 offset:36864
    ds_read_b64_tr_b16 v[40:41], v52 offset:40192
    ds_read_b64_tr_b16 v[42:43], v52 offset:40352
    ds_read_b128 v[28:31], v51 offset:36864
    ds_read_b64_tr_b16 v[44:45], v52 offset:40832
    ds_read_b64_tr_b16 v[46:47], v52 offset:40992
    s_waitcnt lgkmcnt(9)
    v_mfma_f32_32x32x16_bf16 v[0:15], v[16:19], v[32:35], v[0:15]
    s_waitcnt lgkmcnt(6)
    v_mfma_f32_32x32x16_bf16 v[0:15], v[20:23], v[36:39], v[0:15]
    s_waitcnt lgkmcnt(3)
    v_mfma_f32_32x32x16_bf16 v[0:15], v[24:27], v[40:43], v[0:15]
    s_waitcnt lgkmcnt(0)
    v_mfma_f32_32x32x16_bf16 v[0:15], v[28:31], v[44:47], v[0:15]
L_kv_twov:
    s_waitcnt vmcnt(8)
    s_nop 0
    ds_read_b128 v[16:19], v48 offset:18432
    ds_read_b64_tr_b16 v[32:33], v52 offset:20480
    ds_read_b64_tr_b16 v[34:35], v52 offset:20640
    ds_read_b128 v[20:23], v49 offset:18432
    ds_read_b64_tr_b16 v[36:37], v52 offset:21120
    ds_read_b64_tr_b16 v[38:39], v52 offset:21280
    ds_read_b128 v[24:27], v50 offset:18432
    ds_read_b64_tr_b16 v[40:41], v52 offset:21760
    ds_read_b64_tr_b16 v[42:43], v52 offset:21920
    ds_read_b128 v[28:31], v51 offset:18432
    ds_read_b64_tr_b16 v[44:45], v52 offset:22400
    ds_read_b64_tr_b16 v[46:47], v52 offset:22560
    s_waitcnt lgkmcnt(9)
    v_mfma_f32_32x32x16_bf16 v[0:15], v[16:19], v[32:35], v[0:15]
    s_waitcnt lgkmcnt(6)
    v_mfma_f32_32x32x16_bf16 v[0:15], v[20:23], v[36:39], v[0:15]
    s_waitcnt lgkmcnt(3)
    v_mfma_f32_32x32x16_bf16 v[0:15], v[24:27], v[40:43], v[0:15]
    s_waitcnt lgkmcnt(0)
    v_mfma_f32_32x32x16_bf16 v[0:15], v[28:31], v[44:47], v[0:15]
    s_waitcnt vmcnt(3)
    s_nop 0
    ds_read_b128 v[16:19], v48 offset:0
    ds_read_b64_tr_b16 v[32:33], v52 offset:2048
    ds_read_b64_tr_b16 v[34:35], v52 offset:2208
    ds_read_b128 v[20:23], v49 offset:0
    ds_read_b64_tr_b16 v[36:37], v52 offset:2688
    ds_read_b64_tr_b16 v[38:39], v52 offset:2848
    ds_read_b128 v[24:27], v50 offset:0
    ds_read_b64_tr_b16 v[40:41], v52 offset:3328
    ds_read_b64_tr_b16 v[42:43], v52 offset:3488
    ds_read_b128 v[28:31], v51 offset:0
    ds_read_b64_tr_b16 v[44:45], v52 offset:3968
    ds_read_b64_tr_b16 v[46:47], v52 offset:4128
    s_waitcnt lgkmcnt(9)
    v_mfma_f32_32x32x16_bf16 v[0:15], v[16:19], v[32:35], v[0:15]
    s_waitcnt lgkmcnt(6)
    v_mfma_f32_32x32x16_bf16 v[0:15], v[20:23], v[36:39], v[0:15]
    s_waitcnt lgkmcnt(3)
    v_mfma_f32_32x32x16_bf16 v[0:15], v[24:27], v[40:43], v[0:15]
    s_waitcnt lgkmcnt(0)
    v_mfma_f32_32x32x16_bf16 v[0:15], v[28:31], v[44:47], v[0:15]
    s_nop 11
    ds_write_b128 v53, v[0:3] offset:0
    ds_write_b128 v53, v[4:7] offset:1024
    s_cmp_lg_u32 s38, 0
    s_waitcnt lgkmcnt(0)
    s_barrier
    s_cbranch_scc1 L_kv_end
    s_nop 0
    ds_read_b128 v[56:59], v53 offset:4608
    ds_read_b128 v[72:75], v53 offset:9216
    ds_read_b128 v[88:91], v53 offset:13824
    ds_read_b128 v[60:63], v53 offset:5632
    ds_read_b128 v[76:79], v53 offset:10240
    ds_read_b128 v[92:95], v53 offset:14848
    s_waitcnt lgkmcnt(3)
    s_nop 0
    v_pk_add_f32 v[0:1], v[0:1], v[56:57]
    v_pk_add_f32 v[72:73], v[72:73], v[88:89]
    v_pk_add_f32 v[2:3], v[2:3], v[58:59]
    v_pk_add_f32 v[74:75], v[74:75], v[90:91]
    v_pk_add_f32 v[0:1], v[0:1], v[72:73]
    v_pk_add_f32 v[2:3], v[2:3], v[74:75]
    v_cvt_pk_bf16_f32 v16, v0, v1
    v_cvt_pk_bf16_f32 v17, v2, v3
    v_cndmask_b32 v16, v16, v104, s[72:73]
    v_cndmask_b32 v17, v17, v104, s[72:73]
    s_waitcnt lgkmcnt(0)
    s_nop 0
    v_pk_add_f32 v[4:5], v[4:5], v[60:61]
    v_pk_add_f32 v[76:77], v[76:77], v[92:93]
    v_pk_add_f32 v[6:7], v[6:7], v[62:63]
    v_pk_add_f32 v[78:79], v[78:79], v[94:95]
    v_pk_add_f32 v[4:5], v[4:5], v[76:77]
    v_pk_add_f32 v[6:7], v[6:7], v[78:79]
    v_cvt_pk_bf16_f32 v18, v4, v5
    v_cvt_pk_bf16_f32 v19, v6, v7
    v_cndmask_b32 v18, v18, v104, s[72:73]
    v_cndmask_b32 v19, v19, v104, s[72:73]
    buffer_store_dwordx4 v[16:19], v54, s[48:51], s67 offen sc1
    buffer_load_dword v106, v105, s[56:59], 0 offen sc1
    v_max3_f32 v30, |v0|, |v1|, |v2|
    v_max3_f32 v31, |v3|, |v4|, |v5|
    v_max3_f32 v30, v30, |v6|, |v7|
    v_max_u32_e64 v30, v30, v31
    v_subrev_u32 v31, 0x2b800000, v30
    v_cmp_ne_u32 s[72:73], 0, v30
    v_cmp_lt_u32 vcc, 0x28000000, v31
    s_nop 0
    s_and_b64 vcc, vcc, s[72:73]
    s_cselect_b32 s39, 0x7f800001, 1
    v_mov_b32 v30, s39
L_kv_flag:
    s_waitcnt vmcnt(0)
    v_cmp_gt_u32 vcc, 4, v106
    s_cbranch_vccz L_kv_sig
    s_mov_b64 exec, 1
    v_mov_b32 v105, 0
    s_mov_b32 s39, 40000
L_poll_1:
    buffer_load_dword v106, v105, s[56:59], 0 offen sc1
    s_sub_u32 s39, s39, 1
    s_cbranch_scc1 L_polled_2
    s_waitcnt vmcnt(0)
    v_cmp_gt_u32 vcc, 4, v106
    s_cbranch_vccz L_polled_2
    s_branch L_poll_1
L_polled_2:
    s_waitcnt vmcnt(0)
    s_mov_b64 exec, -1
L_kv_sig:
    s_mov_b64 exec, 1
    buffer_store_dword v30, v105, s[52:55], s66 offen sc1
    s_mov_b64 exec, -1
L_kv_end:
    s_setprio 0
    s_lshl_b32 s67, s38, 13
    s_add_u32 s67, s67, 36864
    s_and_b32 s70, s38, 1
    s_lshl_b32 s70, s70, 6
    v_lshrrev_b32 v4, 5, v255
    v_bfe_u32 v5, v255, 4, 1
    v_and_b32_e64 v6, 15, v255
    v_lshrrev_b32 v7, 4, v255
    v_bfe_u32 v8, v255, 2, 2
    v_and_b32_e64 v9, 3, v255
    v_bfe_u32 v10, v255, 3, 1
    v_bfe_u32 v11, v255, 1, 3
    v_mov_b32 v119, 0
    v_xor_b32 v224, s70, v254
    v_xor_b32_e64 v225, 64, v224
    v_mul_u32_u24 v1, 24, v4
    v_mul_u32_u24 v2, 12, v10
    v_add3_u32 v1, v1, v2, v5
    v_mul_u32_u24 v1, 1280, v1
    v_and_b32 v2, 0x70, v224
    v_add_u32 v112, v1, v2
    v_xor_b32 v1, v7, v11
    v_lshlrev_b32_e64 v2, 7, v6
    v_lshl_add_u32 v1, v1, 4, v2
    v_add_u32 v116, s67, v1
    v_xor_b32 v117, 64, v116
    v_lshl_add_u32 v114, v10, 11, v1
    v_xor_b32 v115, 64, v114
    v_xor_b32 v1, v5, v11
    v_lshl_add_u32 v1, v1, 4, v2
    v_mul_u32_u24 v2, 10240, v4
    s_lshr_b32 s70, s38, 1
    s_lshl_b32 s70, s70, 6
    v_add_u32 v1, v1, v2
    v_xor_b32 v216, s70, v1
    v_xor_b32_e64 v217, 32, v216
    v_add_u32 v218, 40960, v216
    v_add_u32 v219, 40960, v217
    v_mov_b32_e64 v118, 1
    s_mul_i32 s70, s38, 6656
    v_mul_u32_u24 v1, 208, v6
    v_mul_u32_u24 v2, 48, v7
    s_nop 0
    v_add3_u32 v159, v1, v2, s70
    v_lshl_add_u32 v1, v7, 3, v8
    v_mul_u32_u24 v1, 208, v1
    v_lshlrev_b32_e64 v2, 3, v9
    v_add3_u32 v160, v1, v2, s70
    v_lshlrev_b32_e64 v158, 3, v6
    s_sub_u32 s72, s74, 1
    v_sub_u32 v1, s72, v7
    v_mul_i32_i24 v1, 5120, v1
    v_add_u32_e64 v1, v1, v158
    v_subrev_u32 v2, 0, v1
    v_lshrrev_b32 v152, 31, v2
    v_min_u32 v146, 0x7fff0000, v2
    v_subrev_u32 v2, 20480, v1
    v_lshrrev_b32 v153, 31, v2
    v_min_u32 v147, 0x7fff0000, v2
    v_subrev_u32 v2, 40960, v1
    v_lshrrev_b32 v154, 31, v2
    v_min_u32 v148, 0x7fff0000, v2
    v_subrev_u32 v2, 61440, v1
    v_lshrrev_b32 v155, 31, v2
    v_min_u32 v149, 0x7fff0000, v2
    v_subrev_u32 v2, 81920, v1
    v_lshrrev_b32 v156, 31, v2
    v_min_u32 v150, 0x7fff0000, v2
    v_subrev_u32 v2, 102400, v1
    v_lshrrev_b32 v157, 31, v2
    v_min_u32 v151, 0x7fff0000, v2
    s_and_b32 s70, s61, 7
    s_mul_i32 s70, s70, 160
    s_lshr_b32 s71, s61, 3
    s_lshl_b32 s72, s60, 2
    s_add_u32 s71, s71, s72
    s_lshl_b32 s71, s71, 1
    s_and_b32 s72, s38, 1
    s_add_u32 s71, s71, s72
    s_lshl_b32 s71, s71, 1
    s_lshr_b32 s72, s38, 1
    s_add_u32 s71, s71, s72
    s_nop 0
    s_mul_i32 s71, s71, 20480
    v_mul_u32_u24 v1, 336, v6
    v_lshl_add_u32 v1, v7, 4, v1
    s_xor_b32 s72, s38, 2
    s_mul_i32 s72, s72, 5376
    s_add_u32 s72, s72, 21504
    v_add_u32 v220, s72, v1
    s_mul_i32 s72, s38, 5376
    v_add_u32 v226, s72, v1
    v_add_u32 v1, 0, v255
    v_mul_u32_u24 v2, 3277, v1
    v_lshrrev_b32 v2, 16, v2
    v_add_lshl_u32 v3, v1, v2, 4
    v_add_u32 v227, s72, v3
    v_mul_u32_u24 v3, 4800, v2
    v_lshl_add_u32 v232, v1, 4, v3
    v_mul_u32_u24 v3, 20, v2
    v_sub_u32 v3, v1, v3
    v_lshl_add_u32 v242, v3, 3, s70
    v_mul_u32_u24 v2, 1280, v2
    v_add3_u32 v237, v2, v242, s71
    v_add_u32_e64 v1, 64, v255
    v_mul_u32_u24 v2, 3277, v1
    v_lshrrev_b32 v2, 16, v2
    v_add_lshl_u32 v3, v1, v2, 4
    v_add_u32 v228, s72, v3
    v_mul_u32_u24 v3, 4800, v2
    v_lshl_add_u32 v233, v1, 4, v3
    v_mul_u32_u24 v3, 20, v2
    v_sub_u32 v3, v1, v3
    v_lshl_add_u32 v243, v3, 3, s70
    v_mul_u32_u24 v2, 1280, v2
    v_add3_u32 v238, v2, v243, s71
    v_add_u32 v1, 128, v255
    v_mul_u32_u24 v2, 3277, v1
    v_lshrrev_b32 v2, 16, v2
    v_add_lshl_u32 v3, v1, v2, 4
    v_add_u32 v229, s72, v3
    v_mul_u32_u24 v3, 4800, v2
    v_lshl_add_u32 v234, v1, 4, v3
    v_mul_u32_u24 v3, 20, v2
    v_sub_u32 v3, v1, v3
    v_lshl_add_u32 v244, v3, 3, s70
    v_mul_u32_u24 v2, 1280, v2
    v_add3_u32 v239, v2, v244, s71
    v_add_u32 v1, 192, v255
    v_mul_u32_u24 v2, 3277, v1
    v_lshrrev_b32 v2, 16, v2
    v_add_lshl_u32 v3, v1, v2, 4
    v_add_u32 v230, s72, v3
    v_mul_u32_u24 v3, 4800, v2
    v_lshl_add_u32 v235, v1, 4, v3
    v_mul_u32_u24 v3, 20, v2
    v_sub_u32 v3, v1, v3
    v_lshl_add_u32 v245, v3, 3, s70
    v_mul_u32_u24 v2, 1280, v2
    v_add3_u32 v240, v2, v245, s71
    v_add_u32 v1, 256, v255
    v_mul_u32_u24 v2, 3277, v1
    v_lshrrev_b32 v2, 16, v2
    v_add_lshl_u32 v3, v1, v2, 4
    v_add_u32 v231, s72, v3
    v_mul_u32_u24 v3, 4800, v2
    v_lshl_add_u32 v236, v1, 4, v3
    v_mul_u32_u24 v3, 20, v2
    v_sub_u32 v3, v1, v3
    v_lshl_add_u32 v246, v3, 3, s70
    v_mul_u32_u24 v2, 1280, v2
    v_add3_u32 v241, v2, v246, s71
    s_waitcnt vmcnt(0)
    v_lshlrev_b32 v164, 16, v164
    v_lshlrev_b32 v165, 16, v165
    v_lshlrev_b32 v166, 16, v166
    v_mul_f32 v166, 0x3fb8aa3b, v166
    v_exp_f32 v166, v166
    v_cvt_f32_u32 v7, v7
    v_cvt_pk_bf16_f32 v166, v166, v166
    v_lshlrev_b32 v166, 16, v166
    v_mul_f32 v12, v166, v164
    v_mul_f32_e64 v13, v166, v165
    v_mul_f32 v12, 0x3fb8aa3b, v12
    v_mul_f32 v13, 0x3e22f983, v13
    v_mul_f32 v14, 1.0, v12
    v_mul_f32 v15, 1.0, v13
    v_exp_f32 v14, v14
    v_fract_f32 v15, v15
    v_cos_f32 v132, v15
    v_sin_f32 v133, v15
    v_mul_f32 v132, v14, v132
    v_mul_f32_e64 v133, v14, v133
    v_mul_f32 v14, 0x40c00000, v12
    v_mul_f32 v15, 0x40c00000, v13
    v_exp_f32 v14, v14
    v_fract_f32 v15, v15
    v_cos_f32 v122, v15
    v_sin_f32 v123, v15
    v_mul_f32 v122, v14, v122
    v_mul_f32 v123, v14, v123
    v_mul_f32 v14, 0x41400000, v12
    v_mul_f32 v15, 0x41400000, v13
    v_exp_f32 v14, v14
    v_fract_f32 v15, v15
    v_cos_f32 v134, v15
    v_sin_f32 v135, v15
    v_mul_f32 v134, v14, v134
    v_mul_f32 v135, v14, v135
    v_mul_f32 v14, 0x41c00000, v12
    v_mul_f32 v15, 0x41c00000, v13
    v_exp_f32 v14, v14
    v_fract_f32 v15, v15
    v_cos_f32 v136, v15
    v_sin_f32 v137, v15
    v_mul_f32 v136, v14, v136
    v_mul_f32 v137, v14, v137
    v_mul_f32 v14, 0x43c00000, v12
    v_mul_f32 v15, 0x43c00000, v13
    v_exp_f32 v14, v14
    v_fract_f32 v15, v15
    v_cos_f32 v142, v15
    v_sin_f32 v143, v15
    v_mul_f32 v142, v14, v142
    v_mul_f32 v143, v14, v143
    v_mul_f32 v7, 0x41c00000, v7
    v_mul_f32 v14, v7, v12
    v_mul_f32 v15, v7, v13
    v_exp_f32 v14, v14
    v_fract_f32 v15, v15
    v_cos_f32 v138, v15
    v_sin_f32 v139, v15
    v_mul_f32 v138, v14, v138
    v_mul_f32 v139, v14, v139
    v_mul_f32 v7, 4.0, v7
    v_mul_f32 v14, v7, v12
    v_mul_f32 v15, v7, v13
    v_exp_f32 v14, v14
    v_fract_f32 v15, v15
    v_cos_f32 v140, v15
    v_sin_f32 v141, v15
    v_mul_f32 v140, v14, v140
    v_mul_f32 v141, v14, v141
    v_mul_f32 v14, v164, v164
    v_fmac_f32 v14, v165, v165
    v_rcp_f32 v14, v14
    v_add_f32 v15, -1.0, v132
    v_mul_f32 v144, v15, v164
    v_mul_f32 v145, v133, v164
    v_add_f32 v14, v14, v14
    v_fmac_f32_e64 v144, v133, v165
    v_fma_f32 v145, -v15, v165, v145
    v_mul_f32 v144, v14, v144
    v_mul_f32 v145, v14, v145
    v_mov_b32 v180, v132
    v_mov_b32 v181, v132
    v_mov_b32 v182, v133
    v_mov_b32 v183, v133
    v_mov_b32 v184, v122
    v_mov_b32 v185, v122
    v_mov_b32 v186, v123
    v_mov_b32 v187, v123
    v_mov_b32 v188, v144
    v_mov_b32 v189, v144
    v_mov_b32 v190, v145
    v_mov_b32 v191, v145
    s_cmp_eq_u32 s101, 0
    s_cbranch_scc1 L_u_idle
    s_mov_b32 s40, s14
    s_mov_b32 s41, s15
    s_mov_b32 s42, 0x280000
    s_mov_b32 s43, 0x20000
    s_mov_b32 s44, s20
    s_mov_b32 s45, s21
    s_mov_b32 s46, 0xc8000
    s_mov_b32 s47, 0x20000
    s_mov_b32 s48, s22
    s_mov_b32 s49, s23
    s_mov_b32 s50, 0xc8000
    s_mov_b32 s51, 0x20000
    s_and_b32 s70, s38, 1
    s_lshr_b32 s71, s38, 1
    s_mul_i32 s71, s71, 6
    s_mul_i32 s72, s70, 48
    s_add_u32 s71, s71, s72
    s_mul_i32 s72, s74, 96
    s_add_u32 s71, s71, s72
    s_mul_i32 s64, s71, 1280
    s_mul_i32 s65, s75, 20480
    s_mul_i32 s66, s38, 3072
    s_lshl_b32 s67, s38, 13
    s_add_u32 s67, s67, 36864
    s_mov_b32 s68, s100
    s_cmp_lg_u32 s38, 0
    s_cbranch_scc1 L_w0_3
    s_lshl_b32 s70, s60, 5
    s_add_u32 s70, s70, s61
    s_lshl_b32 s70, s70, 5
    s_nop 0
    s_add_u32 s70, s70, 8192
    s_mov_b32 s39, 40000
L_spoll_4:
    s_load_dword s3, s[36:37], s70 glc
    s_sub_u32 s39, s39, 1
    s_cbranch_scc1 L_spolled_5
    s_waitcnt lgkmcnt(0)
    s_cmp_ge_u32 s3, 1
    s_cbranch_scc1 L_spolled_5
    s_sleep 4
    s_branch L_spoll_4
L_spolled_5:
    s_waitcnt lgkmcnt(0)
L_w0_3:
    s_barrier
    s_add_u32 m0, s66, 0
    s_add_u32 s70, s64, s100
    s_nop 0
    buffer_load_dwordx4 v112, s[40:43], s70 offen lds
    s_add_u32 s70, s70, 1536
    buffer_load_dwordx4 v112, s[40:43], s70 offen offset:1024 lds
    s_add_u32 s70, s70, 1536
    buffer_load_dwordx4 v112, s[40:43], s70 offen offset:2048 lds
    s_add_u32 s100, s100, 128
    s_cmp_eq_u32 s100, 1280
    s_cselect_b32 s100, 0, s100
    s_add_u32 m0, s67, 0
    s_add_u32 s71, s65, s68
    s_nop 0
    buffer_load_dwordx4 v254, s[44:47], s71 offen lds
    buffer_load_dwordx4 v253, s[44:47], s71 offen offset:1024 lds
    s_add_u32 m0, s67, 2048
    s_add_u32 s68, s68, 128
    s_cmp_eq_u32 s68, 1280
    s_cselect_b32 s68, 0, s68
    s_nop 0
    buffer_load_dwordx4 v254, s[48:51], s71 offen lds
    buffer_load_dwordx4 v253, s[48:51], s71 offen offset:1024 lds
    s_add_u32 m0, s66, 12288
    s_add_u32 s70, s64, s100
    s_nop 0
    buffer_load_dwordx4 v112, s[40:43], s70 offen lds
    s_add_u32 s70, s70, 1536
    buffer_load_dwordx4 v112, s[40:43], s70 offen offset:1024 lds
    s_add_u32 s70, s70, 1536
    buffer_load_dwordx4 v112, s[40:43], s70 offen offset:2048 lds
    s_add_u32 s100, s100, 128
    s_cmp_eq_u32 s100, 1280
    s_cselect_b32 s100, 0, s100
    s_setprio 0
    s_waitcnt vmcnt(3)
    s_barrier
    ds_read_b128 v[48:51], v116 offset:0
    ds_read_b128 v[52:55], v116 offset:2048
    ds_read_b128 v[80:83], v114 offset:0
    ds_read_b128 v[84:87], v114 offset:1024
    ds_read_b128 v[88:91], v114 offset:2048
    ds_read_b128 v[56:59], v117 offset:0
    ds_read_b128 v[60:63], v117 offset:2048
    ds_read_b128 v[92:95], v114 offset:6144
    ds_read_b128 v[96:99], v114 offset:7168
    ds_read_b128 v[100:103], v114 offset:8192
    s_add_u32 m0, s67, 4096
    s_add_u32 s71, s65, s68
    buffer_load_dwordx4 v254, s[44:47], s71 offen lds
    buffer_load_dwordx4 v253, s[44:47], s71 offen offset:1024 lds
    s_add_u32 m0, s67, 6144
    s_add_u32 s68, s68, 128
    s_cmp_eq_u32 s68, 1280
    s_cselect_b32 s68, 0, s68
    buffer_load_dwordx4 v254, s[48:51], s71 offen lds
    buffer_load_dwordx4 v253, s[48:51], s71 offen offset:1024 lds
    s_add_u32 m0, s66, 24576
    s_add_u32 s70, s64, s100
    buffer_load_dwordx4 v112, s[40:43], s70 offen lds
    s_add_u32 s70, s70, 1536
    buffer_load_dwordx4 v112, s[40:43], s70 offen offset:1024 lds
    s_add_u32 s70, s70, 1536
    buffer_load_dwordx4 v112, s[40:43], s70 offen offset:2048 lds
    s_add_u32 s100, s100, 128
    s_cmp_eq_u32 s100, 1280
    s_cselect_b32 s100, 0, s100
    s_waitcnt lgkmcnt(5)
    s_setprio 3
    v_mfma_f32_16x16x32_bf16 v[0:3], v[80:83], v[48:51], 0
    v_mfma_f32_16x16x32_bf16 v[24:27], v[80:83], v[52:55], 0
    s_setprio 0
    ds_read_b128 v[168:171], v115 offset:0
    v_mfma_f32_16x16x32_bf16 v[4:7], v[84:87], v[48:51], 0
    v_mfma_f32_16x16x32_bf16 v[28:31], v[84:87], v[52:55], 0
    ds_read_b128 v[172:175], v115 offset:1024
    v_mfma_f32_16x16x32_bf16 v[8:11], v[88:91], v[48:51], 0
    v_mfma_f32_16x16x32_bf16 v[32:35], v[88:91], v[52:55], 0
    ds_read_b128 v[176:179], v115 offset:2048
    s_waitcnt lgkmcnt(3)
    s_setprio 3
    v_mfma_f32_16x16x32_bf16 v[12:15], v[92:95], v[48:51], 0
    v_mfma_f32_16x16x32_bf16 v[36:39], v[92:95], v[52:55], 0
    s_setprio 0
    ds_read_b128 v[80:83], v115 offset:6144
    v_mfma_f32_16x16x32_bf16 v[16:19], v[96:99], v[48:51], 0
    v_mfma_f32_16x16x32_bf16 v[40:43], v[96:99], v[52:55], 0
    ds_read_b128 v[84:87], v115 offset:7168
    s_add_u32 m0, s67, 0
    s_add_u32 s71, s65, s68
    buffer_load_dwordx4 v254, s[44:47], s71 offen lds
    v_mfma_f32_16x16x32_bf16 v[20:23], v[100:103], v[48:51], 0
    v_mfma_f32_16x16x32_bf16 v[44:47], v[100:103], v[52:55], 0
    ds_read_b128 v[88:91], v115 offset:8192
    buffer_load_dwordx4 v253, s[44:47], s71 offen offset:1024 lds
    s_waitcnt lgkmcnt(0)
    s_waitcnt vmcnt(5)
    s_barrier
    s_setprio 3
    v_mfma_f32_16x16x32_bf16 v[0:3], v[168:171], v[56:59], v[0:3]
    v_mfma_f32_16x16x32_bf16 v[24:27], v[168:171], v[60:63], v[24:27]
    s_setprio 0
    ds_read_b128 v[64:67], v116 offset:4096
    ds_read_b128 v[92:95], v114 offset:12288
    v_mfma_f32_16x16x32_bf16 v[4:7], v[172:175], v[56:59], v[4:7]
    v_mfma_f32_16x16x32_bf16 v[28:31], v[172:175], v[60:63], v[28:31]
    ds_read_b128 v[68:71], v116 offset:6144
    ds_read_b128 v[96:99], v114 offset:13312
    s_add_u32 m0, s67, 2048
    s_add_u32 s68, s68, 128
    s_cmp_eq_u32 s68, 1280
    s_cselect_b32 s68, 0, s68
    buffer_load_dwordx4 v254, s[48:51], s71 offen lds
    v_mfma_f32_16x16x32_bf16 v[8:11], v[176:179], v[56:59], v[8:11]
    v_mfma_f32_16x16x32_bf16 v[32:35], v[176:179], v[60:63], v[32:35]
    ds_read_b128 v[100:103], v114 offset:14336
    buffer_load_dwordx4 v253, s[48:51], s71 offen offset:1024 lds
    s_waitcnt lgkmcnt(5)
    s_setprio 3
    v_mfma_f32_16x16x32_bf16 v[12:15], v[80:83], v[56:59], v[12:15]
    v_mfma_f32_16x16x32_bf16 v[36:39], v[80:83], v[60:63], v[36:39]
    s_setprio 0
    ds_read_b128 v[72:75], v117 offset:4096
    ds_read_b128 v[168:171], v114 offset:18432
    s_add_u32 m0, s66, 0
    s_add_u32 s70, s64, s100
    buffer_load_dwordx4 v112, s[40:43], s70 offen lds
    v_mfma_f32_16x16x32_bf16 v[16:19], v[84:87], v[56:59], v[16:19]
    v_mfma_f32_16x16x32_bf16 v[40:43], v[84:87], v[60:63], v[40:43]
    ds_read_b128 v[76:79], v117 offset:6144
    ds_read_b128 v[172:175], v114 offset:19456
    s_add_u32 s70, s70, 1536
    buffer_load_dwordx4 v112, s[40:43], s70 offen offset:1024 lds
    v_mfma_f32_16x16x32_bf16 v[20:23], v[88:91], v[56:59], v[20:23]
    v_mfma_f32_16x16x32_bf16 v[44:47], v[88:91], v[60:63], v[44:47]
    ds_read_b128 v[176:179], v114 offset:20480
    s_add_u32 s70, s70, 1536
    buffer_load_dwordx4 v112, s[40:43], s70 offen offset:2048 lds
    s_add_u32 s100, s100, 128
    s_cmp_eq_u32 s100, 1280
    s_cselect_b32 s100, 0, s100
    s_waitcnt lgkmcnt(5)
    s_setprio 3
    v_mfma_f32_16x16x32_bf16 v[0:3], v[92:95], v[64:67], v[0:3]
    v_mfma_f32_16x16x32_bf16 v[24:27], v[92:95], v[68:71], v[24:27]
    s_setprio 0
    ds_read_b128 v[80:83], v115 offset:12288
    v_mfma_f32_16x16x32_bf16 v[4:7], v[96:99], v[64:67], v[4:7]
    v_mfma_f32_16x16x32_bf16 v[28:31], v[96:99], v[68:71], v[28:31]
    ds_read_b128 v[84:87], v115 offset:13312
    v_mfma_f32_16x16x32_bf16 v[8:11], v[100:103], v[64:67], v[8:11]
    v_mfma_f32_16x16x32_bf16 v[32:35], v[100:103], v[68:71], v[32:35]
    ds_read_b128 v[88:91], v115 offset:14336
    s_waitcnt lgkmcnt(3)
    s_setprio 3
    v_mfma_f32_16x16x32_bf16 v[12:15], v[168:171], v[64:67], v[12:15]
    v_mfma_f32_16x16x32_bf16 v[36:39], v[168:171], v[68:71], v[36:39]
    s_setprio 0
    ds_read_b128 v[92:95], v115 offset:18432
    v_mfma_f32_16x16x32_bf16 v[16:19], v[172:175], v[64:67], v[16:19]
    v_mfma_f32_16x16x32_bf16 v[40:43], v[172:175], v[68:71], v[40:43]
    ds_read_b128 v[96:99], v115 offset:19456
    s_add_u32 m0, s67, 4096
    s_add_u32 s71, s65, s68
    buffer_load_dwordx4 v254, s[44:47], s71 offen lds
    v_mfma_f32_16x16x32_bf16 v[20:23], v[176:179], v[64:67], v[20:23]
    v_mfma_f32_16x16x32_bf16 v[44:47], v[176:179], v[68:71], v[44:47]
    ds_read_b128 v[100:103], v115 offset:20480
    buffer_load_dwordx4 v253, s[44:47], s71 offen offset:1024 lds
    s_waitcnt lgkmcnt(0)
    s_waitcnt vmcnt(5)
    s_barrier
    s_setprio 3
    v_mfma_f32_16x16x32_bf16 v[0:3], v[80:83], v[72:75], v[0:3]
    v_mfma_f32_16x16x32_bf16 v[24:27], v[80:83], v[76:79], v[24:27]
    s_setprio 0
    ds_read_b128 v[48:51], v116 offset:0
    ds_read_b128 v[168:171], v114 offset:24576
    v_mfma_f32_16x16x32_bf16 v[4:7], v[84:87], v[72:75], v[4:7]
    v_mfma_f32_16x16x32_bf16 v[28:31], v[84:87], v[76:79], v[28:31]
    ds_read_b128 v[52:55], v116 offset:2048
    ds_read_b128 v[172:175], v114 offset:25600
    s_add_u32 m0, s67, 6144
    s_add_u32 s68, s68, 128
    s_cmp_eq_u32 s68, 1280
    s_cselect_b32 s68, 0, s68
    buffer_load_dwordx4 v254, s[48:51], s71 offen lds
    v_mfma_f32_16x16x32_bf16 v[8:11], v[88:91], v[72:75], v[8:11]
    v_mfma_f32_16x16x32_bf16 v[32:35], v[88:91], v[76:79], v[32:35]
    ds_read_b128 v[176:179], v114 offset:26624
    buffer_load_dwordx4 v253, s[48:51], s71 offen offset:1024 lds
    s_waitcnt lgkmcnt(5)
    s_setprio 3
    v_mfma_f32_16x16x32_bf16 v[12:15], v[92:95], v[72:75], v[12:15]
    v_mfma_f32_16x16x32_bf16 v[36:39], v[92:95], v[76:79], v[36:39]
    s_setprio 0
    ds_read_b128 v[56:59], v117 offset:0
    ds_read_b128 v[80:83], v114 offset:30720
    s_add_u32 m0, s66, 12288
    s_add_u32 s70, s64, s100
    buffer_load_dwordx4 v112, s[40:43], s70 offen lds
    v_mfma_f32_16x16x32_bf16 v[16:19], v[96:99], v[72:75], v[16:19]
    v_mfma_f32_16x16x32_bf16 v[40:43], v[96:99], v[76:79], v[40:43]
    ds_read_b128 v[60:63], v117 offset:2048
    ds_read_b128 v[84:87], v114 offset:31744
    s_add_u32 s70, s70, 1536
    buffer_load_dwordx4 v112, s[40:43], s70 offen offset:1024 lds
    v_mfma_f32_16x16x32_bf16 v[20:23], v[100:103], v[72:75], v[20:23]
    v_mfma_f32_16x16x32_bf16 v[44:47], v[100:103], v[76:79], v[44:47]
    ds_read_b128 v[88:91], v114 offset:32768
    s_add_u32 s70, s70, 1536
    buffer_load_dwordx4 v112, s[40:43], s70 offen offset:2048 lds
    s_add_u32 s100, s100, 128
    s_cmp_eq_u32 s100, 1280
    s_cselect_b32 s100, 0, s100
    s_waitcnt lgkmcnt(5)
    s_setprio 3
    v_mfma_f32_16x16x32_bf16 v[0:3], v[168:171], v[48:51], v[0:3]
    v_mfma_f32_16x16x32_bf16 v[24:27], v[168:171], v[52:55], v[24:27]
    s_setprio 0
    ds_read_b128 v[92:95], v115 offset:24576
    v_mfma_f32_16x16x32_bf16 v[4:7], v[172:175], v[48:51], v[4:7]
    v_mfma_f32_16x16x32_bf16 v[28:31], v[172:175], v[52:55], v[28:31]
    ds_read_b128 v[96:99], v115 offset:25600
    v_mfma_f32_16x16x32_bf16 v[8:11], v[176:179], v[48:51], v[8:11]
    v_mfma_f32_16x16x32_bf16 v[32:35], v[176:179], v[52:55], v[32:35]
    ds_read_b128 v[100:103], v115 offset:26624
    s_waitcnt lgkmcnt(3)
    s_setprio 3
    v_mfma_f32_16x16x32_bf16 v[12:15], v[80:83], v[48:51], v[12:15]
    v_mfma_f32_16x16x32_bf16 v[36:39], v[80:83], v[52:55], v[36:39]
    s_setprio 0
    ds_read_b128 v[168:171], v115 offset:30720
    v_mfma_f32_16x16x32_bf16 v[16:19], v[84:87], v[48:51], v[16:19]
    v_mfma_f32_16x16x32_bf16 v[40:43], v[84:87], v[52:55], v[40:43]
    ds_read_b128 v[172:175], v115 offset:31744
    s_add_u32 m0, s67, 0
    s_add_u32 s71, s65, s68
    buffer_load_dwordx4 v254, s[44:47], s71 offen lds
    v_mfma_f32_16x16x32_bf16 v[20:23], v[88:91], v[48:51], v[20:23]
    v_mfma_f32_16x16x32_bf16 v[44:47], v[88:91], v[52:55], v[44:47]
    ds_read_b128 v[176:179], v115 offset:32768
    buffer_load_dwordx4 v253, s[44:47], s71 offen offset:1024 lds
    s_waitcnt lgkmcnt(0)
    s_waitcnt vmcnt(5)
    s_barrier
    s_setprio 3
    v_mfma_f32_16x16x32_bf16 v[0:3], v[92:95], v[56:59], v[0:3]
    v_mfma_f32_16x16x32_bf16 v[24:27], v[92:95], v[60:63], v[24:27]
    s_setprio 0
    ds_read_b128 v[64:67], v116 offset:4096
    ds_read_b128 v[80:83], v114 offset:0
    v_mfma_f32_16x16x32_bf16 v[4:7], v[96:99], v[56:59], v[4:7]
    v_mfma_f32_16x16x32_bf16 v[28:31], v[96:99], v[60:63], v[28:31]
    ds_read_b128 v[68:71], v116 offset:6144
    ds_read_b128 v[84:87], v114 offset:1024
    s_add_u32 m0, s67, 2048
    s_add_u32 s68, s68, 128
    s_cmp_eq_u32 s68, 1280
    s_cselect_b32 s68, 0, s68
    buffer_load_dwordx4 v254, s[48:51], s71 offen lds
    v_mfma_f32_16x16x32_bf16 v[8:11], v[100:103], v[56:59], v[8:11]
    v_mfma_f32_16x16x32_bf16 v[32:35], v[100:103], v[60:63], v[32:35]
    ds_read_b128 v[88:91], v114 offset:2048
    buffer_load_dwordx4 v253, s[48:51], s71 offen offset:1024 lds
    s_waitcnt lgkmcnt(5)
    s_setprio 3
    v_mfma_f32_16x16x32_bf16 v[12:15], v[168:171], v[56:59], v[12:15]
    v_mfma_f32_16x16x32_bf16 v[36:39], v[168:171], v[60:63], v[36:39]
    s_setprio 0
    ds_read_b128 v[72:75], v117 offset:4096
    ds_read_b128 v[92:95], v114 offset:6144
    s_add_u32 m0, s66, 24576
    s_add_u32 s70, s64, s100
    buffer_load_dwordx4 v112, s[40:43], s70 offen lds
    v_mfma_f32_16x16x32_bf16 v[16:19], v[172:175], v[56:59], v[16:19]
    v_mfma_f32_16x16x32_bf16 v[40:43], v[172:175], v[60:63], v[40:43]
    ds_read_b128 v[76:79], v117 offset:6144
    ds_read_b128 v[96:99], v114 offset:7168
    s_add_u32 s70, s70, 1536
    buffer_load_dwordx4 v112, s[40:43], s70 offen offset:1024 lds
    v_mfma_f32_16x16x32_bf16 v[20:23], v[176:179], v[56:59], v[20:23]
    v_mfma_f32_16x16x32_bf16 v[44:47], v[176:179], v[60:63], v[44:47]
    ds_read_b128 v[100:103], v114 offset:8192
    s_add_u32 s70, s70, 1536
    buffer_load_dwordx4 v112, s[40:43], s70 offen offset:2048 lds
    s_add_u32 s100, s100, 128
    s_cmp_eq_u32 s100, 1280
    s_cselect_b32 s100, 0, s100
    s_waitcnt lgkmcnt(5)
    s_setprio 3
    v_mfma_f32_16x16x32_bf16 v[0:3], v[80:83], v[64:67], v[0:3]
    v_mfma_f32_16x16x32_bf16 v[24:27], v[80:83], v[68:71], v[24:27]
    s_setprio 0
    ds_read_b128 v[168:171], v115 offset:0
    v_mfma_f32_16x16x32_bf16 v[4:7], v[84:87], v[64:67], v[4:7]
    v_mfma_f32_16x16x32_bf16 v[28:31], v[84:87], v[68:71], v[28:31]
    ds_read_b128 v[172:175], v115 offset:1024
    v_mfma_f32_16x16x32_bf16 v[8:11], v[88:91], v[64:67], v[8:11]
    v_mfma_f32_16x16x32_bf16 v[32:35], v[88:91], v[68:71], v[32:35]
    ds_read_b128 v[176:179], v115 offset:2048
    s_waitcnt lgkmcnt(3)
    s_setprio 3
    v_mfma_f32_16x16x32_bf16 v[12:15], v[92:95], v[64:67], v[12:15]
    v_mfma_f32_16x16x32_bf16 v[36:39], v[92:95], v[68:71], v[36:39]
    s_setprio 0
    ds_read_b128 v[80:83], v115 offset:6144
    v_mfma_f32_16x16x32_bf16 v[16:19], v[96:99], v[64:67], v[16:19]
    v_mfma_f32_16x16x32_bf16 v[40:43], v[96:99], v[68:71], v[40:43]
    ds_read_b128 v[84:87], v115 offset:7168
    s_add_u32 m0, s67, 4096
    s_add_u32 s71, s65, s68
    buffer_load_dwordx4 v254, s[44:47], s71 offen lds
    v_mfma_f32_16x16x32_bf16 v[20:23], v[100:103], v[64:67], v[20:23]
    v_mfma_f32_16x16x32_bf16 v[44:47], v[100:103], v[68:71], v[44:47]
    ds_read_b128 v[88:91], v115 offset:8192
    buffer_load_dwordx4 v253, s[44:47], s71 offen offset:1024 lds
    s_waitcnt lgkmcnt(0)
    s_waitcnt vmcnt(5)
    s_barrier
    s_setprio 3
    v_mfma_f32_16x16x32_bf16 v[0:3], v[168:171], v[72:75], v[0:3]
    v_mfma_f32_16x16x32_bf16 v[24:27], v[168:171], v[76:79], v[24:27]
    s_setprio 0
    ds_read_b128 v[48:51], v116 offset:0
    ds_read_b128 v[92:95], v114 offset:12288
    v_mfma_f32_16x16x32_bf16 v[4:7], v[172:175], v[72:75], v[4:7]
    v_mfma_f32_16x16x32_bf16 v[28:31], v[172:175], v[76:79], v[28:31]
    ds_read_b128 v[52:55], v116 offset:2048
    ds_read_b128 v[96:99], v114 offset:13312
    s_add_u32 m0, s67, 6144
    s_add_u32 s68, s68, 128
    s_cmp_eq_u32 s68, 1280
    s_cselect_b32 s68, 0, s68
    buffer_load_dwordx4 v254, s[48:51], s71 offen lds
    v_mfma_f32_16x16x32_bf16 v[8:11], v[176:179], v[72:75], v[8:11]
    v_mfma_f32_16x16x32_bf16 v[32:35], v[176:179], v[76:79], v[32:35]
    ds_read_b128 v[100:103], v114 offset:14336
    buffer_load_dwordx4 v253, s[48:51], s71 offen offset:1024 lds
    s_waitcnt lgkmcnt(5)
    s_setprio 3
    v_mfma_f32_16x16x32_bf16 v[12:15], v[80:83], v[72:75], v[12:15]
    v_mfma_f32_16x16x32_bf16 v[36:39], v[80:83], v[76:79], v[36:39]
    s_setprio 0
    ds_read_b128 v[56:59], v117 offset:0
    ds_read_b128 v[168:171], v114 offset:18432
    s_add_u32 m0, s66, 0
    s_add_u32 s70, s64, s100
    buffer_load_dwordx4 v112, s[40:43], s70 offen lds
    v_mfma_f32_16x16x32_bf16 v[16:19], v[84:87], v[72:75], v[16:19]
    v_mfma_f32_16x16x32_bf16 v[40:43], v[84:87], v[76:79], v[40:43]
    ds_read_b128 v[60:63], v117 offset:2048
    ds_read_b128 v[172:175], v114 offset:19456
    s_add_u32 s70, s70, 1536
    buffer_load_dwordx4 v112, s[40:43], s70 offen offset:1024 lds
    v_mfma_f32_16x16x32_bf16 v[20:23], v[88:91], v[72:75], v[20:23]
    v_mfma_f32_16x16x32_bf16 v[44:47], v[88:91], v[76:79], v[44:47]
    ds_read_b128 v[176:179], v114 offset:20480
    s_add_u32 s70, s70, 1536
    buffer_load_dwordx4 v112, s[40:43], s70 offen offset:2048 lds
    s_add_u32 s100, s100, 128
    s_cmp_eq_u32 s100, 1280
    s_cselect_b32 s100, 0, s100
    s_waitcnt lgkmcnt(5)
    s_setprio 3
    v_mfma_f32_16x16x32_bf16 v[0:3], v[92:95], v[48:51], v[0:3]
    v_mfma_f32_16x16x32_bf16 v[24:27], v[92:95], v[52:55], v[24:27]
    s_setprio 0
    ds_read_b128 v[80:83], v115 offset:12288
    v_mfma_f32_16x16x32_bf16 v[4:7], v[96:99], v[48:51], v[4:7]
    v_mfma_f32_16x16x32_bf16 v[28:31], v[96:99], v[52:55], v[28:31]
    ds_read_b128 v[84:87], v115 offset:13312
    v_mfma_f32_16x16x32_bf16 v[8:11], v[100:103], v[48:51], v[8:11]
    v_mfma_f32_16x16x32_bf16 v[32:35], v[100:103], v[52:55], v[32:35]
    ds_read_b128 v[88:91], v115 offset:14336
    s_waitcnt lgkmcnt(3)
    s_setprio 3
    v_mfma_f32_16x16x32_bf16 v[12:15], v[168:171], v[48:51], v[12:15]
    v_mfma_f32_16x16x32_bf16 v[36:39], v[168:171], v[52:55], v[36:39]
    s_setprio 0
    ds_read_b128 v[92:95], v115 offset:18432
    v_mfma_f32_16x16x32_bf16 v[16:19], v[172:175], v[48:51], v[16:19]
    v_mfma_f32_16x16x32_bf16 v[40:43], v[172:175], v[52:55], v[40:43]
    ds_read_b128 v[96:99], v115 offset:19456
    s_add_u32 m0, s67, 0
    s_add_u32 s71, s65, s68
    buffer_load_dwordx4 v254, s[44:47], s71 offen lds
    v_mfma_f32_16x16x32_bf16 v[20:23], v[176:179], v[48:51], v[20:23]
    v_mfma_f32_16x16x32_bf16 v[44:47], v[176:179], v[52:55], v[44:47]
    ds_read_b128 v[100:103], v115 offset:20480
    buffer_load_dwordx4 v253, s[44:47], s71 offen offset:1024 lds
    s_waitcnt lgkmcnt(0)
    s_waitcnt vmcnt(5)
    s_barrier
    s_setprio 3
    v_mfma_f32_16x16x32_bf16 v[0:3], v[80:83], v[56:59], v[0:3]
    v_mfma_f32_16x16x32_bf16 v[24:27], v[80:83], v[60:63], v[24:27]
    s_setprio 0
    ds_read_b128 v[64:67], v116 offset:4096
    ds_read_b128 v[168:171], v114 offset:24576
    v_mfma_f32_16x16x32_bf16 v[4:7], v[84:87], v[56:59], v[4:7]
    v_mfma_f32_16x16x32_bf16 v[28:31], v[84:87], v[60:63], v[28:31]
    ds_read_b128 v[68:71], v116 offset:6144
    ds_read_b128 v[172:175], v114 offset:25600
    s_add_u32 m0, s67, 2048
    s_add_u32 s68, s68, 128
    s_cmp_eq_u32 s68, 1280
    s_cselect_b32 s68, 0, s68
    buffer_load_dwordx4 v254, s[48:51], s71 offen lds
    v_mfma_f32_16x16x32_bf16 v[8:11], v[88:91], v[56:59], v[8:11]
    v_mfma_f32_16x16x32_bf16 v[32:35], v[88:91], v[60:63], v[32:35]
    ds_read_b128 v[176:179], v114 offset:26624
    buffer_load_dwordx4 v253, s[48:51], s71 offen offset:1024 lds
    s_waitcnt lgkmcnt(5)
    s_setprio 3
    v_mfma_f32_16x16x32_bf16 v[12:15], v[92:95], v[56:59], v[12:15]
    v_mfma_f32_16x16x32_bf16 v[36:39], v[92:95], v[60:63], v[36:39]
    s_setprio 0
    ds_read_b128 v[72:75], v117 offset:4096
    ds_read_b128 v[80:83], v114 offset:30720
    s_add_u32 m0, s66, 12288
    s_add_u32 s70, s64, s100
    buffer_load_dwordx4 v112, s[40:43], s70 offen lds
    v_mfma_f32_16x16x32_bf16 v[16:19], v[96:99], v[56:59], v[16:19]
    v_mfma_f32_16x16x32_bf16 v[40:43], v[96:99], v[60:63], v[40:43]
    ds_read_b128 v[76:79], v117 offset:6144
    ds_read_b128 v[84:87], v114 offset:31744
    s_add_u32 s70, s70, 1536
    buffer_load_dwordx4 v112, s[40:43], s70 offen offset:1024 lds
    v_mfma_f32_16x16x32_bf16 v[20:23], v[100:103], v[56:59], v[20:23]
    v_mfma_f32_16x16x32_bf16 v[44:47], v[100:103], v[60:63], v[44:47]
    ds_read_b128 v[88:91], v114 offset:32768
    s_add_u32 s70, s70, 1536
    buffer_load_dwordx4 v112, s[40:43], s70 offen offset:2048 lds
    s_add_u32 s100, s100, 128
    s_cmp_eq_u32 s100, 1280
    s_cselect_b32 s100, 0, s100
    s_waitcnt lgkmcnt(5)
    s_setprio 3
    v_mfma_f32_16x16x32_bf16 v[0:3], v[168:171], v[64:67], v[0:3]
    v_mfma_f32_16x16x32_bf16 v[24:27], v[168:171], v[68:71], v[24:27]
    s_setprio 0
    ds_read_b128 v[92:95], v115 offset:24576
    v_mfma_f32_16x16x32_bf16 v[4:7], v[172:175], v[64:67], v[4:7]
    v_mfma_f32_16x16x32_bf16 v[28:31], v[172:175], v[68:71], v[28:31]
    ds_read_b128 v[96:99], v115 offset:25600
    v_mfma_f32_16x16x32_bf16 v[8:11], v[176:179], v[64:67], v[8:11]
    v_mfma_f32_16x16x32_bf16 v[32:35], v[176:179], v[68:71], v[32:35]
    ds_read_b128 v[100:103], v115 offset:26624
    s_waitcnt lgkmcnt(3)
    s_setprio 3
    v_mfma_f32_16x16x32_bf16 v[12:15], v[80:83], v[64:67], v[12:15]
    v_mfma_f32_16x16x32_bf16 v[36:39], v[80:83], v[68:71], v[36:39]
    s_setprio 0
    ds_read_b128 v[168:171], v115 offset:30720
    v_mfma_f32_16x16x32_bf16 v[16:19], v[84:87], v[64:67], v[16:19]
    v_mfma_f32_16x16x32_bf16 v[40:43], v[84:87], v[68:71], v[40:43]
    ds_read_b128 v[172:175], v115 offset:31744
    s_add_u32 m0, s67, 4096
    s_add_u32 s71, s65, s68
    buffer_load_dwordx4 v254, s[44:47], s71 offen lds
    v_mfma_f32_16x16x32_bf16 v[20:23], v[88:91], v[64:67], v[20:23]
    v_mfma_f32_16x16x32_bf16 v[44:47], v[88:91], v[68:71], v[44:47]
    ds_read_b128 v[176:179], v115 offset:32768
    buffer_load_dwordx4 v253, s[44:47], s71 offen offset:1024 lds
    s_waitcnt lgkmcnt(0)
    s_waitcnt vmcnt(5)
    s_barrier
    s_setprio 3
    v_mfma_f32_16x16x32_bf16 v[0:3], v[92:95], v[72:75], v[0:3]
    v_mfma_f32_16x16x32_bf16 v[24:27], v[92:95], v[76:79], v[24:27]
    s_setprio 0
    ds_read_b128 v[48:51], v116 offset:0
    ds_read_b128 v[80:83], v114 offset:0
    v_mfma_f32_16x16x32_bf16 v[4:7], v[96:99], v[72:75], v[4:7]
    v_mfma_f32_16x16x32_bf16 v[28:31], v[96:99], v[76:79], v[28:31]
    ds_read_b128 v[52:55], v116 offset:2048
    ds_read_b128 v[84:87], v114 offset:1024
    s_add_u32 m0, s67, 6144
    s_add_u32 s68, s68, 128
    s_cmp_eq_u32 s68, 1280
    s_cselect_b32 s68, 0, s68
    buffer_load_dwordx4 v254, s[48:51], s71 offen lds
    v_mfma_f32_16x16x32_bf16 v[8:11], v[100:103], v[72:75], v[8:11]
    v_mfma_f32_16x16x32_bf16 v[32:35], v[100:103], v[76:79], v[32:35]
    ds_read_b128 v[88:91], v114 offset:2048
    buffer_load_dwordx4 v253, s[48:51], s71 offen offset:1024 lds
    s_waitcnt lgkmcnt(5)
    s_setprio 3
    v_mfma_f32_16x16x32_bf16 v[12:15], v[168:171], v[72:75], v[12:15]
    v_mfma_f32_16x16x32_bf16 v[36:39], v[168:171], v[76:79], v[36:39]
    s_setprio 0
    ds_read_b128 v[56:59], v117 offset:0
    ds_read_b128 v[92:95], v114 offset:6144
    s_add_u32 m0, s66, 24576
    s_add_u32 s70, s64, s100
    buffer_load_dwordx4 v112, s[40:43], s70 offen lds
    v_mfma_f32_16x16x32_bf16 v[16:19], v[172:175], v[72:75], v[16:19]
    v_mfma_f32_16x16x32_bf16 v[40:43], v[172:175], v[76:79], v[40:43]
    ds_read_b128 v[60:63], v117 offset:2048
    ds_read_b128 v[96:99], v114 offset:7168
    s_add_u32 s70, s70, 1536
    buffer_load_dwordx4 v112, s[40:43], s70 offen offset:1024 lds
    v_mfma_f32_16x16x32_bf16 v[20:23], v[176:179], v[72:75], v[20:23]
    v_mfma_f32_16x16x32_bf16 v[44:47], v[176:179], v[76:79], v[44:47]
    ds_read_b128 v[100:103], v114 offset:8192
    s_add_u32 s70, s70, 1536
    buffer_load_dwordx4 v112, s[40:43], s70 offen offset:2048 lds
    s_add_u32 s100, s100, 128
    s_cmp_eq_u32 s100, 1280
    s_cselect_b32 s100, 0, s100
    s_waitcnt lgkmcnt(5)
    s_setprio 3
    v_mfma_f32_16x16x32_bf16 v[0:3], v[80:83], v[48:51], v[0:3]
    v_mfma_f32_16x16x32_bf16 v[24:27], v[80:83], v[52:55], v[24:27]
    s_setprio 0
    ds_read_b128 v[168:171], v115 offset:0
    v_mfma_f32_16x16x32_bf16 v[4:7], v[84:87], v[48:51], v[4:7]
    v_mfma_f32_16x16x32_bf16 v[28:31], v[84:87], v[52:55], v[28:31]
    ds_read_b128 v[172:175], v115 offset:1024
    v_mfma_f32_16x16x32_bf16 v[8:11], v[88:91], v[48:51], v[8:11]
    v_mfma_f32_16x16x32_bf16 v[32:35], v[88:91], v[52:55], v[32:35]
    ds_read_b128 v[176:179], v115 offset:2048
    s_waitcnt lgkmcnt(3)
    s_setprio 3
    v_mfma_f32_16x16x32_bf16 v[12:15], v[92:95], v[48:51], v[12:15]
    v_mfma_f32_16x16x32_bf16 v[36:39], v[92:95], v[52:55], v[36:39]
    s_setprio 0
    ds_read_b128 v[80:83], v115 offset:6144
    v_mfma_f32_16x16x32_bf16 v[16:19], v[96:99], v[48:51], v[16:19]
    v_mfma_f32_16x16x32_bf16 v[40:43], v[96:99], v[52:55], v[40:43]
    ds_read_b128 v[84:87], v115 offset:7168
    s_add_u32 m0, s67, 0
    s_add_u32 s71, s65, s68
    buffer_load_dwordx4 v254, s[44:47], s71 offen lds
    v_mfma_f32_16x16x32_bf16 v[20:23], v[100:103], v[48:51], v[20:23]
    v_mfma_f32_16x16x32_bf16 v[44:47], v[100:103], v[52:55], v[44:47]
    ds_read_b128 v[88:91], v115 offset:8192
    buffer_load_dwordx4 v253, s[44:47], s71 offen offset:1024 lds
    s_waitcnt lgkmcnt(0)
    s_waitcnt vmcnt(5)
    s_barrier
    s_setprio 3
    v_mfma_f32_16x16x32_bf16 v[0:3], v[168:171], v[56:59], v[0:3]
    v_mfma_f32_16x16x32_bf16 v[24:27], v[168:171], v[60:63], v[24:27]
    s_setprio 0
    ds_read_b128 v[64:67], v116 offset:4096
    ds_read_b128 v[92:95], v114 offset:12288
    v_mfma_f32_16x16x32_bf16 v[4:7], v[172:175], v[56:59], v[4:7]
    v_mfma_f32_16x16x32_bf16 v[28:31], v[172:175], v[60:63], v[28:31]
    ds_read_b128 v[68:71], v116 offset:6144
    ds_read_b128 v[96:99], v114 offset:13312
    s_add_u32 m0, s67, 2048
    s_add_u32 s68, s68, 128
    s_cmp_eq_u32 s68, 1280
    s_cselect_b32 s68, 0, s68
    buffer_load_dwordx4 v254, s[48:51], s71 offen lds
    v_mfma_f32_16x16x32_bf16 v[8:11], v[176:179], v[56:59], v[8:11]
    v_mfma_f32_16x16x32_bf16 v[32:35], v[176:179], v[60:63], v[32:35]
    ds_read_b128 v[100:103], v114 offset:14336
    buffer_load_dwordx4 v253, s[48:51], s71 offen offset:1024 lds
    s_waitcnt lgkmcnt(5)
    s_setprio 3
    v_mfma_f32_16x16x32_bf16 v[12:15], v[80:83], v[56:59], v[12:15]
    v_mfma_f32_16x16x32_bf16 v[36:39], v[80:83], v[60:63], v[36:39]
    s_setprio 0
    ds_read_b128 v[72:75], v117 offset:4096
    ds_read_b128 v[168:171], v114 offset:18432
    s_add_u32 m0, s66, 0
    s_add_u32 s70, s64, s100
    buffer_load_dwordx4 v112, s[40:43], s70 offen lds
    v_mfma_f32_16x16x32_bf16 v[16:19], v[84:87], v[56:59], v[16:19]
    v_mfma_f32_16x16x32_bf16 v[40:43], v[84:87], v[60:63], v[40:43]
    ds_read_b128 v[76:79], v117 offset:6144
    ds_read_b128 v[172:175], v114 offset:19456
    s_add_u32 s70, s70, 1536
    buffer_load_dwordx4 v112, s[40:43], s70 offen offset:1024 lds
    v_mfma_f32_16x16x32_bf16 v[20:23], v[88:91], v[56:59], v[20:23]
    v_mfma_f32_16x16x32_bf16 v[44:47], v[88:91], v[60:63], v[44:47]
    ds_read_b128 v[176:179], v114 offset:20480
    s_add_u32 s70, s70, 1536
    buffer_load_dwordx4 v112, s[40:43], s70 offen offset:2048 lds
    s_add_u32 s100, s100, 128
    s_cmp_eq_u32 s100, 1280
    s_cselect_b32 s100, 0, s100
    s_waitcnt lgkmcnt(5)
    s_setprio 3
    v_mfma_f32_16x16x32_bf16 v[0:3], v[92:95], v[64:67], v[0:3]
    v_mfma_f32_16x16x32_bf16 v[24:27], v[92:95], v[68:71], v[24:27]
    s_setprio 0
    ds_read_b128 v[80:83], v115 offset:12288
    v_mfma_f32_16x16x32_bf16 v[4:7], v[96:99], v[64:67], v[4:7]
    v_mfma_f32_16x16x32_bf16 v[28:31], v[96:99], v[68:71], v[28:31]
    ds_read_b128 v[84:87], v115 offset:13312
    v_mfma_f32_16x16x32_bf16 v[8:11], v[100:103], v[64:67], v[8:11]
    v_mfma_f32_16x16x32_bf16 v[32:35], v[100:103], v[68:71], v[32:35]
    ds_read_b128 v[88:91], v115 offset:14336
    s_waitcnt lgkmcnt(3)
    s_setprio 3
    v_mfma_f32_16x16x32_bf16 v[12:15], v[168:171], v[64:67], v[12:15]
    v_mfma_f32_16x16x32_bf16 v[36:39], v[168:171], v[68:71], v[36:39]
    s_setprio 0
    ds_read_b128 v[92:95], v115 offset:18432
    v_mfma_f32_16x16x32_bf16 v[16:19], v[172:175], v[64:67], v[16:19]
    v_mfma_f32_16x16x32_bf16 v[40:43], v[172:175], v[68:71], v[40:43]
    ds_read_b128 v[96:99], v115 offset:19456
    s_add_u32 m0, s67, 4096
    s_add_u32 s71, s65, s68
    buffer_load_dwordx4 v254, s[44:47], s71 offen lds
    v_mfma_f32_16x16x32_bf16 v[20:23], v[176:179], v[64:67], v[20:23]
    v_mfma_f32_16x16x32_bf16 v[44:47], v[176:179], v[68:71], v[44:47]
    ds_read_b128 v[100:103], v115 offset:20480
    buffer_load_dwordx4 v253, s[44:47], s71 offen offset:1024 lds
    s_waitcnt lgkmcnt(0)
    s_waitcnt vmcnt(5)
    s_barrier
    s_setprio 3
    v_mfma_f32_16x16x32_bf16 v[0:3], v[80:83], v[72:75], v[0:3]
    v_mfma_f32_16x16x32_bf16 v[24:27], v[80:83], v[76:79], v[24:27]
    s_setprio 0
    ds_read_b128 v[48:51], v116 offset:0
    ds_read_b128 v[168:171], v114 offset:24576
    v_mfma_f32_16x16x32_bf16 v[4:7], v[84:87], v[72:75], v[4:7]
    v_mfma_f32_16x16x32_bf16 v[28:31], v[84:87], v[76:79], v[28:31]
    ds_read_b128 v[52:55], v116 offset:2048
    ds_read_b128 v[172:175], v114 offset:25600
    s_add_u32 m0, s67, 6144
    s_add_u32 s68, s68, 128
    s_cmp_eq_u32 s68, 1280
    s_cselect_b32 s68, 0, s68
    buffer_load_dwordx4 v254, s[48:51], s71 offen lds
    v_mfma_f32_16x16x32_bf16 v[8:11], v[88:91], v[72:75], v[8:11]
    v_mfma_f32_16x16x32_bf16 v[32:35], v[88:91], v[76:79], v[32:35]
    ds_read_b128 v[176:179], v114 offset:26624
    buffer_load_dwordx4 v253, s[48:51], s71 offen offset:1024 lds
    s_waitcnt lgkmcnt(5)
    s_setprio 3
    v_mfma_f32_16x16x32_bf16 v[12:15], v[92:95], v[72:75], v[12:15]
    v_mfma_f32_16x16x32_bf16 v[36:39], v[92:95], v[76:79], v[36:39]
    s_setprio 0
    ds_read_b128 v[56:59], v117 offset:0
    ds_read_b128 v[80:83], v114 offset:30720
    v_mfma_f32_16x16x32_bf16 v[16:19], v[96:99], v[72:75], v[16:19]
    v_mfma_f32_16x16x32_bf16 v[40:43], v[96:99], v[76:79], v[40:43]
    ds_read_b128 v[60:63], v117 offset:2048
    ds_read_b128 v[84:87], v114 offset:31744
    v_mfma_f32_16x16x32_bf16 v[20:23], v[100:103], v[72:75], v[20:23]
    v_mfma_f32_16x16x32_bf16 v[44:47], v[100:103], v[76:79], v[44:47]
    ds_read_b128 v[88:91], v114 offset:32768
    s_waitcnt lgkmcnt(5)
    s_setprio 3
    v_mfma_f32_16x16x32_bf16 v[0:3], v[168:171], v[48:51], v[0:3]
    v_mfma_f32_16x16x32_bf16 v[24:27], v[168:171], v[52:55], v[24:27]
    s_setprio 0
    ds_read_b128 v[92:95], v115 offset:24576
    v_mfma_f32_16x16x32_bf16 v[4:7], v[172:175], v[48:51], v[4:7]
    v_mfma_f32_16x16x32_bf16 v[28:31], v[172:175], v[52:55], v[28:31]
    ds_read_b128 v[96:99], v115 offset:25600
    v_mfma_f32_16x16x32_bf16 v[8:11], v[176:179], v[48:51], v[8:11]
    v_mfma_f32_16x16x32_bf16 v[32:35], v[176:179], v[52:55], v[32:35]
    ds_read_b128 v[100:103], v115 offset:26624
    s_waitcnt lgkmcnt(3)
    s_setprio 3
    v_mfma_f32_16x16x32_bf16 v[12:15], v[80:83], v[48:51], v[12:15]
    v_mfma_f32_16x16x32_bf16 v[36:39], v[80:83], v[52:55], v[36:39]
    s_setprio 0
    ds_read_b128 v[168:171], v115 offset:30720
    v_mfma_f32_16x16x32_bf16 v[16:19], v[84:87], v[48:51], v[16:19]
    v_mfma_f32_16x16x32_bf16 v[40:43], v[84:87], v[52:55], v[40:43]
    ds_read_b128 v[172:175], v115 offset:31744
    v_mfma_f32_16x16x32_bf16 v[20:23], v[88:91], v[48:51], v[20:23]
    v_mfma_f32_16x16x32_bf16 v[44:47], v[88:91], v[52:55], v[44:47]
    ds_read_b128 v[176:179], v115 offset:32768
    s_waitcnt lgkmcnt(0)
    s_waitcnt vmcnt(0)
    s_barrier
    s_setprio 3
    v_mfma_f32_16x16x32_bf16 v[0:3], v[92:95], v[56:59], v[0:3]
    v_mfma_f32_16x16x32_bf16 v[24:27], v[92:95], v[60:63], v[24:27]
    s_setprio 0
    ds_read_b128 v[64:67], v116 offset:4096
    ds_read_b128 v[80:83], v114 offset:0
    v_mfma_f32_16x16x32_bf16 v[4:7], v[96:99], v[56:59], v[4:7]
    v_mfma_f32_16x16x32_bf16 v[28:31], v[96:99], v[60:63], v[28:31]
    ds_read_b128 v[68:71], v116 offset:6144
    ds_read_b128 v[84:87], v114 offset:1024
    v_mfma_f32_16x16x32_bf16 v[8:11], v[100:103], v[56:59], v[8:11]
    v_mfma_f32_16x16x32_bf16 v[32:35], v[100:103], v[60:63], v[32:35]
    ds_read_b128 v[88:91], v114 offset:2048
    s_waitcnt lgkmcnt(5)
    s_setprio 3
    v_mfma_f32_16x16x32_bf16 v[12:15], v[168:171], v[56:59], v[12:15]
    v_mfma_f32_16x16x32_bf16 v[36:39], v[168:171], v[60:63], v[36:39]
    s_setprio 0
    ds_read_b128 v[72:75], v117 offset:4096
    ds_read_b128 v[92:95], v114 offset:6144
    v_mfma_f32_16x16x32_bf16 v[16:19], v[172:175], v[56:59], v[16:19]
    v_mfma_f32_16x16x32_bf16 v[40:43], v[172:175], v[60:63], v[40:43]
    ds_read_b128 v[76:79], v117 offset:6144
    ds_read_b128 v[96:99], v114 offset:7168
    v_mfma_f32_16x16x32_bf16 v[20:23], v[176:179], v[56:59], v[20:23]
    v_mfma_f32_16x16x32_bf16 v[44:47], v[176:179], v[60:63], v[44:47]
    ds_read_b128 v[100:103], v114 offset:8192
    s_waitcnt lgkmcnt(5)
    s_setprio 3
    v_mfma_f32_16x16x32_bf16 v[0:3], v[80:83], v[64:67], v[0:3]
    v_mfma_f32_16x16x32_bf16 v[24:27], v[80:83], v[68:71], v[24:27]
    s_setprio 0
    ds_read_b128 v[168:171], v115 offset:0
    v_mfma_f32_16x16x32_bf16 v[4:7], v[84:87], v[64:67], v[4:7]
    v_mfma_f32_16x16x32_bf16 v[28:31], v[84:87], v[68:71], v[28:31]
    ds_read_b128 v[172:175], v115 offset:1024
    v_mfma_f32_16x16x32_bf16 v[8:11], v[88:91], v[64:67], v[8:11]
    v_mfma_f32_16x16x32_bf16 v[32:35], v[88:91], v[68:71], v[32:35]
    ds_read_b128 v[176:179], v115 offset:2048
    buffer_load_dword v120, v119, s[56:59], 0 offen offset:128 sc1
    s_waitcnt lgkmcnt(3)
    s_setprio 3
    v_mfma_f32_16x16x32_bf16 v[12:15], v[92:95], v[64:67], v[12:15]
    v_mfma_f32_16x16x32_bf16 v[36:39], v[92:95], v[68:71], v[36:39]
    s_setprio 0
    ds_read_b128 v[80:83], v115 offset:6144
    v_mfma_f32_16x16x32_bf16 v[16:19], v[96:99], v[64:67], v[16:19]
    v_mfma_f32_16x16x32_bf16 v[40:43], v[96:99], v[68:71], v[40:43]
    ds_read_b128 v[84:87], v115 offset:7168
    v_mfma_f32_16x16x32_bf16 v[20:23], v[100:103], v[64:67], v[20:23]
    v_mfma_f32_16x16x32_bf16 v[44:47], v[100:103], v[68:71], v[44:47]
    ds_read_b128 v[88:91], v115 offset:8192
    s_waitcnt lgkmcnt(0)
    s_setprio 3
    v_mfma_f32_16x16x32_bf16 v[0:3], v[168:171], v[72:75], v[0:3]
    v_mfma_f32_16x16x32_bf16 v[24:27], v[168:171], v[76:79], v[24:27]
    s_setprio 0
    v_mfma_f32_16x16x32_bf16 v[4:7], v[172:175], v[72:75], v[4:7]
    v_mfma_f32_16x16x32_bf16 v[28:31], v[172:175], v[76:79], v[28:31]
    v_mfma_f32_16x16x32_bf16 v[8:11], v[176:179], v[72:75], v[8:11]
    v_mfma_f32_16x16x32_bf16 v[32:35], v[176:179], v[76:79], v[32:35]
    s_waitcnt lgkmcnt(0)
    s_setprio 3
    v_mfma_f32_16x16x32_bf16 v[12:15], v[80:83], v[72:75], v[12:15]
    v_mfma_f32_16x16x32_bf16 v[36:39], v[80:83], v[76:79], v[36:39]
    s_setprio 0
    v_mfma_f32_16x16x32_bf16 v[16:19], v[84:87], v[72:75], v[16:19]
    v_mfma_f32_16x16x32_bf16 v[40:43], v[84:87], v[76:79], v[40:43]
    v_mfma_f32_16x16x32_bf16 v[20:23], v[88:91], v[72:75], v[20:23]
    v_mfma_f32_16x16x32_bf16 v[44:47], v[88:91], v[76:79], v[44:47]
    s_barrier
    s_lshr_b32 s62, s61, 3
    s_lshl_b32 s70, s60, 2
    s_add_u32 s62, s62, s70
    s_and_b32 s63, s61, 7
    s_cmp_lt_u32 s38, 2
    s_cselect_b32 s40, s24, s26
    s_cselect_b32 s41, s25, s27
    s_mov_b32 s42, 819200
    s_mov_b32 s43, 0x20000
    s_lshl_b32 s64, s63, 1
    s_and_b32 s70, s38, 1
    s_add_u32 s64, s64, s70
    s_mul_i32 s64, s64, 51200
    s_mul_i32 s65, s38, 5120
    s_mul_i32 s66, s63, 5
    s_lshr_b32 s66, s66, 2
    s_lshr_b32 s70, s61, 3
    s_mul_i32 s70, s70, 5
    s_lshr_b32 s70, s70, 1
    s_add_u32 s66, s66, s70
    s_cmp_ge_u32 s66, 10
    s_cselect_b32 s70, 10, 0
    s_sub_u32 s66, s66, s70
    s_lshl_b32 s67, s66, 12
    s_lshl_b32 s66, s66, 7
    s_setprio 3
    v_pk_fma_f32 v[104:105], v[0:1], v[180:181], v[2:3]
    v_pk_fma_f32 v[76:77], v[12:13], v[180:181], v[14:15]
    v_pk_fma_f32 v[106:107], v[24:25], v[180:181], v[26:27]
    v_pk_fma_f32 v[78:79], v[36:37], v[180:181], v[38:39]
    v_pk_fma_f32 v[104:105], v[24:25], v[182:183], v[104:105] neg_lo:[0,1,0] neg_hi:[0,1,0]
    v_pk_fma_f32 v[76:77], v[36:37], v[182:183], v[76:77] neg_lo:[0,1,0] neg_hi:[0,1,0]
    v_pk_fma_f32 v[106:107], v[0:1], v[182:183], v[106:107]
    v_pk_fma_f32 v[78:79], v[12:13], v[182:183], v[78:79]
    v_pk_fma_f32 v[48:49], v[104:105], v[180:181], v[4:5]
    v_pk_fma_f32 v[72:73], v[76:77], v[180:181], v[16:17]
    v_pk_fma_f32 v[50:51], v[106:107], v[180:181], v[28:29]
    v_pk_fma_f32 v[74:75], v[78:79], v[180:181], v[40:41]
    v_pk_fma_f32 v[48:49], v[106:107], v[182:183], v[48:49] neg_lo:[0,1,0] neg_hi:[0,1,0]
    v_pk_fma_f32 v[72:73], v[78:79], v[182:183], v[72:73] neg_lo:[0,1,0] neg_hi:[0,1,0]
    v_pk_fma_f32 v[50:51], v[104:105], v[182:183], v[50:51]
    v_pk_fma_f32 v[74:75], v[76:77], v[182:183], v[74:75]
    v_pk_fma_f32 v[104:105], v[48:49], v[180:181], v[6:7]
    v_pk_fma_f32 v[76:77], v[72:73], v[180:181], v[18:19]
    v_pk_fma_f32 v[106:107], v[50:51], v[180:181], v[30:31]
    v_pk_fma_f32 v[78:79], v[74:75], v[180:181], v[42:43]
    v_pk_fma_f32 v[104:105], v[50:51], v[182:183], v[104:105] neg_lo:[0,1,0] neg_hi:[0,1,0]
    v_pk_fma_f32 v[76:77], v[74:75], v[182:183], v[76:77] neg_lo:[0,1,0] neg_hi:[0,1,0]
    v_pk_fma_f32 v[106:107], v[48:49], v[182:183], v[106:107]
    v_pk_fma_f32 v[78:79], v[72:73], v[182:183], v[78:79]
    v_pk_fma_f32 v[48:49], v[104:105], v[180:181], v[8:9]
    v_pk_fma_f32 v[72:73], v[76:77], v[180:181], v[20:21]
    v_pk_fma_f32 v[50:51], v[106:107], v[180:181], v[32:33]
    v_pk_fma_f32 v[74:75], v[78:79], v[180:181], v[44:45]
    v_pk_fma_f32 v[48:49], v[106:107], v[182:183], v[48:49] neg_lo:[0,1,0] neg_hi:[0,1,0]
    v_pk_fma_f32 v[72:73], v[78:79], v[182:183], v[72:73] neg_lo:[0,1,0] neg_hi:[0,1,0]
    v_pk_fma_f32 v[50:51], v[104:105], v[182:183], v[50:51]
    v_pk_fma_f32 v[74:75], v[76:77], v[182:183], v[74:75]
    v_pk_fma_f32 v[104:105], v[48:49], v[180:181], v[10:11]
    v_pk_fma_f32 v[76:77], v[72:73], v[180:181], v[22:23]
    v_pk_fma_f32 v[106:107], v[50:51], v[180:181], v[34:35]
    v_pk_fma_f32 v[78:79], v[74:75], v[180:181], v[46:47]
    v_pk_fma_f32 v[104:105], v[50:51], v[182:183], v[104:105] neg_lo:[0,1,0] neg_hi:[0,1,0]
    v_pk_fma_f32 v[76:77], v[74:75], v[182:183], v[76:77] neg_lo:[0,1,0] neg_hi:[0,1,0]
    v_pk_fma_f32 v[106:107], v[48:49], v[182:183], v[106:107]
    v_pk_fma_f32 v[78:79], v[72:73], v[182:183], v[78:79]
    v_pk_fma_f32 v[52:53], v[104:105], v[184:185], v[76:77]
    v_pk_fma_f32 v[54:55], v[106:107], v[184:185], v[78:79]
    v_pk_fma_f32 v[52:53], v[106:107], v[186:187], v[52:53] neg_lo:[0,1,0] neg_hi:[0,1,0]
    v_pk_fma_f32 v[54:55], v[104:105], v[186:187], v[54:55]
    v_fma_f32 v56, v134, v52, v53
    v_fma_f32 v60, v134, v54, v55
    v_fma_f32 v56, -v135, v54, v56
    v_fma_f32 v60, v135, v52, v60
    v_mov_b32 v57, v56
    v_mov_b32 v61, v60
    s_nop 0
    v_permlane16_swap_b32 v56, v57
    v_permlane16_swap_b32 v60, v61
    v_mov_b32 v58, v56
    v_mov_b32 v62, v60
    v_mov_b32 v59, v57
    v_mov_b32_e64 v63, v61
    v_permlane32_swap_b32 v56, v58
    v_permlane32_swap_b32 v60, v62
    v_permlane32_swap_b32 v57, v59
    v_permlane32_swap_b32 v61, v63
    v_fma_f32 v64, v136, v56, v57
    v_fma_f32 v65, v136, v60, v61
    v_fma_f32 v64, -v137, v60, v64
    v_fma_f32 v65, v137, v56, v65
    v_fma_f32 v66, v136, v64, v58
    v_fma_f32 v67, v136, v65, v62
    v_fma_f32 v66, -v137, v65, v66
    v_fma_f32 v67, v137, v64, v67
    v_fma_f32 v68, v136, v66, v59
    v_fma_f32 v69, v136, v67, v63
    v_fma_f32 v68, -v137, v67, v68
    v_fma_f32 v69, v137, v66, v69
    v_or_b32 v68, 1, v68
    v_or_b32 v69, 1, v69
    s_mul_i32 s72, s74, 5120
    s_lshl_b32 s73, s75, 7
    s_add_u32 s73, s73, 65536
    s_add_u32 s72, s72, s73
    s_waitcnt vmcnt(0)
    v_cmp_gt_u32 vcc, 36, v120
    s_cbranch_vccz L_u_ready
    s_movk_i32 s70, 128
    s_mov_b64 exec, 1
    v_mov_b32 v119, 0
    s_mov_b32 s39, 40000
L_poll_6:
    buffer_load_dword v120, v119, s[56:59], s70 offen sc1
    s_sub_u32 s39, s39, 1
    s_cbranch_scc1 L_polled_7
    s_waitcnt vmcnt(0)
    v_cmp_gt_u32 vcc, 36, v120
    s_cbranch_vccz L_polled_7
    s_sleep 8
    s_branch L_poll_6
L_polled_7:
    s_waitcnt vmcnt(0)
    s_mov_b64 exec, -1
L_u_ready:
    s_mov_b64 exec, 0xffff
    buffer_store_dwordx2 v[68:69], v158, s[52:55], s72 offen sc1
    s_mov_b64 exec, -1
    v_mov_b32 v70, 0
    v_mov_b32_e64 v71, 0
    s_setprio 0
    s_add_u32 m0, s65, 40960
    s_add_u32 s70, s64, s66
    s_nop 0
    buffer_load_dwordx4 v224, s[40:43], s70 offen lds
    s_add_u32 s66, s66, 128
    s_cmp_eq_u32 s66, 1280
    s_cselect_b32 s66, 0, s66
    s_nop 0
    s_add_u32 s70, s70, 9216
    buffer_load_dwordx4 v225, s[40:43], s70 offen offset:1024 lds
    s_add_u32 s70, s70, 9216
    buffer_load_dwordx4 v224, s[40:43], s70 offen offset:2048 lds
    s_add_u32 s70, s70, 9216
    buffer_load_dwordx4 v225, s[40:43], s70 offen offset:3072 lds
    s_add_u32 m0, s65, 45056
    s_add_u32 s70, s70, 13312
    buffer_load_dwordx4 v224, s[40:43], s70 offen lds
    s_add_u32 m0, s65, 61440
    s_add_u32 s70, s64, s66
    s_nop 0
    buffer_load_dwordx4 v224, s[40:43], s70 offen lds
    s_add_u32 s66, s66, 128
    s_cmp_eq_u32 s66, 1280
    s_cselect_b32 s66, 0, s66
    s_nop 0
    s_add_u32 s70, s70, 9216
    buffer_load_dwordx4 v225, s[40:43], s70 offen offset:1024 lds
    s_add_u32 s70, s70, 9216
    buffer_load_dwordx4 v224, s[40:43], s70 offen offset:2048 lds
    s_add_u32 s70, s70, 9216
    buffer_load_dwordx4 v225, s[40:43], s70 offen offset:3072 lds
    s_add_u32 m0, s65, 65536
    s_add_u32 s70, s70, 13312
    buffer_load_dwordx4 v224, s[40:43], s70 offen lds
    s_setprio 3
    s_nop 0
    v_pk_mul_f32 v[92:93], v[0:1], v[190:191]
    v_pk_mul_f32 v[94:95], v[2:3], v[190:191]
    v_pk_mul_f32 v[96:97], v[4:5], v[190:191]
    v_pk_mul_f32 v[98:99], v[6:7], v[190:191]
    v_pk_mul_f32 v[0:1], v[0:1], v[188:189]
    v_pk_mul_f32 v[2:3], v[2:3], v[188:189]
    v_pk_mul_f32 v[4:5], v[4:5], v[188:189]
    v_pk_mul_f32 v[6:7], v[6:7], v[188:189]
    v_pk_fma_f32 v[0:1], v[24:25], v[190:191], v[0:1] neg_lo:[0,1,0] neg_hi:[0,1,0]
    v_pk_fma_f32 v[2:3], v[26:27], v[190:191], v[2:3] neg_lo:[0,1,0] neg_hi:[0,1,0]
    v_pk_fma_f32 v[4:5], v[28:29], v[190:191], v[4:5] neg_lo:[0,1,0] neg_hi:[0,1,0]
    v_pk_fma_f32 v[6:7], v[30:31], v[190:191], v[6:7] neg_lo:[0,1,0] neg_hi:[0,1,0]
    v_pk_fma_f32 v[24:25], v[24:25], v[188:189], v[92:93] neg_lo:[0,1,1] neg_hi:[0,1,1]
    v_pk_fma_f32 v[26:27], v[26:27], v[188:189], v[94:95] neg_lo:[0,1,1] neg_hi:[0,1,1]
    v_pk_fma_f32 v[28:29], v[28:29], v[188:189], v[96:97] neg_lo:[0,1,1] neg_hi:[0,1,1]
    v_pk_fma_f32 v[30:31], v[30:31], v[188:189], v[98:99] neg_lo:[0,1,1] neg_hi:[0,1,1]
    v_mov_b32_dpp v70, v56 quad_perm:[0,1,2,3] row_mask:0x2 bank_mask:0xf
    v_mov_b32_dpp v71, v60 quad_perm:[0,1,2,3] row_mask:0x2 bank_mask:0xf
    v_pk_mul_f32 v[92:93], v[8:9], v[190:191]
    v_pk_mul_f32 v[94:95], v[10:11], v[190:191]
    v_pk_mul_f32 v[96:97], v[12:13], v[190:191]
    v_pk_mul_f32 v[98:99], v[14:15], v[190:191]
    v_pk_mul_f32 v[8:9], v[8:9], v[188:189]
    v_pk_mul_f32 v[10:11], v[10:11], v[188:189]
    v_pk_mul_f32 v[12:13], v[12:13], v[188:189]
    v_pk_mul_f32 v[14:15], v[14:15], v[188:189]
    v_pk_fma_f32 v[8:9], v[32:33], v[190:191], v[8:9] neg_lo:[0,1,0] neg_hi:[0,1,0]
    v_pk_fma_f32 v[10:11], v[34:35], v[190:191], v[10:11] neg_lo:[0,1,0] neg_hi:[0,1,0]
    v_pk_fma_f32 v[12:13], v[36:37], v[190:191], v[12:13] neg_lo:[0,1,0] neg_hi:[0,1,0]
    v_pk_fma_f32 v[14:15], v[38:39], v[190:191], v[14:15] neg_lo:[0,1,0] neg_hi:[0,1,0]
    v_pk_fma_f32 v[32:33], v[32:33], v[188:189], v[92:93] neg_lo:[0,1,1] neg_hi:[0,1,1]
    v_pk_fma_f32 v[34:35], v[34:35], v[188:189], v[94:95] neg_lo:[0,1,1] neg_hi:[0,1,1]
    v_pk_fma_f32 v[36:37], v[36:37], v[188:189], v[96:97] neg_lo:[0,1,1] neg_hi:[0,1,1]
    v_pk_fma_f32 v[38:39], v[38:39], v[188:189], v[98:99] neg_lo:[0,1,1] neg_hi:[0,1,1]
    v_mov_b32_dpp v70, v64 quad_perm:[0,1,2,3] row_mask:0x4 bank_mask:0xf
    v_mov_b32_dpp v71, v65 quad_perm:[0,1,2,3] row_mask:0x4 bank_mask:0xf
    v_pk_mul_f32 v[92:93], v[16:17], v[190:191]
    v_pk_mul_f32 v[94:95], v[18:19], v[190:191]
    v_pk_mul_f32 v[96:97], v[20:21], v[190:191]
    v_pk_mul_f32 v[98:99], v[22:23], v[190:191]
    v_pk_mul_f32 v[16:17], v[16:17], v[188:189]
    v_pk_mul_f32 v[18:19], v[18:19], v[188:189]
    v_pk_mul_f32 v[20:21], v[20:21], v[188:189]
    v_pk_mul_f32 v[22:23], v[22:23], v[188:189]
    v_pk_fma_f32 v[16:17], v[40:41], v[190:191], v[16:17] neg_lo:[0,1,0] neg_hi:[0,1,0]
    v_pk_fma_f32 v[18:19], v[42:43], v[190:191], v[18:19] neg_lo:[0,1,0] neg_hi:[0,1,0]
    v_pk_fma_f32 v[20:21], v[44:45], v[190:191], v[20:21] neg_lo:[0,1,0] neg_hi:[0,1,0]
    v_pk_fma_f32 v[22:23], v[46:47], v[190:191], v[22:23] neg_lo:[0,1,0] neg_hi:[0,1,0]
    v_pk_fma_f32 v[40:41], v[40:41], v[188:189], v[92:93] neg_lo:[0,1,1] neg_hi:[0,1,1]
    v_pk_fma_f32 v[42:43], v[42:43], v[188:189], v[94:95] neg_lo:[0,1,1] neg_hi:[0,1,1]
    v_pk_fma_f32 v[44:45], v[44:45], v[188:189], v[96:97] neg_lo:[0,1,1] neg_hi:[0,1,1]
    v_pk_fma_f32 v[46:47], v[46:47], v[188:189], v[98:99] neg_lo:[0,1,1] neg_hi:[0,1,1]
    v_mov_b32_dpp v70, v66 quad_perm:[0,1,2,3] row_mask:0x8 bank_mask:0xf
    v_mov_b32_dpp v71, v67 quad_perm:[0,1,2,3] row_mask:0x8 bank_mask:0xf
    v_pk_mul_f32 v[92:93], v[104:105], v[190:191]
    v_pk_mul_f32 v[104:105], v[104:105], v[188:189]
    v_pk_fma_f32 v[104:105], v[106:107], v[190:191], v[104:105] neg_lo:[0,1,0] neg_hi:[0,1,0]
    v_pk_fma_f32 v[106:107], v[106:107], v[188:189], v[92:93] neg_lo:[0,1,1] neg_hi:[0,1,1]
    s_mov_b32 s39, 40000
L_epoll_8:
    s_setprio 0
    s_nop 0
    buffer_load_dwordx2 v[80:81], v146, s[52:55], s73 offen sc1
    buffer_load_dwordx2 v[82:83], v147, s[52:55], s73 offen sc1
    buffer_load_dwordx2 v[84:85], v148, s[52:55], s73 offen sc1
    buffer_load_dwordx2 v[86:87], v149, s[52:55], s73 offen sc1
    buffer_load_dwordx2 v[88:89], v150, s[52:55], s73 offen sc1
    buffer_load_dwordx2 v[90:91], v151, s[52:55], s73 offen sc1
    s_setprio 3
    s_sub_u32 s39, s39, 1
    s_cbranch_scc1 L_epolled_9
    s_waitcnt vmcnt(0)
    v_and_or_b32 v92, v80, v81, v152
    v_and_or_b32 v93, v82, v83, v153
    v_and_or_b32 v94, v84, v85, v154
    v_and_or_b32 v95, v86, v87, v155
    v_and_or_b32 v96, v88, v89, v156
    v_and_or_b32 v97, v90, v91, v157
    v_bitop3_b32 v92, v92, v93, v94 bitop3:0x80
    v_bitop3_b32 v95, v95, v96, v97 bitop3:0x80
    v_bitop3_b32 v92, v92, v95, 1 bitop3:0x80
    v_cmp_eq_u32 vcc, 0, v92
    s_cbranch_vccz L_epolled_9
    s_sleep 6
    s_branch L_epoll_8
L_epolled_9:
    s_waitcnt vmcnt(0)
    s_nop 0
    v_fma_f32 v92, v142, v90, v88
    v_fma_f32 v93, v142, v91, v89
    v_fma_f32 v92, -v143, v91, v92
    v_fma_f32 v93, v143, v90, v93
    v_fma_f32 v94, v142, v92, v86
    v_fma_f32 v95, v142, v93, v87
    v_fma_f32 v94, -v143, v93, v94
    v_fma_f32 v95, v143, v92, v95
    v_fma_f32 v92, v142, v94, v84
    v_fma_f32 v93, v142, v95, v85
    v_fma_f32 v92, -v143, v95, v92
    v_fma_f32 v93, v143, v94, v93
    v_fma_f32 v94, v142, v92, v82
    v_fma_f32 v95, v142, v93, v83
    v_fma_f32 v94, -v143, v93, v94
    v_fma_f32 v95, v143, v92, v95
    v_fma_f32 v92, v142, v94, v80
    v_fma_f32 v93, v142, v95, v81
    v_fma_f32 v92, -v143, v95, v92
    v_fma_f32 v93, v143, v94, v93
    v_fma_f32 v96, v140, v92, 0
    v_fma_f32 v98, v140, v93, 0
    v_fma_f32 v96, -v141, v93, v96
    v_fma_f32 v98, v141, v92, v98
    v_mov_b32 v97, v96
    v_mov_b32 v99, v98
    s_nop 0
    v_permlane16_swap_b32 v96, v97
    v_permlane16_swap_b32 v98, v99
    v_add_f32 v96, v96, v97
    v_add_f32 v98, v98, v99
    v_mov_b32 v97, v96
    v_mov_b32 v99, v98
    s_nop 0
    v_permlane32_swap_b32 v96, v97
    v_permlane32_swap_b32 v98, v99
    v_add_f32 v96, v96, v97
    v_add_f32 v98, v98, v99
    v_fma_f32 v100, v138, v96, v70
    v_fma_f32 v102, v138, v98, v71
    v_fma_f32 v100, -v139, v98, v100
    v_fma_f32 v102, v139, v96, v102
    v_fma_f32 v101, v134, v100, v52
    v_fma_f32 v103, v134, v102, v54
    v_fma_f32 v101, -v135, v102, v101
    v_fma_f32 v103, v135, v100, v103
    v_pk_mul_f32 v[92:93], v[100:101], v[190:191]
    v_pk_mul_f32 v[100:101], v[100:101], v[188:189]
    v_pk_fma_f32 v[100:101], v[102:103], v[190:191], v[100:101] neg_lo:[0,1,0] neg_hi:[0,1,0]
    v_pk_fma_f32 v[102:103], v[102:103], v[188:189], v[92:93] neg_lo:[0,1,1] neg_hi:[0,1,1]
    v_pk_fma_f32 v[104:105], v[100:101], v[184:185], v[104:105]
    v_pk_fma_f32 v[106:107], v[102:103], v[184:185], v[106:107]
    v_pk_fma_f32 v[104:105], v[102:103], v[186:187], v[104:105]
    v_pk_fma_f32 v[106:107], v[100:101], v[186:187], v[106:107] neg_lo:[0,1,0] neg_hi:[0,1,0]
    v_pk_fma_f32 v[0:1], v[100:101], v[180:181], v[0:1]
    v_pk_fma_f32 v[12:13], v[104:105], v[180:181], v[12:13]
    v_pk_fma_f32 v[24:25], v[102:103], v[180:181], v[24:25]
    v_pk_fma_f32 v[36:37], v[106:107], v[180:181], v[36:37]
    v_pk_fma_f32 v[0:1], v[102:103], v[182:183], v[0:1]
    v_pk_fma_f32 v[12:13], v[106:107], v[182:183], v[12:13]
    v_pk_fma_f32 v[24:25], v[100:101], v[182:183], v[24:25] neg_lo:[0,1,0] neg_hi:[0,1,0]
    v_pk_fma_f32 v[36:37], v[104:105], v[182:183], v[36:37] neg_lo:[0,1,0] neg_hi:[0,1,0]
    v_pk_fma_f32 v[2:3], v[0:1], v[180:181], v[2:3]
    v_pk_fma_f32 v[14:15], v[12:13], v[180:181], v[14:15]
    v_pk_fma_f32 v[26:27], v[24:25], v[180:181], v[26:27]
    v_pk_fma_f32 v[38:39], v[36:37], v[180:181], v[38:39]
    v_pk_fma_f32 v[2:3], v[24:25], v[182:183], v[2:3]
    v_pk_fma_f32 v[14:15], v[36:37], v[182:183], v[14:15]
    v_pk_fma_f32 v[26:27], v[0:1], v[182:183], v[26:27] neg_lo:[0,1,0] neg_hi:[0,1,0]
    v_pk_fma_f32 v[38:39], v[12:13], v[182:183], v[38:39] neg_lo:[0,1,0] neg_hi:[0,1,0]
    v_pk_fma_f32 v[4:5], v[2:3], v[180:181], v[4:5]
    v_pk_fma_f32 v[16:17], v[14:15], v[180:181], v[16:17]
    v_pk_fma_f32 v[28:29], v[26:27], v[180:181], v[28:29]
    v_pk_fma_f32 v[40:41], v[38:39], v[180:181], v[40:41]
    v_pk_fma_f32 v[4:5], v[26:27], v[182:183], v[4:5]
    v_pk_fma_f32 v[16:17], v[38:39], v[182:183], v[16:17]
    v_pk_fma_f32 v[28:29], v[2:3], v[182:183], v[28:29] neg_lo:[0,1,0] neg_hi:[0,1,0]
    v_pk_fma_f32 v[40:41], v[14:15], v[182:183], v[40:41] neg_lo:[0,1,0] neg_hi:[0,1,0]
    v_pk_fma_f32 v[6:7], v[4:5], v[180:181], v[6:7]
    v_pk_fma_f32 v[18:19], v[16:17], v[180:181], v[18:19]
    v_pk_fma_f32 v[30:31], v[28:29], v[180:181], v[30:31]
    v_pk_fma_f32 v[42:43], v[40:41], v[180:181], v[42:43]
    v_pk_fma_f32 v[6:7], v[28:29], v[182:183], v[6:7]
    v_pk_fma_f32 v[18:19], v[40:41], v[182:183], v[18:19]
    v_pk_fma_f32 v[30:31], v[4:5], v[182:183], v[30:31] neg_lo:[0,1,0] neg_hi:[0,1,0]
    v_pk_fma_f32 v[42:43], v[16:17], v[182:183], v[42:43] neg_lo:[0,1,0] neg_hi:[0,1,0]
    v_pk_fma_f32 v[8:9], v[6:7], v[180:181], v[8:9]
    v_pk_fma_f32 v[20:21], v[18:19], v[180:181], v[20:21]
    v_pk_fma_f32 v[32:33], v[30:31], v[180:181], v[32:33]
    v_pk_fma_f32 v[44:45], v[42:43], v[180:181], v[44:45]
    v_pk_fma_f32 v[8:9], v[30:31], v[182:183], v[8:9]
    v_pk_fma_f32 v[20:21], v[42:43], v[182:183], v[20:21]
    v_pk_fma_f32 v[32:33], v[6:7], v[182:183], v[32:33] neg_lo:[0,1,0] neg_hi:[0,1,0]
    v_pk_fma_f32 v[44:45], v[18:19], v[182:183], v[44:45] neg_lo:[0,1,0] neg_hi:[0,1,0]
    v_pk_fma_f32 v[10:11], v[8:9], v[180:181], v[10:11]
    v_pk_fma_f32 v[22:23], v[20:21], v[180:181], v[22:23]
    v_pk_fma_f32 v[34:35], v[32:33], v[180:181], v[34:35]
    v_pk_fma_f32 v[46:47], v[44:45], v[180:181], v[46:47]
    v_pk_fma_f32 v[10:11], v[32:33], v[182:183], v[10:11]
    v_pk_fma_f32 v[22:23], v[44:45], v[182:183], v[22:23]
    v_pk_fma_f32 v[34:35], v[8:9], v[182:183], v[34:35] neg_lo:[0,1,0] neg_hi:[0,1,0]
    v_pk_fma_f32 v[46:47], v[20:21], v[182:183], v[46:47] neg_lo:[0,1,0] neg_hi:[0,1,0]
    v_cvt_pk_bf16_f32 v48, v0, v2
    v_cvt_pk_bf16_f32 v49, v4, v6
    v_cvt_pk_bf16_f32 v50, v8, v10
    v_cvt_pk_bf16_f32 v51, v12, v14
    v_cvt_pk_bf16_f32 v52, v16, v18
    v_cvt_pk_bf16_f32 v53, v20, v22
    v_cvt_pk_bf16_f32 v54, v1, v3
    v_cvt_pk_bf16_f32 v55, v5, v7
    v_cvt_pk_bf16_f32 v56, v9, v11
    v_cvt_pk_bf16_f32 v57, v13, v15
    v_cvt_pk_bf16_f32 v58, v17, v19
    v_cvt_pk_bf16_f32 v59, v21, v23
    v_cvt_pk_bf16_f32 v60, v24, v26
    v_cvt_pk_bf16_f32 v61, v28, v30
    v_cvt_pk_bf16_f32 v62, v32, v34
    v_cvt_pk_bf16_f32 v63, v36, v38
    v_cvt_pk_bf16_f32 v64, v40, v42
    v_cvt_pk_bf16_f32 v65, v44, v46
    v_cvt_pk_bf16_f32 v66, v25, v27
    v_cvt_pk_bf16_f32 v67, v29, v31
    v_cvt_pk_bf16_f32 v68, v33, v35
    v_cvt_pk_bf16_f32 v69, v37, v39
    v_cvt_pk_bf16_f32 v70, v41, v43
    v_cvt_pk_bf16_f32 v71, v45, v47
    s_setprio 0
    s_nop 0
    ds_write_b128 v159, v[48:51] offset:0
    ds_write_b128 v159, v[52:55] offset:16
    ds_write_b128 v159, v[56:59] offset:32
    ds_write_b128 v159, v[60:63] offset:3328
    ds_write_b128 v159, v[64:67] offset:3344
    ds_write_b128 v159, v[68:71] offset:3360
    s_mul_i32 s72, s74, 245760
    s_lshl_b32 s73, s75, 10
    s_add_u32 s72, s72, s73
    s_add_u32 s72, s72, 4194304
    s_waitcnt lgkmcnt(0)
    s_nop 0
    ds_read_b64_tr_b16 v[0:1], v160 offset:0
    ds_read_b64_tr_b16 v[2:3], v160 offset:832
    ds_read_b64_tr_b16 v[4:5], v160 offset:32
    ds_read_b64_tr_b16 v[6:7], v160 offset:864
    ds_read_b64_tr_b16 v[8:9], v160 offset:64
    ds_read_b64_tr_b16 v[10:11], v160 offset:896
    ds_read_b64_tr_b16 v[12:13], v160 offset:96
    ds_read_b64_tr_b16 v[14:15], v160 offset:928
    ds_read_b64_tr_b16 v[16:17], v160 offset:128
    ds_read_b64_tr_b16 v[18:19], v160 offset:960
    ds_read_b64_tr_b16 v[20:21], v160 offset:160
    ds_read_b64_tr_b16 v[22:23], v160 offset:992
    s_add_u32 s73, s72, 0
    s_waitcnt lgkmcnt(10)
    buffer_store_dwordx4 v[0:3], v248, s[52:55], s73 offen sc1
    s_add_u32 s73, s72, 40960
    s_waitcnt lgkmcnt(8)
    buffer_store_dwordx4 v[4:7], v248, s[52:55], s73 offen sc1
    s_add_u32 s73, s72, 81920
    s_waitcnt lgkmcnt(6)
    buffer_store_dwordx4 v[8:11], v248, s[52:55], s73 offen sc1
    s_add_u32 s73, s72, 122880
    s_waitcnt lgkmcnt(4)
    buffer_store_dwordx4 v[12:15], v248, s[52:55], s73 offen sc1
    s_add_u32 s73, s72, 163840
    s_waitcnt lgkmcnt(2)
    buffer_store_dwordx4 v[16:19], v248, s[52:55], s73 offen sc1
    s_add_u32 s73, s72, 204800
    s_waitcnt lgkmcnt(0)
    buffer_store_dwordx4 v[20:23], v248, s[52:55], s73 offen sc1
    s_lshl_b32 s72, s74, 7
    s_add_u32 s72, s72, 57344
    s_waitcnt vmcnt(0)
    s_barrier
    s_cmp_lg_u32 s38, 0
    s_cbranch_scc1 L_w0_10
    s_mov_b64 exec, 1
    buffer_atomic_add v118, v119, s[52:55], s72 offen
    s_mov_b64 exec, -1
L_w0_10:
    s_branch L_u_end
L_u_idle:
    s_lshl_b32 s70, s60, 2
    s_lshr_b32 s71, 0x32221000, s70
    s_and_b32 s71, s71, 15
    s_add_u32 s70, s70, s71
    s_add_u32 s70, s70, s61
    s_lshl_b32 s70, s70, 2
    s_add_u32 s70, s70, s38
    s_lshl_b32 s70, s70, 10
    s_setprio 3
    s_add_u32 s40, s36, 0xe000
    s_addc_u32 s41, s37, 0
    s_mov_b32 s42, 0x1d800
    s_mov_b32 s43, 0x20000
    v_mov_b32 v4, 0
    v_mov_b32 v5, 0
    v_mov_b32 v6, 0
    v_mov_b32 v7, 0
    buffer_store_dwordx4 v[4:7], v248, s[40:43], s70 offen sc1
    v_add_u32_e64 v1, 0, v255
    v_mul_u32_u24 v2, 6554, v1
    v_lshrrev_b32 v2, 16, v2
    v_mul_u32_u24 v2, 1120, v2
    v_lshl_add_u32 v200, v1, 4, v2
    v_add_u32 v1, 64, v255
    v_mul_u32_u24 v2, 6554, v1
    v_lshrrev_b32 v2, 16, v2
    s_nop 0
    v_mul_u32_u24 v2, 1120, v2
    v_lshl_add_u32 v201, v1, 4, v2
    v_subrev_u32 v201, 1024, v201
    v_add_u32 v1, 128, v255
    v_mul_u32_u24 v2, 6554, v1
    v_lshrrev_b32 v2, 16, v2
    s_nop 0
    v_mul_u32_u24 v2, 1120, v2
    v_lshl_add_u32 v202, v1, 4, v2
    v_subrev_u32 v202, 2048, v202
    v_add_u32 v1, 192, v255
    v_mul_u32_u24 v2, 6554, v1
    v_lshrrev_b32 v2, 16, v2
    s_nop 0
    v_mul_u32_u24 v2, 1120, v2
    v_lshl_add_u32 v203, v1, 4, v2
    v_subrev_u32 v203, 3072, v203
    v_add_u32 v1, 256, v255
    v_mul_u32_u24 v2, 6554, v1
    v_lshrrev_b32 v2, 16, v2
    v_mul_u32_u24 v2, 1120, v2
    v_lshl_add_u32 v204, v1, 4, v2
    v_lshrrev_b32 v10, 4, v255
    v_lshlrev_b32_e64 v10, 3, v10
    v_bfe_u32 v11, v255, 2, 2
    v_mul_u32_u24 v11, 160, v11
    v_and_b32_e64 v9, 3, v255
    v_lshl_add_u32 v11, v9, 3, v11
    s_movk_i32 s71, 160
    s_lshl_b32 s69, s38, 5
    s_mov_b32 s70, 0x18140400
    s_cmp_eq_u32 s38, 1
    s_cselect_b32 s70, 0x3c2c2810, s70
    s_cmp_eq_u32 s38, 2
    s_cselect_b32 s70, 0x54503840, s70
    s_cmp_eq_u32 s38, 3
    s_nop 0
    s_cselect_b32 s70, 0x78606864, s70
    v_bfe_u32 v3, s70, v10, 8
    v_mad_u32_u24 v12, v3, s71, v11
    s_mov_b32 s70, 0x88908c7c
    v_bfe_u32 v3, s70, v10, 8
    v_mad_u32_u24 v14, v3, s71, v11
    v_add_u32_e64 v16, s69, v14
    s_mov_b32 s70, 0x201c0c08
    s_cmp_eq_u32 s38, 1
    s_cselect_b32 s70, 0x44343024, s70
    s_cmp_eq_u32 s38, 2
    s_cselect_b32 s70, 0x5c584c48, s70
    s_cmp_eq_u32 s38, 3
    s_nop 0
    s_cselect_b32 s70, 0x8074706c, s70
    v_bfe_u32 v3, s70, v10, 8
    v_mad_u32_u24 v13, v3, s71, v11
    s_mov_b32 s70, 0x9c989484
    v_bfe_u32 v3, s70, v10, 8
    v_mad_u32_u24 v15, v3, s71, v11
    v_add_u32_e64 v17, s69, v15
    s_mov_b32 s44, s12
    s_mov_b32 s45, s13
    s_mov_b32 s46, 0xc8000
    s_mov_b32 s47, 0x20000
    s_cmp_lg_u32 s38, 0
    s_cbranch_scc1 L_w0_11
    s_lshl_b32 s70, s60, 5
    s_add_u32 s70, s70, s61
    s_lshl_b32 s70, s70, 5
    s_nop 0
    s_add_u32 s70, s70, 8192
    s_mov_b32 s39, 40000
L_spoll_12:
    s_load_dword s3, s[36:37], s70 glc
    s_sub_u32 s39, s39, 1
    s_cbranch_scc1 L_spolled_13
    s_waitcnt lgkmcnt(0)
    s_cmp_ge_u32 s3, 1
    s_cbranch_scc1 L_spolled_13
    s_sleep 4
    s_branch L_spoll_12
L_spolled_13:
    s_waitcnt lgkmcnt(0)
L_w0_11:
    s_barrier
    s_cmp_ge_u32 s61, 4
    s_cbranch_scc1 L_wp_end
    s_mul_i32 s64, s61, 204800
    s_mul_i32 s65, s60, 160
    s_add_u32 s64, s64, s65
    s_mul_i32 s65, s38, 40960
    s_add_u32 s65, s65, s64
    s_mul_i32 s66, s38, 5120
    s_mov_b32 m0, s66
    s_mul_i32 s67, s38, 10240
    buffer_load_dwordx4 v200, s[44:47], s65 offen lds
    buffer_load_dwordx4 v201, s[44:47], s65 offen offset:1024 lds
    buffer_load_dwordx4 v202, s[44:47], s65 offen offset:2048 lds
    buffer_load_dwordx4 v203, s[44:47], s65 offen offset:3072 lds
    s_add_u32 m0, s66, 4096
    s_add_u32 s64, s64, s67
    buffer_load_dwordx4 v204, s[44:47], s65 offen lds
    s_lshr_b32 s67, s67, 3
    s_add_u32 m0, s67, 20480
    s_add_u32 s64, s64, 163840
    buffer_load_dwordx4 v200, s[44:47], s64 offen lds
    s_mov_b64 exec, 0xffff
    buffer_load_dwordx4 v201, s[44:47], s64 offen offset:1024 lds
    s_mov_b64 exec, -1
    s_lshl_b32 s64, s60, 2
    s_add_u32 s64, s64, s61
    s_mul_i32 s64, s64, 25600
    s_add_u32 s64, s64, 524288
    s_add_u32 s65, s64, s66
    s_add_u32 s66, s65, 4096
    s_lshl_b32 s67, s38, 10
    s_add_u32 s67, s67, s64
    s_add_u32 s67, s67, 20480
    s_add_u32 s64, s64, 24576
    s_waitcnt vmcnt(0)
    s_barrier
    ds_read_b64_tr_b16 v[20:21], v12 offset:0
    ds_read_b64_tr_b16 v[22:23], v13 offset:0
    ds_read_b64_tr_b16 v[24:25], v12 offset:32
    ds_read_b64_tr_b16 v[26:27], v13 offset:32
    ds_read_b64_tr_b16 v[28:29], v12 offset:64
    ds_read_b64_tr_b16 v[30:31], v13 offset:64
    ds_read_b64_tr_b16 v[32:33], v12 offset:96
    ds_read_b64_tr_b16 v[34:35], v13 offset:96
    ds_read_b64_tr_b16 v[36:37], v12 offset:128
    ds_read_b64_tr_b16 v[38:39], v13 offset:128
    ds_read_b64_tr_b16 v[40:41], v16 offset:0
    ds_read_b64_tr_b16 v[42:43], v17 offset:0
    ds_read_b64_tr_b16 v[44:45], v14 offset:128
    ds_read_b64_tr_b16 v[46:47], v15 offset:128
    s_waitcnt lgkmcnt(12)
    buffer_store_dwordx4 v[20:23], v248, s[52:55], s65 offen offset:0 sc1
    s_waitcnt lgkmcnt(10)
    buffer_store_dwordx4 v[24:27], v248, s[52:55], s65 offen offset:1024 sc1
    s_waitcnt lgkmcnt(8)
    buffer_store_dwordx4 v[28:31], v248, s[52:55], s65 offen offset:2048 sc1
    s_waitcnt lgkmcnt(6)
    buffer_store_dwordx4 v[32:35], v248, s[52:55], s65 offen offset:3072 sc1
    s_waitcnt lgkmcnt(4)
    buffer_store_dwordx4 v[36:39], v248, s[52:55], s66 offen offset:0 sc1
    s_waitcnt lgkmcnt(2)
    buffer_store_dwordx4 v[40:43], v248, s[52:55], s67 offen offset:0 sc1
    s_waitcnt lgkmcnt(0)
    buffer_store_dwordx4 v[44:47], v248, s[52:55], s64 offen offset:0 sc1
L_wp_end:
    s_movk_i32 s72, 128
    s_waitcnt vmcnt(0)
    s_barrier
    s_cmp_lg_u32 s38, 0
    s_cbranch_scc1 L_w0_14
    s_mov_b64 exec, 1
    v_mov_b32 v1, 0
    v_mov_b32_e64 v2, 1
    buffer_atomic_add v2, v1, s[56:59], s72 offen
    s_mov_b64 exec, -1
L_w0_14:
    v_lshlrev_b32 v1, 7, v255
    s_bfe_u32 s64, s60, 0x10001
    s_lshl_b32 s64, s64, 2
    s_add_u32 s64, s64, 16
    s_mul_i32 s65, s60, 12
    s_setprio 0
    s_lshl_b32 s66, s61, 2
    s_add_u32 s66, s66, s38
L_pf_c:
    s_add_u32 s67, s66, s65
    s_cmp_ge_u32 s67, 100
    s_cselect_b32 s68, 100, 0
    s_sub_u32 s67, s67, s68
    s_lshl_b32 s67, s67, 13
    s_add_u32 s68, s24, s67
    s_addc_u32 s69, s25, 0
    global_load_dword v247, v1, s[68:69]
    s_waitcnt vmcnt(0)
    s_add_u32 s68, s26, s67
    s_addc_u32 s69, s27, 0
    global_load_dword v247, v1, s[68:69]
    s_waitcnt vmcnt(0)
    s_add_u32 s66, s66, s64
    s_cmp_lt_u32 s66, 100
    s_cbranch_scc1 L_pf_c
    s_add_u32 s76, s36, 524288
    s_addc_u32 s77, s37, 0
    s_setprio 3
    s_cmp_lg_u32 s38, 0
    s_cbranch_scc1 L_w0_15
    s_mov_b64 exec, 1
    v_mov_b32_e64 v2, 0
    s_mov_b32 s39, 40000
L_poll_16:
    buffer_load_dword v3, v2, s[56:59], s72 offen sc1
    s_sub_u32 s39, s39, 1
    s_cbranch_scc1 L_polled_17
    s_waitcnt vmcnt(0)
    v_cmp_gt_u32 vcc, 36, v3
    s_cbranch_vccz L_polled_17
    s_sleep 16
    s_branch L_poll_16
L_polled_17:
    s_waitcnt vmcnt(0)
    s_mov_b64 exec, -1
L_w0_15:
    s_setprio 0
    s_barrier
    s_lshl_b32 s66, s61, 2
    s_add_u32 s66, s66, s38
L_pf_w:
    s_add_u32 s67, s66, s65
    s_cmp_ge_u32 s67, 100
    s_cselect_b32 s68, 100, 0
    s_sub_u32 s67, s67, s68
    s_lshl_b32 s67, s67, 13
    s_add_u32 s68, s76, s67
    s_addc_u32 s69, s77, 0
    global_load_dword v247, v1, s[68:69] sc1
    s_waitcnt vmcnt(0)
    s_add_u32 s66, s66, s64
    s_cmp_lt_u32 s66, 100
    s_cbranch_scc1 L_pf_w
    s_lshr_b32 s62, s61, 3
    s_lshl_b32 s70, s60, 2
    s_add_u32 s62, s62, s70
    s_and_b32 s63, s61, 7
    s_cmp_lt_u32 s38, 2
    s_cselect_b32 s40, s24, s26
    s_cselect_b32 s41, s25, s27
    s_mov_b32 s42, 819200
    s_mov_b32 s43, 0x20000
    s_lshl_b32 s64, s63, 1
    s_and_b32 s70, s38, 1
    s_add_u32 s64, s64, s70
    s_mul_i32 s64, s64, 51200
    s_mul_i32 s65, s38, 5120
    s_mul_i32 s66, s63, 5
    s_lshr_b32 s66, s66, 2
    s_lshr_b32 s70, s61, 3
    s_mul_i32 s70, s70, 5
    s_lshr_b32 s70, s70, 1
    s_add_u32 s66, s66, s70
    s_cmp_ge_u32 s66, 10
    s_cselect_b32 s70, 10, 0
    s_sub_u32 s66, s66, s70
    s_lshl_b32 s67, s66, 12
    s_lshl_b32 s66, s66, 7
    s_setprio 0
    s_add_u32 m0, s65, 40960
    s_add_u32 s70, s64, s66
    buffer_load_dwordx4 v224, s[40:43], s70 offen lds
    s_add_u32 s66, s66, 128
    s_cmp_eq_u32 s66, 1280
    s_cselect_b32 s66, 0, s66
    s_nop 0
    s_add_u32 s70, s70, 9216
    buffer_load_dwordx4 v225, s[40:43], s70 offen offset:1024 lds
    s_add_u32 s70, s70, 9216
    buffer_load_dwordx4 v224, s[40:43], s70 offen offset:2048 lds
    s_add_u32 s70, s70, 9216
    buffer_load_dwordx4 v225, s[40:43], s70 offen offset:3072 lds
    s_add_u32 m0, s65, 45056
    s_add_u32 s70, s70, 13312
    buffer_load_dwordx4 v224, s[40:43], s70 offen lds
    s_add_u32 m0, s65, 61440
    s_add_u32 s70, s64, s66
    s_nop 0
    buffer_load_dwordx4 v224, s[40:43], s70 offen lds
    s_add_u32 s66, s66, 128
    s_cmp_eq_u32 s66, 1280
    s_cselect_b32 s66, 0, s66
    s_nop 0
    s_add_u32 s70, s70, 9216
    buffer_load_dwordx4 v225, s[40:43], s70 offen offset:1024 lds
    s_add_u32 s70, s70, 9216
    buffer_load_dwordx4 v224, s[40:43], s70 offen offset:2048 lds
    s_add_u32 s70, s70, 9216
    buffer_load_dwordx4 v225, s[40:43], s70 offen offset:3072 lds
    s_add_u32 m0, s65, 65536
    s_add_u32 s70, s70, 13312
    buffer_load_dwordx4 v224, s[40:43], s70 offen lds
L_u_end:
    s_setprio 0
    s_add_u32 m0, s65, 0
    s_add_u32 s70, s64, s66
    s_nop 0
    buffer_load_dwordx4 v224, s[40:43], s70 offen lds
    s_add_u32 s66, s66, 128
    s_cmp_eq_u32 s66, 1280
    s_cselect_b32 s66, 0, s66
    s_nop 0
    s_add_u32 s70, s70, 9216
    buffer_load_dwordx4 v225, s[40:43], s70 offen offset:1024 lds
    s_add_u32 s70, s70, 9216
    buffer_load_dwordx4 v224, s[40:43], s70 offen offset:2048 lds
    s_add_u32 s70, s70, 9216
    buffer_load_dwordx4 v225, s[40:43], s70 offen offset:3072 lds
    s_add_u32 m0, s65, 4096
    s_add_u32 s70, s70, 13312
    buffer_load_dwordx4 v224, s[40:43], s70 offen lds
    s_add_u32 m0, s65, 20480
    s_add_u32 s70, s64, s66
    s_nop 0
    buffer_load_dwordx4 v224, s[40:43], s70 offen lds
    s_add_u32 s66, s66, 128
    s_cmp_eq_u32 s66, 1280
    s_cselect_b32 s66, 0, s66
    s_nop 0
    s_add_u32 s70, s70, 9216
    buffer_load_dwordx4 v225, s[40:43], s70 offen offset:1024 lds
    s_add_u32 s70, s70, 9216
    buffer_load_dwordx4 v224, s[40:43], s70 offen offset:2048 lds
    s_add_u32 s70, s70, 9216
    buffer_load_dwordx4 v225, s[40:43], s70 offen offset:3072 lds
    s_add_u32 m0, s65, 24576
    s_add_u32 s70, s70, 13312
    buffer_load_dwordx4 v224, s[40:43], s70 offen lds
    s_mov_b32 s48, s32
    s_mov_b32 s49, s33
    s_mov_b32 s50, 0xa00000
    s_mov_b32 s51, 0x20000
    s_setprio 3
    s_waitcnt vmcnt(10)
    s_cmp_lg_u32 s38, 0
    s_cbranch_scc1 L_w0_18
    s_lshl_b32 s70, s62, 1
    v_add_u32_e64 v1, s70, v255
    v_mul_u32_u24 v1, 43, v1
    v_and_b32 v1, 0xff80, v1
    s_mov_b32 s70, 57344
    s_mov_b64 exec, 3
    s_mov_b32 s39, 40000
L_poll_19:
    buffer_load_dword v2, v1, s[52:55], s70 offen sc1
    s_sub_u32 s39, s39, 1
    s_cbranch_scc1 L_polled_20
    s_waitcnt vmcnt(0)
    v_cmp_gt_u32 vcc, 10, v2
    s_cbranch_vccz L_polled_20
    s_sleep 3
    s_branch L_poll_19
L_polled_20:
    s_waitcnt vmcnt(0)
    s_mov_b64 exec, -1
L_w0_18:
    s_lshl_b32 s72, s62, 1
    s_and_b32 s71, s38, 1
    s_add_u32 s72, s72, s71
    s_lshl_b32 s72, s72, 1
    s_lshr_b32 s69, s38, 1
    s_add_u32 s72, s72, s69
    s_mul_i32 s73, s72, 81920
    s_mul_i32 s71, s63, 320
    s_add_u32 s73, s73, s71
    s_add_u32 s73, s73, 2560
    s_lshl_b32 s69, s69, 11
    s_add_u32 s69, s69, 4194304
    s_xor_b32 s68, s72, 1
    s_mul_i32 s68, s68, 40960
    s_add_u32 s68, s68, s69
    s_mul_i32 s72, s72, 40960
    s_add_u32 s69, s69, s72
    s_barrier
    s_setprio 1
    s_add_u32 s71, s68, s67
    buffer_load_dwordx4 v[72:75], v248, s[52:55], s71 offen sc1
    s_add_u32 s72, s69, s67
    buffer_load_dwordx4 v[76:79], v248, s[52:55], s72 offen sc1
    buffer_load_dwordx4 v[80:83], v248, s[52:55], s71 offen offset:1024 sc1
    buffer_load_dwordx4 v[84:87], v248, s[52:55], s72 offen offset:1024 sc1
    s_add_u32 s67, s67, 4096
    s_cmp_eq_u32 s67, 40960
    s_cselect_b32 s67, 0, s67
    s_add_u32 s71, s68, s67
    buffer_load_dwordx4 v[88:91], v248, s[52:55], s71 offen sc1
    s_add_u32 s72, s69, s67
    buffer_load_dwordx4 v[92:95], v248, s[52:55], s72 offen sc1
    buffer_load_dwordx4 v[96:99], v248, s[52:55], s71 offen offset:1024 sc1
    buffer_load_dwordx4 v[100:103], v248, s[52:55], s72 offen offset:1024 sc1
    s_add_u32 s67, s67, 4096
    s_cmp_eq_u32 s67, 40960
    s_cselect_b32 s67, 0, s67
    s_add_u32 s71, s68, s67
    buffer_load_dwordx4 v[104:107], v248, s[52:55], s71 offen sc1
    s_add_u32 s72, s69, s67
    buffer_load_dwordx4 v[108:111], v248, s[52:55], s72 offen sc1
    buffer_load_dwordx4 v[112:115], v248, s[52:55], s71 offen offset:1024 sc1
    buffer_load_dwordx4 v[116:119], v248, s[52:55], s72 offen offset:1024 sc1
    s_add_u32 s67, s67, 4096
    s_cmp_eq_u32 s67, 40960
    s_cselect_b32 s67, 0, s67
    ds_read_b128 v[32:35], v218 offset:0
    ds_read_b128 v[36:39], v218 offset:2048
    ds_read_b128 v[40:43], v218 offset:4096
    ds_read_b128 v[44:47], v218 offset:6144
    ds_read_b128 v[48:51], v218 offset:8192
    ds_read_b128 v[52:55], v219 offset:0
    ds_read_b128 v[56:59], v219 offset:2048
    ds_read_b128 v[60:63], v219 offset:4096
    ds_read_b128 v[64:67], v219 offset:6144
    ds_read_b128 v[68:71], v219 offset:8192
    s_waitcnt lgkmcnt(5) vmcnt(10)
    v_mfma_f32_16x16x32_bf16 v[0:3], v[32:35], v[72:75], 0
    v_mfma_f32_16x16x32_bf16 v[180:183], v[32:35], v[76:79], 0
    ds_read_b128 v[160:163], v218 offset:20480
    v_mfma_f32_16x16x32_bf16 v[4:7], v[36:39], v[72:75], 0
    v_mfma_f32_16x16x32_bf16 v[184:187], v[36:39], v[76:79], 0
    ds_read_b128 v[164:167], v218 offset:22528
    s_add_u32 s71, s68, s67
    buffer_load_dwordx4 v[120:123], v248, s[52:55], s71 offen sc1
    v_mfma_f32_16x16x32_bf16 v[8:11], v[40:43], v[72:75], 0
    v_mfma_f32_16x16x32_bf16 v[188:191], v[40:43], v[76:79], 0
    ds_read_b128 v[168:171], v218 offset:24576
    v_mfma_f32_16x16x32_bf16 v[12:15], v[44:47], v[72:75], 0
    v_mfma_f32_16x16x32_bf16 v[192:195], v[44:47], v[76:79], 0
    ds_read_b128 v[172:175], v218 offset:26624
    s_add_u32 s72, s69, s67
    buffer_load_dwordx4 v[124:127], v248, s[52:55], s72 offen sc1
    v_mfma_f32_16x16x32_bf16 v[16:19], v[48:51], v[72:75], 0
    v_mfma_f32_16x16x32_bf16 v[196:199], v[48:51], v[76:79], 0
    ds_read_b128 v[176:179], v218 offset:28672
    s_waitcnt lgkmcnt(5) vmcnt(10)
    v_mfma_f32_16x16x32_bf16 v[0:3], v[52:55], v[80:83], v[0:3]
    v_mfma_f32_16x16x32_bf16 v[180:183], v[52:55], v[84:87], v[180:183]
    ds_read_b128 v[32:35], v219 offset:20480
    v_mfma_f32_16x16x32_bf16 v[4:7], v[56:59], v[80:83], v[4:7]
    v_mfma_f32_16x16x32_bf16 v[184:187], v[56:59], v[84:87], v[184:187]
    ds_read_b128 v[36:39], v219 offset:22528
    buffer_load_dwordx4 v[128:131], v248, s[52:55], s71 offen offset:1024 sc1
    v_mfma_f32_16x16x32_bf16 v[8:11], v[60:63], v[80:83], v[8:11]
    v_mfma_f32_16x16x32_bf16 v[188:191], v[60:63], v[84:87], v[188:191]
    ds_read_b128 v[40:43], v219 offset:24576
    v_mfma_f32_16x16x32_bf16 v[12:15], v[64:67], v[80:83], v[12:15]
    v_mfma_f32_16x16x32_bf16 v[192:195], v[64:67], v[84:87], v[192:195]
    ds_read_b128 v[44:47], v219 offset:26624
    buffer_load_dwordx4 v[132:135], v248, s[52:55], s72 offen offset:1024 sc1
    s_add_u32 s67, s67, 4096
    s_cmp_eq_u32 s67, 40960
    s_cselect_b32 s67, 0, s67
    v_mfma_f32_16x16x32_bf16 v[16:19], v[68:71], v[80:83], v[16:19]
    v_mfma_f32_16x16x32_bf16 v[196:199], v[68:71], v[84:87], v[196:199]
    ds_read_b128 v[48:51], v219 offset:28672
    s_waitcnt lgkmcnt(5) vmcnt(10)
    s_barrier
    v_mfma_f32_16x16x32_bf16 v[0:3], v[160:163], v[88:91], v[0:3]
    v_mfma_f32_16x16x32_bf16 v[180:183], v[160:163], v[92:95], v[180:183]
    ds_read_b128 v[52:55], v216 offset:0
    s_add_u32 m0, s65, 40960
    s_add_u32 s70, s64, s66
    buffer_load_dwordx4 v224, s[40:43], s70 offen lds
    s_add_u32 s66, s66, 128
    s_cmp_eq_u32 s66, 1280
    s_cselect_b32 s66, 0, s66
    v_mfma_f32_16x16x32_bf16 v[4:7], v[164:167], v[88:91], v[4:7]
    v_mfma_f32_16x16x32_bf16 v[184:187], v[164:167], v[92:95], v[184:187]
    ds_read_b128 v[56:59], v216 offset:2048
    s_add_u32 s71, s68, s67
    buffer_load_dwordx4 v[72:75], v248, s[52:55], s71 offen sc1
    v_mfma_f32_16x16x32_bf16 v[8:11], v[168:171], v[88:91], v[8:11]
    v_mfma_f32_16x16x32_bf16 v[188:191], v[168:171], v[92:95], v[188:191]
    ds_read_b128 v[60:63], v216 offset:4096
    s_add_u32 s70, s70, 9216
    buffer_load_dwordx4 v225, s[40:43], s70 offen offset:1024 lds
    v_mfma_f32_16x16x32_bf16 v[12:15], v[172:175], v[88:91], v[12:15]
    v_mfma_f32_16x16x32_bf16 v[192:195], v[172:175], v[92:95], v[192:195]
    ds_read_b128 v[64:67], v216 offset:6144
    s_add_u32 s72, s69, s67
    buffer_load_dwordx4 v[76:79], v248, s[52:55], s72 offen sc1
    v_mfma_f32_16x16x32_bf16 v[16:19], v[176:179], v[88:91], v[16:19]
    v_mfma_f32_16x16x32_bf16 v[196:199], v[176:179], v[92:95], v[196:199]
    ds_read_b128 v[68:71], v216 offset:8192
    s_add_u32 s70, s70, 9216
    buffer_load_dwordx4 v224, s[40:43], s70 offen offset:2048 lds
    s_waitcnt lgkmcnt(5) vmcnt(13)
    v_mfma_f32_16x16x32_bf16 v[0:3], v[32:35], v[96:99], v[0:3]
    v_mfma_f32_16x16x32_bf16 v[180:183], v[32:35], v[100:103], v[180:183]
    ds_read_b128 v[160:163], v217 offset:0
    s_add_u32 s70, s70, 9216
    buffer_load_dwordx4 v225, s[40:43], s70 offen offset:3072 lds
    v_mfma_f32_16x16x32_bf16 v[4:7], v[36:39], v[96:99], v[4:7]
    v_mfma_f32_16x16x32_bf16 v[184:187], v[36:39], v[100:103], v[184:187]
    ds_read_b128 v[164:167], v217 offset:2048
    buffer_load_dwordx4 v[80:83], v248, s[52:55], s71 offen offset:1024 sc1
    v_mfma_f32_16x16x32_bf16 v[8:11], v[40:43], v[96:99], v[8:11]
    v_mfma_f32_16x16x32_bf16 v[188:191], v[40:43], v[100:103], v[188:191]
    ds_read_b128 v[168:171], v217 offset:4096
    s_add_u32 m0, s65, 45056
    s_add_u32 s70, s70, 13312
    buffer_load_dwordx4 v224, s[40:43], s70 offen lds
    v_mfma_f32_16x16x32_bf16 v[12:15], v[44:47], v[96:99], v[12:15]
    v_mfma_f32_16x16x32_bf16 v[192:195], v[44:47], v[100:103], v[192:195]
    ds_read_b128 v[172:175], v217 offset:6144
    buffer_load_dwordx4 v[84:87], v248, s[52:55], s72 offen offset:1024 sc1
    s_add_u32 s67, s67, 4096
    s_cmp_eq_u32 s67, 40960
    s_cselect_b32 s67, 0, s67
    v_mfma_f32_16x16x32_bf16 v[16:19], v[48:51], v[96:99], v[16:19]
    v_mfma_f32_16x16x32_bf16 v[196:199], v[48:51], v[100:103], v[196:199]
    ds_read_b128 v[176:179], v217 offset:8192
    s_waitcnt lgkmcnt(5) vmcnt(15)
    s_barrier
    v_mfma_f32_16x16x32_bf16 v[0:3], v[52:55], v[104:107], v[0:3]
    v_mfma_f32_16x16x32_bf16 v[180:183], v[52:55], v[108:111], v[180:183]
    ds_read_b128 v[32:35], v216 offset:20480
    s_add_u32 m0, s65, 61440
    s_add_u32 s70, s64, s66
    buffer_load_dwordx4 v224, s[40:43], s70 offen lds
    s_add_u32 s66, s66, 128
    s_cmp_eq_u32 s66, 1280
    s_cselect_b32 s66, 0, s66
    v_mfma_f32_16x16x32_bf16 v[4:7], v[56:59], v[104:107], v[4:7]
    v_mfma_f32_16x16x32_bf16 v[184:187], v[56:59], v[108:111], v[184:187]
    ds_read_b128 v[36:39], v216 offset:22528
    s_add_u32 s71, s68, s67
    buffer_load_dwordx4 v[88:91], v248, s[52:55], s71 offen sc1
    v_mfma_f32_16x16x32_bf16 v[8:11], v[60:63], v[104:107], v[8:11]
    v_mfma_f32_16x16x32_bf16 v[188:191], v[60:63], v[108:111], v[188:191]
    ds_read_b128 v[40:43], v216 offset:24576
    s_add_u32 s70, s70, 9216
    buffer_load_dwordx4 v225, s[40:43], s70 offen offset:1024 lds
    v_mfma_f32_16x16x32_bf16 v[12:15], v[64:67], v[104:107], v[12:15]
    v_mfma_f32_16x16x32_bf16 v[192:195], v[64:67], v[108:111], v[192:195]
    ds_read_b128 v[44:47], v216 offset:26624
    s_add_u32 s72, s69, s67
    buffer_load_dwordx4 v[92:95], v248, s[52:55], s72 offen sc1
    v_mfma_f32_16x16x32_bf16 v[16:19], v[68:71], v[104:107], v[16:19]
    v_mfma_f32_16x16x32_bf16 v[196:199], v[68:71], v[108:111], v[196:199]
    ds_read_b128 v[48:51], v216 offset:28672
    s_add_u32 s70, s70, 9216
    buffer_load_dwordx4 v224, s[40:43], s70 offen offset:2048 lds
    s_waitcnt lgkmcnt(5) vmcnt(18)
    v_mfma_f32_16x16x32_bf16 v[0:3], v[160:163], v[112:115], v[0:3]
    v_mfma_f32_16x16x32_bf16 v[180:183], v[160:163], v[116:119], v[180:183]
    ds_read_b128 v[52:55], v217 offset:20480
    s_add_u32 s70, s70, 9216
    buffer_load_dwordx4 v225, s[40:43], s70 offen offset:3072 lds
    v_mfma_f32_16x16x32_bf16 v[4:7], v[164:167], v[112:115], v[4:7]
    v_mfma_f32_16x16x32_bf16 v[184:187], v[164:167], v[116:119], v[184:187]
    ds_read_b128 v[56:59], v217 offset:22528
    buffer_load_dwordx4 v[96:99], v248, s[52:55], s71 offen offset:1024 sc1
    v_mfma_f32_16x16x32_bf16 v[8:11], v[168:171], v[112:115], v[8:11]
    v_mfma_f32_16x16x32_bf16 v[188:191], v[168:171], v[116:119], v[188:191]
    ds_read_b128 v[60:63], v217 offset:24576
    s_add_u32 m0, s65, 65536
    s_add_u32 s70, s70, 13312
    buffer_load_dwordx4 v224, s[40:43], s70 offen lds
    v_mfma_f32_16x16x32_bf16 v[12:15], v[172:175], v[112:115], v[12:15]
    v_mfma_f32_16x16x32_bf16 v[192:195], v[172:175], v[116:119], v[192:195]
    ds_read_b128 v[64:67], v217 offset:26624
    buffer_load_dwordx4 v[100:103], v248, s[52:55], s72 offen offset:1024 sc1
    s_add_u32 s67, s67, 4096
    s_cmp_eq_u32 s67, 40960
    s_cselect_b32 s67, 0, s67
    v_mfma_f32_16x16x32_bf16 v[16:19], v[176:179], v[112:115], v[16:19]
    v_mfma_f32_16x16x32_bf16 v[196:199], v[176:179], v[116:119], v[196:199]
    ds_read_b128 v[68:71], v217 offset:28672
    s_waitcnt lgkmcnt(5) vmcnt(10)
    s_barrier
    v_mfma_f32_16x16x32_bf16 v[0:3], v[32:35], v[120:123], v[0:3]
    v_mfma_f32_16x16x32_bf16 v[180:183], v[32:35], v[124:127], v[180:183]
    ds_read_b128 v[160:163], v218 offset:0
    s_add_u32 m0, s65, 0
    s_add_u32 s70, s64, s66
    buffer_load_dwordx4 v224, s[40:43], s70 offen lds
    s_add_u32 s66, s66, 128
    s_cmp_eq_u32 s66, 1280
    s_cselect_b32 s66, 0, s66
    v_mfma_f32_16x16x32_bf16 v[4:7], v[36:39], v[120:123], v[4:7]
    v_mfma_f32_16x16x32_bf16 v[184:187], v[36:39], v[124:127], v[184:187]
    ds_read_b128 v[164:167], v218 offset:2048
    s_add_u32 s71, s68, s67
    buffer_load_dwordx4 v[104:107], v248, s[52:55], s71 offen sc1
    v_mfma_f32_16x16x32_bf16 v[8:11], v[40:43], v[120:123], v[8:11]
    v_mfma_f32_16x16x32_bf16 v[188:191], v[40:43], v[124:127], v[188:191]
    ds_read_b128 v[168:171], v218 offset:4096
    s_add_u32 s70, s70, 9216
    buffer_load_dwordx4 v225, s[40:43], s70 offen offset:1024 lds
    v_mfma_f32_16x16x32_bf16 v[12:15], v[44:47], v[120:123], v[12:15]
    v_mfma_f32_16x16x32_bf16 v[192:195], v[44:47], v[124:127], v[192:195]
    ds_read_b128 v[172:175], v218 offset:6144
    s_add_u32 s72, s69, s67
    buffer_load_dwordx4 v[108:111], v248, s[52:55], s72 offen sc1
    v_mfma_f32_16x16x32_bf16 v[16:19], v[48:51], v[120:123], v[16:19]
    v_mfma_f32_16x16x32_bf16 v[196:199], v[48:51], v[124:127], v[196:199]
    ds_read_b128 v[176:179], v218 offset:8192
    s_add_u32 s70, s70, 9216
    buffer_load_dwordx4 v224, s[40:43], s70 offen offset:2048 lds
    s_waitcnt lgkmcnt(5)
    v_mfma_f32_16x16x32_bf16 v[0:3], v[52:55], v[128:131], v[0:3]
    v_mfma_f32_16x16x32_bf16 v[180:183], v[52:55], v[132:135], v[180:183]
    ds_read_b128 v[32:35], v219 offset:0
    s_add_u32 s70, s70, 9216
    buffer_load_dwordx4 v225, s[40:43], s70 offen offset:3072 lds
    v_mfma_f32_16x16x32_bf16 v[4:7], v[56:59], v[128:131], v[4:7]
    v_mfma_f32_16x16x32_bf16 v[184:187], v[56:59], v[132:135], v[184:187]
    ds_read_b128 v[36:39], v219 offset:2048
    buffer_load_dwordx4 v[112:115], v248, s[52:55], s71 offen offset:1024 sc1
    v_mfma_f32_16x16x32_bf16 v[8:11], v[60:63], v[128:131], v[8:11]
    v_mfma_f32_16x16x32_bf16 v[188:191], v[60:63], v[132:135], v[188:191]
    ds_read_b128 v[40:43], v219 offset:4096
    s_add_u32 m0, s65, 4096
    s_add_u32 s70, s70, 13312
    buffer_load_dwordx4 v224, s[40:43], s70 offen lds
    v_mfma_f32_16x16x32_bf16 v[12:15], v[64:67], v[128:131], v[12:15]
    v_mfma_f32_16x16x32_bf16 v[192:195], v[64:67], v[132:135], v[192:195]
    ds_read_b128 v[44:47], v219 offset:6144
    buffer_load_dwordx4 v[116:119], v248, s[52:55], s72 offen offset:1024 sc1
    s_add_u32 s67, s67, 4096
    s_cmp_eq_u32 s67, 40960
    s_cselect_b32 s67, 0, s67
    v_mfma_f32_16x16x32_bf16 v[16:19], v[68:71], v[128:131], v[16:19]
    v_mfma_f32_16x16x32_bf16 v[196:199], v[68:71], v[132:135], v[196:199]
    ds_read_b128 v[48:51], v219 offset:8192
    s_waitcnt lgkmcnt(5) vmcnt(10)
    s_barrier
    v_mfma_f32_16x16x32_bf16 v[0:3], v[160:163], v[72:75], v[0:3]
    v_mfma_f32_16x16x32_bf16 v[180:183], v[160:163], v[76:79], v[180:183]
    ds_read_b128 v[52:55], v218 offset:20480
    s_add_u32 m0, s65, 20480
    s_add_u32 s70, s64, s66
    buffer_load_dwordx4 v224, s[40:43], s70 offen lds
    s_add_u32 s66, s66, 128
    s_cmp_eq_u32 s66, 1280
    s_cselect_b32 s66, 0, s66
    v_mfma_f32_16x16x32_bf16 v[4:7], v[164:167], v[72:75], v[4:7]
    v_mfma_f32_16x16x32_bf16 v[184:187], v[164:167], v[76:79], v[184:187]
    ds_read_b128 v[56:59], v218 offset:22528
    s_add_u32 s71, s68, s67
    buffer_load_dwordx4 v[120:123], v248, s[52:55], s71 offen sc1
    v_mfma_f32_16x16x32_bf16 v[8:11], v[168:171], v[72:75], v[8:11]
    v_mfma_f32_16x16x32_bf16 v[188:191], v[168:171], v[76:79], v[188:191]
    ds_read_b128 v[60:63], v218 offset:24576
    s_add_u32 s70, s70, 9216
    buffer_load_dwordx4 v225, s[40:43], s70 offen offset:1024 lds
    v_mfma_f32_16x16x32_bf16 v[12:15], v[172:175], v[72:75], v[12:15]
    v_mfma_f32_16x16x32_bf16 v[192:195], v[172:175], v[76:79], v[192:195]
    ds_read_b128 v[64:67], v218 offset:26624
    s_add_u32 s72, s69, s67
    buffer_load_dwordx4 v[124:127], v248, s[52:55], s72 offen sc1
    v_mfma_f32_16x16x32_bf16 v[16:19], v[176:179], v[72:75], v[16:19]
    v_mfma_f32_16x16x32_bf16 v[196:199], v[176:179], v[76:79], v[196:199]
    ds_read_b128 v[68:71], v218 offset:28672
    s_add_u32 s70, s70, 9216
    buffer_load_dwordx4 v224, s[40:43], s70 offen offset:2048 lds
    s_waitcnt lgkmcnt(5)
    v_mfma_f32_16x16x32_bf16 v[0:3], v[32:35], v[80:83], v[0:3]
    v_mfma_f32_16x16x32_bf16 v[180:183], v[32:35], v[84:87], v[180:183]
    ds_read_b128 v[160:163], v219 offset:20480
    s_add_u32 s70, s70, 9216
    buffer_load_dwordx4 v225, s[40:43], s70 offen offset:3072 lds
    v_mfma_f32_16x16x32_bf16 v[4:7], v[36:39], v[80:83], v[4:7]
    v_mfma_f32_16x16x32_bf16 v[184:187], v[36:39], v[84:87], v[184:187]
    ds_read_b128 v[164:167], v219 offset:22528
    buffer_load_dwordx4 v[128:131], v248, s[52:55], s71 offen offset:1024 sc1
    v_mfma_f32_16x16x32_bf16 v[8:11], v[40:43], v[80:83], v[8:11]
    v_mfma_f32_16x16x32_bf16 v[188:191], v[40:43], v[84:87], v[188:191]
    ds_read_b128 v[168:171], v219 offset:24576
    s_add_u32 m0, s65, 24576
    s_add_u32 s70, s70, 13312
    buffer_load_dwordx4 v224, s[40:43], s70 offen lds
    v_mfma_f32_16x16x32_bf16 v[12:15], v[44:47], v[80:83], v[12:15]
    v_mfma_f32_16x16x32_bf16 v[192:195], v[44:47], v[84:87], v[192:195]
    ds_read_b128 v[172:175], v219 offset:26624
    buffer_load_dwordx4 v[132:135], v248, s[52:55], s72 offen offset:1024 sc1
    s_add_u32 s67, s67, 4096
    s_cmp_eq_u32 s67, 40960
    s_cselect_b32 s67, 0, s67
    v_mfma_f32_16x16x32_bf16 v[16:19], v[48:51], v[80:83], v[16:19]
    v_mfma_f32_16x16x32_bf16 v[196:199], v[48:51], v[84:87], v[196:199]
    ds_read_b128 v[176:179], v219 offset:28672
    s_waitcnt lgkmcnt(5) vmcnt(10)
    s_barrier
    v_mfma_f32_16x16x32_bf16 v[0:3], v[52:55], v[88:91], v[0:3]
    v_mfma_f32_16x16x32_bf16 v[180:183], v[52:55], v[92:95], v[180:183]
    ds_read_b128 v[32:35], v216 offset:0
    s_add_u32 m0, s65, 40960
    s_add_u32 s70, s64, s66
    buffer_load_dwordx4 v224, s[40:43], s70 offen lds
    s_add_u32 s66, s66, 128
    s_cmp_eq_u32 s66, 1280
    s_cselect_b32 s66, 0, s66
    v_mfma_f32_16x16x32_bf16 v[4:7], v[56:59], v[88:91], v[4:7]
    v_mfma_f32_16x16x32_bf16 v[184:187], v[56:59], v[92:95], v[184:187]
    ds_read_b128 v[36:39], v216 offset:2048
    s_add_u32 s71, s68, s67
    buffer_load_dwordx4 v[72:75], v248, s[52:55], s71 offen sc1
    v_mfma_f32_16x16x32_bf16 v[8:11], v[60:63], v[88:91], v[8:11]
    v_mfma_f32_16x16x32_bf16 v[188:191], v[60:63], v[92:95], v[188:191]
    ds_read_b128 v[40:43], v216 offset:4096
    s_add_u32 s70, s70, 9216
    buffer_load_dwordx4 v225, s[40:43], s70 offen offset:1024 lds
    v_mfma_f32_16x16x32_bf16 v[12:15], v[64:67], v[88:91], v[12:15]
    v_mfma_f32_16x16x32_bf16 v[192:195], v[64:67], v[92:95], v[192:195]
    ds_read_b128 v[44:47], v216 offset:6144
    s_add_u32 s72, s69, s67
    buffer_load_dwordx4 v[76:79], v248, s[52:55], s72 offen sc1
    v_mfma_f32_16x16x32_bf16 v[16:19], v[68:71], v[88:91], v[16:19]
    v_mfma_f32_16x16x32_bf16 v[196:199], v[68:71], v[92:95], v[196:199]
    ds_read_b128 v[48:51], v216 offset:8192
    s_add_u32 s70, s70, 9216
    buffer_load_dwordx4 v224, s[40:43], s70 offen offset:2048 lds
    s_waitcnt lgkmcnt(5)
    v_mfma_f32_16x16x32_bf16 v[0:3], v[160:163], v[96:99], v[0:3]
    v_mfma_f32_16x16x32_bf16 v[180:183], v[160:163], v[100:103], v[180:183]
    ds_read_b128 v[52:55], v217 offset:0
    s_add_u32 s70, s70, 9216
    buffer_load_dwordx4 v225, s[40:43], s70 offen offset:3072 lds
    v_mfma_f32_16x16x32_bf16 v[4:7], v[164:167], v[96:99], v[4:7]
    v_mfma_f32_16x16x32_bf16 v[184:187], v[164:167], v[100:103], v[184:187]
    ds_read_b128 v[56:59], v217 offset:2048
    buffer_load_dwordx4 v[80:83], v248, s[52:55], s71 offen offset:1024 sc1
    v_mfma_f32_16x16x32_bf16 v[8:11], v[168:171], v[96:99], v[8:11]
    v_mfma_f32_16x16x32_bf16 v[188:191], v[168:171], v[100:103], v[188:191]
    ds_read_b128 v[60:63], v217 offset:4096
    s_add_u32 m0, s65, 45056
    s_add_u32 s70, s70, 13312
    buffer_load_dwordx4 v224, s[40:43], s70 offen lds
    v_mfma_f32_16x16x32_bf16 v[12:15], v[172:175], v[96:99], v[12:15]
    v_mfma_f32_16x16x32_bf16 v[192:195], v[172:175], v[100:103], v[192:195]
    ds_read_b128 v[64:67], v217 offset:6144
    buffer_load_dwordx4 v[84:87], v248, s[52:55], s72 offen offset:1024 sc1
    s_add_u32 s67, s67, 4096
    s_cmp_eq_u32 s67, 40960
    s_cselect_b32 s67, 0, s67
    v_mfma_f32_16x16x32_bf16 v[16:19], v[176:179], v[96:99], v[16:19]
    v_mfma_f32_16x16x32_bf16 v[196:199], v[176:179], v[100:103], v[196:199]
    ds_read_b128 v[68:71], v217 offset:8192
    s_waitcnt lgkmcnt(5) vmcnt(10)
    s_barrier
    v_mfma_f32_16x16x32_bf16 v[0:3], v[32:35], v[104:107], v[0:3]
    v_mfma_f32_16x16x32_bf16 v[180:183], v[32:35], v[108:111], v[180:183]
    ds_read_b128 v[160:163], v216 offset:20480
    s_add_u32 m0, s65, 61440
    s_add_u32 s70, s64, s66
    buffer_load_dwordx4 v224, s[40:43], s70 offen lds
    s_add_u32 s66, s66, 128
    s_cmp_eq_u32 s66, 1280
    s_cselect_b32 s66, 0, s66
    v_mfma_f32_16x16x32_bf16 v[4:7], v[36:39], v[104:107], v[4:7]
    v_mfma_f32_16x16x32_bf16 v[184:187], v[36:39], v[108:111], v[184:187]
    ds_read_b128 v[164:167], v216 offset:22528
    s_add_u32 s71, s68, s67
    buffer_load_dwordx4 v[88:91], v248, s[52:55], s71 offen sc1
    v_mfma_f32_16x16x32_bf16 v[8:11], v[40:43], v[104:107], v[8:11]
    v_mfma_f32_16x16x32_bf16 v[188:191], v[40:43], v[108:111], v[188:191]
    ds_read_b128 v[168:171], v216 offset:24576
    s_add_u32 s70, s70, 9216
    buffer_load_dwordx4 v225, s[40:43], s70 offen offset:1024 lds
    v_mfma_f32_16x16x32_bf16 v[12:15], v[44:47], v[104:107], v[12:15]
    v_mfma_f32_16x16x32_bf16 v[192:195], v[44:47], v[108:111], v[192:195]
    ds_read_b128 v[172:175], v216 offset:26624
    s_add_u32 s72, s69, s67
    buffer_load_dwordx4 v[92:95], v248, s[52:55], s72 offen sc1
    v_mfma_f32_16x16x32_bf16 v[16:19], v[48:51], v[104:107], v[16:19]
    v_mfma_f32_16x16x32_bf16 v[196:199], v[48:51], v[108:111], v[196:199]
    ds_read_b128 v[176:179], v216 offset:28672
    s_add_u32 s70, s70, 9216
    buffer_load_dwordx4 v224, s[40:43], s70 offen offset:2048 lds
    s_waitcnt lgkmcnt(5)
    v_mfma_f32_16x16x32_bf16 v[0:3], v[52:55], v[112:115], v[0:3]
    v_mfma_f32_16x16x32_bf16 v[180:183], v[52:55], v[116:119], v[180:183]
    ds_read_b128 v[32:35], v217 offset:20480
    s_add_u32 s70, s70, 9216
    buffer_load_dwordx4 v225, s[40:43], s70 offen offset:3072 lds
    v_mfma_f32_16x16x32_bf16 v[4:7], v[56:59], v[112:115], v[4:7]
    v_mfma_f32_16x16x32_bf16 v[184:187], v[56:59], v[116:119], v[184:187]
    ds_read_b128 v[36:39], v217 offset:22528
    buffer_load_dwordx4 v[96:99], v248, s[52:55], s71 offen offset:1024 sc1
    v_mfma_f32_16x16x32_bf16 v[8:11], v[60:63], v[112:115], v[8:11]
    v_mfma_f32_16x16x32_bf16 v[188:191], v[60:63], v[116:119], v[188:191]
    ds_read_b128 v[40:43], v217 offset:24576
    s_add_u32 m0, s65, 65536
    s_add_u32 s70, s70, 13312
    buffer_load_dwordx4 v224, s[40:43], s70 offen lds
    v_mfma_f32_16x16x32_bf16 v[12:15], v[64:67], v[112:115], v[12:15]
    v_mfma_f32_16x16x32_bf16 v[192:195], v[64:67], v[116:119], v[192:195]
    ds_read_b128 v[44:47], v217 offset:26624
    buffer_load_dwordx4 v[100:103], v248, s[52:55], s72 offen offset:1024 sc1
    s_add_u32 s67, s67, 4096
    s_cmp_eq_u32 s67, 40960
    s_cselect_b32 s67, 0, s67
    v_mfma_f32_16x16x32_bf16 v[16:19], v[68:71], v[112:115], v[16:19]
    v_mfma_f32_16x16x32_bf16 v[196:199], v[68:71], v[116:119], v[196:199]
    ds_read_b128 v[48:51], v217 offset:28672
    s_waitcnt lgkmcnt(5) vmcnt(10)
    s_barrier
    v_mfma_f32_16x16x32_bf16 v[0:3], v[160:163], v[120:123], v[0:3]
    v_mfma_f32_16x16x32_bf16 v[180:183], v[160:163], v[124:127], v[180:183]
    ds_read_b128 v[52:55], v218 offset:0
    v_mfma_f32_16x16x32_bf16 v[4:7], v[164:167], v[120:123], v[4:7]
    v_mfma_f32_16x16x32_bf16 v[184:187], v[164:167], v[124:127], v[184:187]
    ds_read_b128 v[56:59], v218 offset:2048
    v_mfma_f32_16x16x32_bf16 v[8:11], v[168:171], v[120:123], v[8:11]
    v_mfma_f32_16x16x32_bf16 v[188:191], v[168:171], v[124:127], v[188:191]
    ds_read_b128 v[60:63], v218 offset:4096
    v_mfma_f32_16x16x32_bf16 v[12:15], v[172:175], v[120:123], v[12:15]
    v_mfma_f32_16x16x32_bf16 v[192:195], v[172:175], v[124:127], v[192:195]
    ds_read_b128 v[64:67], v218 offset:6144
    v_mfma_f32_16x16x32_bf16 v[16:19], v[176:179], v[120:123], v[16:19]
    v_mfma_f32_16x16x32_bf16 v[196:199], v[176:179], v[124:127], v[196:199]
    ds_read_b128 v[68:71], v218 offset:8192
    s_waitcnt lgkmcnt(5)
    v_mfma_f32_16x16x32_bf16 v[0:3], v[32:35], v[128:131], v[0:3]
    v_mfma_f32_16x16x32_bf16 v[180:183], v[32:35], v[132:135], v[180:183]
    ds_read_b128 v[160:163], v219 offset:0
    v_mfma_f32_16x16x32_bf16 v[4:7], v[36:39], v[128:131], v[4:7]
    v_mfma_f32_16x16x32_bf16 v[184:187], v[36:39], v[132:135], v[184:187]
    ds_read_b128 v[164:167], v219 offset:2048
    v_mfma_f32_16x16x32_bf16 v[8:11], v[40:43], v[128:131], v[8:11]
    v_mfma_f32_16x16x32_bf16 v[188:191], v[40:43], v[132:135], v[188:191]
    ds_read_b128 v[168:171], v219 offset:4096
    v_mfma_f32_16x16x32_bf16 v[12:15], v[44:47], v[128:131], v[12:15]
    v_mfma_f32_16x16x32_bf16 v[192:195], v[44:47], v[132:135], v[192:195]
    ds_read_b128 v[172:175], v219 offset:6144
    v_mfma_f32_16x16x32_bf16 v[16:19], v[48:51], v[128:131], v[16:19]
    v_mfma_f32_16x16x32_bf16 v[196:199], v[48:51], v[132:135], v[196:199]
    ds_read_b128 v[176:179], v219 offset:8192
    s_waitcnt lgkmcnt(5) vmcnt(1)
    s_barrier
    v_mfma_f32_16x16x32_bf16 v[0:3], v[52:55], v[72:75], v[0:3]
    v_mfma_f32_16x16x32_bf16 v[180:183], v[52:55], v[76:79], v[180:183]
    ds_read_b128 v[32:35], v218 offset:20480
    global_load_dwordx2 v[140:141], v237, s[14:15]
    v_mfma_f32_16x16x32_bf16 v[4:7], v[56:59], v[72:75], v[4:7]
    v_mfma_f32_16x16x32_bf16 v[184:187], v[56:59], v[76:79], v[184:187]
    ds_read_b128 v[36:39], v218 offset:22528
    global_load_dwordx2 v[150:151], v242, s[30:31]
    v_mfma_f32_16x16x32_bf16 v[8:11], v[60:63], v[72:75], v[8:11]
    v_mfma_f32_16x16x32_bf16 v[188:191], v[60:63], v[76:79], v[188:191]
    ds_read_b128 v[40:43], v218 offset:24576
    global_load_dwordx2 v[142:143], v238, s[14:15]
    v_mfma_f32_16x16x32_bf16 v[12:15], v[64:67], v[72:75], v[12:15]
    v_mfma_f32_16x16x32_bf16 v[192:195], v[64:67], v[76:79], v[192:195]
    ds_read_b128 v[44:47], v218 offset:26624
    global_load_dwordx2 v[152:153], v243, s[30:31]
    v_mfma_f32_16x16x32_bf16 v[16:19], v[68:71], v[72:75], v[16:19]
    v_mfma_f32_16x16x32_bf16 v[196:199], v[68:71], v[76:79], v[196:199]
    ds_read_b128 v[48:51], v218 offset:28672
    global_load_dwordx2 v[144:145], v239, s[14:15]
    s_waitcnt lgkmcnt(5)
    v_mfma_f32_16x16x32_bf16 v[0:3], v[160:163], v[80:83], v[0:3]
    v_mfma_f32_16x16x32_bf16 v[180:183], v[160:163], v[84:87], v[180:183]
    ds_read_b128 v[52:55], v219 offset:20480
    global_load_dwordx2 v[154:155], v244, s[30:31]
    v_mfma_f32_16x16x32_bf16 v[4:7], v[164:167], v[80:83], v[4:7]
    v_mfma_f32_16x16x32_bf16 v[184:187], v[164:167], v[84:87], v[184:187]
    ds_read_b128 v[56:59], v219 offset:22528
    global_load_dwordx2 v[146:147], v240, s[14:15]
    v_mfma_f32_16x16x32_bf16 v[8:11], v[168:171], v[80:83], v[8:11]
    v_mfma_f32_16x16x32_bf16 v[188:191], v[168:171], v[84:87], v[188:191]
    ds_read_b128 v[60:63], v219 offset:24576
    global_load_dwordx2 v[156:157], v245, s[30:31]
    v_mfma_f32_16x16x32_bf16 v[12:15], v[172:175], v[80:83], v[12:15]
    v_mfma_f32_16x16x32_bf16 v[192:195], v[172:175], v[84:87], v[192:195]
    ds_read_b128 v[64:67], v219 offset:26624
    global_load_dwordx2 v[148:149], v241, s[14:15]
    v_mfma_f32_16x16x32_bf16 v[16:19], v[176:179], v[80:83], v[16:19]
    v_mfma_f32_16x16x32_bf16 v[196:199], v[176:179], v[84:87], v[196:199]
    ds_read_b128 v[68:71], v219 offset:28672
    global_load_dwordx2 v[158:159], v246, s[30:31]
    s_waitcnt lgkmcnt(5)
    s_barrier
    v_mfma_f32_16x16x32_bf16 v[0:3], v[32:35], v[88:91], v[0:3]
    v_mfma_f32_16x16x32_bf16 v[180:183], v[32:35], v[92:95], v[180:183]
    v_mfma_f32_16x16x32_bf16 v[4:7], v[36:39], v[88:91], v[4:7]
    v_mfma_f32_16x16x32_bf16 v[184:187], v[36:39], v[92:95], v[184:187]
    v_mfma_f32_16x16x32_bf16 v[8:11], v[40:43], v[88:91], v[8:11]
    v_mfma_f32_16x16x32_bf16 v[188:191], v[40:43], v[92:95], v[188:191]
    v_mfma_f32_16x16x32_bf16 v[12:15], v[44:47], v[88:91], v[12:15]
    v_mfma_f32_16x16x32_bf16 v[192:195], v[44:47], v[92:95], v[192:195]
    v_mfma_f32_16x16x32_bf16 v[16:19], v[48:51], v[88:91], v[16:19]
    v_mfma_f32_16x16x32_bf16 v[196:199], v[48:51], v[92:95], v[196:199]
    s_waitcnt lgkmcnt(0) vmcnt(10)
    v_mfma_f32_16x16x32_bf16 v[0:3], v[52:55], v[96:99], v[0:3]
    v_mfma_f32_16x16x32_bf16 v[180:183], v[52:55], v[100:103], v[180:183]
    v_mfma_f32_16x16x32_bf16 v[4:7], v[56:59], v[96:99], v[4:7]
    v_mfma_f32_16x16x32_bf16 v[184:187], v[56:59], v[100:103], v[184:187]
    v_mfma_f32_16x16x32_bf16 v[8:11], v[60:63], v[96:99], v[8:11]
    v_mfma_f32_16x16x32_bf16 v[188:191], v[60:63], v[100:103], v[188:191]
    v_mfma_f32_16x16x32_bf16 v[12:15], v[64:67], v[96:99], v[12:15]
    v_mfma_f32_16x16x32_bf16 v[192:195], v[64:67], v[100:103], v[192:195]
    v_mfma_f32_16x16x32_bf16 v[16:19], v[68:71], v[96:99], v[16:19]
    v_mfma_f32_16x16x32_bf16 v[196:199], v[68:71], v[100:103], v[196:199]
    ds_write_b128 v220, v[0:3] offset:0
    ds_write_b128 v226, v[180:183] offset:0
    ds_write_b128 v220, v[4:7] offset:64
    ds_write_b128 v226, v[184:187] offset:64
    ds_write_b128 v220, v[8:11] offset:128
    ds_write_b128 v226, v[188:191] offset:128
    ds_write_b128 v220, v[12:15] offset:192
    ds_write_b128 v226, v[192:195] offset:192
    ds_write_b128 v220, v[16:19] offset:256
    ds_write_b128 v226, v[196:199] offset:256
    s_setprio 3
    s_waitcnt vmcnt(0)
    v_lshlrev_b32 v40, 16, v140
    v_and_b32 v41, 0xffff0000, v140
    v_lshlrev_b32 v42, 16, v150
    v_and_b32 v43, 0xffff0000, v150
    v_lshlrev_b32 v44, 16, v141
    v_and_b32 v45, 0xffff0000, v141
    v_lshlrev_b32 v46, 16, v151
    v_and_b32 v47, 0xffff0000, v151
    v_lshlrev_b32 v48, 16, v142
    v_and_b32 v49, 0xffff0000, v142
    v_lshlrev_b32 v50, 16, v152
    v_and_b32 v51, 0xffff0000, v152
    v_lshlrev_b32 v52, 16, v143
    v_and_b32 v53, 0xffff0000, v143
    v_lshlrev_b32 v54, 16, v153
    v_and_b32 v55, 0xffff0000, v153
    v_lshlrev_b32 v56, 16, v144
    v_and_b32 v57, 0xffff0000, v144
    v_lshlrev_b32 v58, 16, v154
    v_and_b32 v59, 0xffff0000, v154
    v_lshlrev_b32 v60, 16, v145
    v_and_b32 v61, 0xffff0000, v145
    v_lshlrev_b32 v62, 16, v155
    v_and_b32 v63, 0xffff0000, v155
    v_lshlrev_b32 v64, 16, v146
    v_and_b32 v65, 0xffff0000, v146
    v_lshlrev_b32 v66, 16, v156
    v_and_b32 v67, 0xffff0000, v156
    v_lshlrev_b32 v68, 16, v147
    v_and_b32 v69, 0xffff0000, v147
    v_lshlrev_b32 v70, 16, v157
    v_and_b32 v71, 0xffff0000, v157
    v_lshlrev_b32 v72, 16, v148
    v_and_b32 v73, 0xffff0000, v148
    v_lshlrev_b32 v74, 16, v158
    v_and_b32 v75, 0xffff0000, v158
    v_lshlrev_b32 v76, 16, v149
    v_and_b32 v77, 0xffff0000, v149
    v_lshlrev_b32 v78, 16, v159
    v_and_b32 v79, 0xffff0000, v159
    s_waitcnt lgkmcnt(0)
    s_barrier
    ds_read_b128 v[80:83], v227 offset:0
    ds_read_b128 v[84:87], v227 offset:21504
    ds_read_b128 v[88:91], v228 offset:0
    ds_read_b128 v[92:95], v228 offset:21504
    ds_read_b128 v[96:99], v229 offset:0
    ds_read_b128 v[100:103], v229 offset:21504
    ds_read_b128 v[104:107], v230 offset:0
    ds_read_b128 v[108:111], v230 offset:21504
    ds_read_b128 v[112:115], v231 offset:0
    ds_read_b128 v[116:119], v231 offset:21504
    s_waitcnt lgkmcnt(8)
    v_fmac_f32 v80, v40, v42
    v_fmac_f32 v81, v41, v43
    v_fmac_f32 v82, v44, v46
    v_fmac_f32 v83, v45, v47
    v_add_f32 v80, v80, v84
    v_add_f32 v81, v81, v85
    v_add_f32 v82, v82, v86
    v_add_f32 v83, v83, v87
    s_waitcnt lgkmcnt(6)
    v_fmac_f32 v88, v48, v50
    v_fmac_f32 v89, v49, v51
    v_fmac_f32 v90, v52, v54
    v_fmac_f32 v91, v53, v55
    v_add_f32 v88, v88, v92
    v_add_f32 v89, v89, v93
    v_add_f32 v90, v90, v94
    v_add_f32 v91, v91, v95
    s_waitcnt lgkmcnt(4)
    v_fmac_f32 v96, v56, v58
    v_fmac_f32 v97, v57, v59
    v_fmac_f32 v98, v60, v62
    v_fmac_f32 v99, v61, v63
    v_add_f32 v96, v96, v100
    v_add_f32 v97, v97, v101
    v_add_f32 v98, v98, v102
    v_add_f32 v99, v99, v103
    s_waitcnt lgkmcnt(2)
    v_fmac_f32 v104, v64, v66
    v_fmac_f32 v105, v65, v67
    v_fmac_f32 v106, v68, v70
    v_fmac_f32 v107, v69, v71
    v_add_f32 v104, v104, v108
    v_add_f32 v105, v105, v109
    v_add_f32 v106, v106, v110
    v_add_f32 v107, v107, v111
    s_waitcnt lgkmcnt(0)
    v_fmac_f32 v112, v72, v74
    v_fmac_f32 v113, v73, v75
    v_fmac_f32 v114, v76, v78
    v_fmac_f32 v115, v77, v79
    v_add_f32 v112, v112, v116
    v_add_f32 v113, v113, v117
    v_add_f32 v114, v114, v118
    v_add_f32 v115, v115, v119
    s_setprio 1
    buffer_store_dwordx4 v[80:83], v232, s[48:51], s73 offen sc1
    buffer_store_dwordx4 v[88:91], v233, s[48:51], s73 offen sc1
    buffer_store_dwordx4 v[96:99], v234, s[48:51], s73 offen sc1
    buffer_store_dwordx4 v[104:107], v235, s[48:51], s73 offen sc1
    buffer_store_dwordx4 v[112:115], v236, s[48:51], s73 offen sc1
L_ssm_done:
    s_endpgm
L_att:
    v_lshrrev_b32 v1, 6, v0
    v_and_b32 v255, 63, v0
    s_and_b32 s60, s2, 7
    v_readfirstlane_b32 s38, v1
    s_bfe_u32 s61, s2, 0x50003
    v_lshrrev_b32 v1, 3, v255
    v_lshrrev_b32 v2, 4, v255
    v_and_b32_e64 v3, 7, v255
    v_mul_u32_u24 v1, 1280, v1
    v_xor_b32_e64 v3, v3, v2
    v_lshl_add_u32 v254, v3, 4, v1
    v_lshlrev_b32 v248, 4, v255
    v_xor_b32 v253, 64, v254
    v_add_u32 v253, 9216, v253
    v_add_u32_e64 v1, 0, v255
    v_mul_u32_u24 v2, 5462, v1
    v_lshrrev_b32 v2, 16, v2
    v_bfe_u32 v3, v2, 3, 1
    v_lshlrev_b32 v3, 1, v3
    v_xor_b32_e64 v3, v3, v255
    v_mul_u32_u24 v2, 1088, v2
    v_lshl_add_u32 v186, v3, 4, v2
    v_add_u32_e64 v1, 64, v255
    v_mul_u32_u24 v2, 5462, v1
    v_lshrrev_b32 v2, 16, v2
    v_bfe_u32 v3, v2, 3, 1
    v_lshlrev_b32 v3, 1, v3
    v_xor_b32_e64 v3, v3, v255
    v_mul_u32_u24 v2, 1088, v2
    v_lshl_add_u32 v187, v3, 4, v2
    v_add_u32 v1, 128, v255
    v_mul_u32_u24 v2, 5462, v1
    v_lshrrev_b32 v2, 16, v2
    v_bfe_u32 v3, v2, 3, 1
    v_lshlrev_b32 v3, 1, v3
    v_xor_b32_e64 v3, v3, v255
    v_mul_u32_u24 v2, 1088, v2
    v_lshl_add_u32 v188, v3, 4, v2
    s_lshr_b32 s62, s61, 3
    s_lshl_b32 s39, s62, 2
    s_lshr_b32 s67, 20611, s39
    s_and_b32 s67, s67, 15
    s_lshl_b32 s39, s60, 2
    s_add_u32 s62, s62, s39
    s_and_b32 s63, s61, 7
    s_lshl_b32 s39, s62, 2
    s_add_u32 s39, s39, s38
    s_mul_i32 s64, s39, 20480
    s_mul_i32 s65, s38, 20480
    s_mul_i32 s39, s63, 160
    s_andn2_b32 s39, s39, 63
    s_add_u32 s65, s65, s39
    s_lshl_b32 s69, s38, 11
    s_mul_i32 s70, s38, 3072
    s_add_u32 s70, s70, 8192
    s_mov_b32 s66, 0
    s_mov_b32 s42, 2621440
    s_mov_b32 s43, 0x20000
    s_mov_b32 s46, 819200
    s_mov_b32 s47, 0x20000
    s_waitcnt lgkmcnt(0)
    s_mov_b32 s40, s4
    s_mov_b32 s41, s5
    s_mov_b32 s44, s6
    s_mov_b32 s45, s7
    s_cmp_lt_u32 s61, 32
    s_cbranch_scc1 L_q_setup
L_q_prea:
    s_add_u32 m0, s69, s66
    s_lshl_b32 s71, s67, 7
    s_add_u32 s71, s71, s64
    buffer_load_dwordx4 v254, s[40:43], s71 offen lds
    s_mul_i32 s72, s67, 81920
    buffer_load_dwordx4 v253, s[40:43], s71 offen offset:1024 lds
    s_add_u32 m0, s70, s66
    s_add_u32 s72, s72, s65
    buffer_load_dwordx4 v186, s[44:47], s72 offen lds
    s_add_u32 s67, s67, 1
    s_cmp_eq_u32 s67, 10
    buffer_load_dwordx4 v187, s[44:47], s72 offen offset:1024 lds
    s_cselect_b32 s67, 0, s67
    s_nop 0
    buffer_load_dwordx4 v188, s[44:47], s72 offen offset:2048 lds
    s_add_u32 s66, s66, 20480
    s_cmp_lt_u32 s66, 61440
    s_cbranch_scc1 L_q_prea
L_q_setup:
    s_mov_b32 s52, s36
    s_mov_b32 s53, s37
    s_mov_b32 s54, 0x900000
    s_mov_b32 s55, 0x20000
    s_mov_b32 s56, s34
    s_mov_b32 s57, s35
    s_nop 0
    s_mov_b32 s58, 0x100
    s_mov_b32 s59, 0x20000
    s_add_u32 s48, s36, 0x40000
    s_addc_u32 s49, s37, 0
    s_mov_b32 s50, 0x2a000
    s_mov_b32 s51, 0x20000
    s_and_b32 s71, s38, 1
    s_lshl_b32 s71, s71, 12
    s_lshr_b32 s72, s38, 1
    s_mul_i32 s72, s72, 80
    s_and_b32 s73, s63, 1
    s_lshl_b32 s73, s73, 5
    s_add_u32 s72, s72, s73
    v_and_b32_e64 v1, 15, v255
    v_lshrrev_b32 v2, 4, v255
    v_bfe_u32 v3, v255, 1, 3
    v_xor_b32 v3, v3, v2
    v_lshlrev_b32 v1, 7, v1
    v_lshl_add_u32 v1, v3, 4, v1
    v_add_u32 v249, s71, v1
    v_xor_b32 v250, 64, v249
    v_bfe_u32 v3, v255, 2, 2
    v_lshl_add_u32 v3, v2, 3, v3
    v_mul_u32_u24 v3, 192, v3
    v_add_u32 v3, 8192, v3
    v_and_b32 v2, 1, v2
    v_lshlrev_b32 v2, 5, v2
    v_and_b32 v4, 1, v255
    v_and_b32 v5, 2, v255
    v_lshlrev_b32_e64 v5, 2, v5
    v_lshl_add_u32 v5, v4, 4, v5
    v_add_u32 v5, s72, v5
    v_add_u32_e64 v6, 40, v5
    v_mul_u32_u24 v7, 40, v4
    v_add3_u32 v7, v7, s72, 32
    v_xor_b32 v5, v5, v2
    v_add_u32 v189, v5, v3
    v_add_u32 v251, 40960, v189
    v_xor_b32 v6, v6, v2
    v_add_u32 v190, v6, v3
    v_add_u32 v252, 40960, v190
    v_xor_b32 v7, v7, v2
    v_add_u32 v191, v7, v3
    v_add_u32 v247, 40960, v191
    v_lshlrev_b32 v40, 7, v255
    v_mov_b32 v45, 0
    v_mov_b32 v46, 40960
    v_mov_b32 v36, 0x3ea52b5c
    v_mov_b32 v37, 0x3ea52b5c
    v_mov_b32 v180, 0xdddddddd
    v_add_u32 v181, 49152, v248
    v_lshlrev_b32_e64 v182, 2, v255
    v_add_u32 v182, 49152, v182
    v_and_b32 v1, 31, v255
    v_lshrrev_b32 v2, 5, v255
    v_min_u32 v1, 21, v1
    v_cmp_eq_u32 vcc, 15, v1
    v_cmp_eq_u32 s[76:77], 21, v1
    v_and_b32_e64 v3, 28, v1
    s_mov_b32 s39, 0x523104
    v_bfe_u32 v3, s39, v3, 4
    v_and_b32_e64 v1, 3, v1
    v_lshl_add_u32 v1, v3, 2, v1
    v_cndmask_b32 v1, v1, 21, vcc
    v_cndmask_b32 v1, v1, 15, s[76:77]
    v_mul_u32_u24 v2, 352, v2
    v_lshl_add_u32 v183, v1, 4, v2
    v_add_u32 v183, 49152, v183
    v_and_b32 v6, 15, v255
    v_lshrrev_b32 v7, 4, v255
    v_add_u32 v210, 51200, v248
    v_mul_u32_u24 v1, 336, v6
    v_lshl_add_u32 v1, v7, 4, v1
    s_mul_i32 s71, s38, 5376
    v_add_u32_e64 v242, s71, v1
    s_add_u32 s71, s71, 25600
    v_add_u32_e64 v1, 0, v255
    v_mul_u32_u24 v2, 3277, v1
    v_lshrrev_b32 v2, 16, v2
    v_add_lshl_u32 v3, v1, v2, 4
    v_add_u32 v200, s71, v3
    v_mul_u32_u24 v2, 4800, v2
    v_lshl_add_u32 v205, v1, 4, v2
    v_add_u32_e64 v1, 64, v255
    v_mul_u32_u24 v2, 3277, v1
    v_lshrrev_b32 v2, 16, v2
    v_add_lshl_u32 v3, v1, v2, 4
    v_add_u32 v201, s71, v3
    v_mul_u32_u24 v2, 4800, v2
    v_lshl_add_u32 v206, v1, 4, v2
    v_add_u32 v1, 128, v255
    v_mul_u32_u24 v2, 3277, v1
    v_lshrrev_b32 v2, 16, v2
    v_add_lshl_u32 v3, v1, v2, 4
    v_add_u32 v202, s71, v3
    v_mul_u32_u24 v2, 4800, v2
    v_lshl_add_u32 v207, v1, 4, v2
    v_add_u32 v1, 192, v255
    v_mul_u32_u24 v2, 3277, v1
    v_lshrrev_b32 v2, 16, v2
    v_add_lshl_u32 v3, v1, v2, 4
    v_add_u32 v203, s71, v3
    v_mul_u32_u24 v2, 4800, v2
    v_lshl_add_u32 v208, v1, 4, v2
    v_add_u32 v1, 256, v255
    v_mul_u32_u24 v2, 3277, v1
    v_lshrrev_b32 v2, 16, v2
    v_add_lshl_u32 v3, v1, v2, 4
    v_add_u32 v204, s71, v3
    v_mul_u32_u24 v2, 4800, v2
    v_lshl_add_u32 v209, v1, 4, v2
    v_subrev_u32 v244, 49152, v182
    v_subrev_u32 v245, 46592, v183
    v_and_b32_e64 v192, 15, v255
    v_bfe_u32 v193, v255, 4, 1
    v_lshrrev_b32 v194, 5, v255
    s_nop 0
    v_mul_u32_u24 v193, 20480, v193
    v_lshl_add_u32 v192, v192, 4, v193
    v_lshl_add_u32 v192, v194, 8, v192
    v_mov_b32 v193, 0
    v_mov_b32 v196, -1
    v_mov_b32 v197, -1
    v_mov_b32 v198, -1
    v_mov_b32_e64 v199, -1
    s_mul_i32 s75, s38, 5120
    s_mul_i32 s74, s63, 102400
    s_add_u32 s74, s74, s75
    s_add_u32 s74, s74, 524288
    v_mov_b32 v156, 0
    v_mov_b32 v157, 0
    v_mov_b32 v158, 0
    v_mov_b32 v159, 0
    v_mov_b32 v160, 0
    v_mov_b32 v161, 0
    v_mov_b32 v162, 0
    v_mov_b32 v163, 0
    s_cmp_ge_u32 s61, 32
    s_cbranch_scc1 L_q_go
L_q_preb:
    s_add_u32 m0, s69, s66
    s_lshl_b32 s71, s67, 7
    s_add_u32 s71, s71, s64
    buffer_load_dwordx4 v254, s[40:43], s71 offen lds
    s_mul_i32 s72, s67, 81920
    buffer_load_dwordx4 v253, s[40:43], s71 offen offset:1024 lds
    s_add_u32 m0, s70, s66
    s_add_u32 s72, s72, s65
    buffer_load_dwordx4 v186, s[44:47], s72 offen lds
    s_add_u32 s67, s67, 1
    s_cmp_eq_u32 s67, 10
    buffer_load_dwordx4 v187, s[44:47], s72 offen offset:1024 lds
    s_cselect_b32 s67, 0, s67
    s_nop 0
    buffer_load_dwordx4 v188, s[44:47], s72 offen offset:2048 lds
    s_add_u32 s66, s66, 20480
    s_cmp_lt_u32 s66, 61440
    s_cbranch_scc1 L_q_preb
L_q_go:
    s_waitcnt vmcnt(10) lgkmcnt(0)
    s_barrier
    s_nop 0
    ds_read_b128 v[48:51], v249 offset:0
    ds_read_b128 v[52:55], v249 offset:2048
    ds_read_b64_tr_b16 v[56:57], v189 offset:0
    ds_read_b64_tr_b16 v[58:59], v189 offset:768
    ds_read_b64_tr_b16 v[60:61], v190 offset:0
    ds_read_b64_tr_b16 v[62:63], v190 offset:768
    ds_read_b64_tr_b16 v[64:65], v191 offset:0
    ds_read_b64_tr_b16 v[66:67], v191 offset:768
    ds_read_b128 v[68:71], v250 offset:0
    ds_read_b128 v[72:75], v250 offset:2048
    ds_read_b64_tr_b16 v[76:77], v189 offset:6144
    ds_read_b64_tr_b16 v[78:79], v189 offset:6912
    ds_read_b64_tr_b16 v[80:81], v190 offset:6144
    ds_read_b64_tr_b16 v[82:83], v190 offset:6912
    ds_read_b64_tr_b16 v[84:85], v191 offset:6144
    ds_read_b64_tr_b16 v[86:87], v191 offset:6912
    s_add_u32 m0, s69, 61440
    s_lshl_b32 s71, s67, 7
    s_add_u32 s71, s71, s64
    buffer_load_dwordx4 v254, s[40:43], s71 offen lds
    s_mul_i32 s72, s67, 81920
    buffer_load_dwordx4 v253, s[40:43], s71 offen offset:1024 lds
    s_add_u32 m0, s70, 61440
    s_add_u32 s72, s72, s65
    buffer_load_dwordx4 v186, s[44:47], s72 offen lds
    s_add_u32 s67, s67, 1
    s_cmp_eq_u32 s67, 10
    buffer_load_dwordx4 v187, s[44:47], s72 offen offset:1024 lds
    s_cselect_b32 s67, 0, s67
    buffer_load_dwordx4 v188, s[44:47], s72 offen offset:2048 lds
    s_waitcnt vmcnt(10) lgkmcnt(0)
    s_barrier
    v_mfma_f32_16x16x32_bf16 v[0:3], v[56:59], v[48:51], 0
    ds_read_b128 v[96:99], v249 offset:20480
    ds_read_b128 v[100:103], v249 offset:22528
    v_mfma_f32_16x16x32_bf16 v[4:7], v[56:59], v[52:55], 0
    ds_read_b64_tr_b16 v[104:105], v189 offset:20480
    ds_read_b64_tr_b16 v[106:107], v189 offset:21248
    v_mfma_f32_16x16x32_bf16 v[8:11], v[60:63], v[48:51], 0
    ds_read_b64_tr_b16 v[108:109], v190 offset:20480
    ds_read_b64_tr_b16 v[110:111], v190 offset:21248
    v_mfma_f32_16x16x32_bf16 v[12:15], v[60:63], v[52:55], 0
    ds_read_b64_tr_b16 v[112:113], v191 offset:20480
    ds_read_b64_tr_b16 v[114:115], v191 offset:21248
    s_add_u32 m0, s69, 0
    s_lshl_b32 s71, s67, 7
    s_add_u32 s71, s71, s64
    s_nop 0
    buffer_load_dwordx4 v254, s[40:43], s71 offen lds
    v_mfma_f32_16x16x32_bf16 v[16:19], v[64:67], v[48:51], 0
    ds_read_b128 v[116:119], v250 offset:20480
    ds_read_b128 v[120:123], v250 offset:22528
    v_mfma_f32_16x16x32_bf16 v[20:23], v[64:67], v[52:55], 0
    ds_read_b64_tr_b16 v[124:125], v189 offset:26624
    ds_read_b64_tr_b16 v[126:127], v189 offset:27392
    s_mul_i32 s72, s67, 81920
    buffer_load_dwordx4 v253, s[40:43], s71 offen offset:1024 lds
    v_mfma_f32_16x16x32_bf16 v[0:3], v[76:79], v[68:71], v[0:3]
    ds_read_b64_tr_b16 v[128:129], v190 offset:26624
    ds_read_b64_tr_b16 v[130:131], v190 offset:27392
    v_mfma_f32_16x16x32_bf16 v[4:7], v[76:79], v[72:75], v[4:7]
    ds_read_b64_tr_b16 v[132:133], v191 offset:26624
    ds_read_b64_tr_b16 v[134:135], v191 offset:27392
    s_add_u32 m0, s70, 0
    s_add_u32 s72, s72, s65
    buffer_load_dwordx4 v186, s[44:47], s72 offen lds
    v_mfma_f32_16x16x32_bf16 v[8:11], v[80:83], v[68:71], v[8:11]
    v_mfma_f32_16x16x32_bf16 v[12:15], v[80:83], v[72:75], v[12:15]
    s_add_u32 s67, s67, 1
    s_cmp_eq_u32 s67, 10
    buffer_load_dwordx4 v187, s[44:47], s72 offen offset:1024 lds
    v_mfma_f32_16x16x32_bf16 v[16:19], v[84:87], v[68:71], v[16:19]
    v_mfma_f32_16x16x32_bf16 v[20:23], v[84:87], v[72:75], v[20:23]
    s_cselect_b32 s67, 0, s67
    buffer_load_dwordx4 v188, s[44:47], s72 offen offset:2048 lds
    s_waitcnt vmcnt(10) lgkmcnt(0)
    s_barrier
    s_nop 0
    v_mfma_f32_16x16x32_bf16 v[0:3], v[104:107], v[96:99], v[0:3]
    ds_read_b128 v[48:51], v249 offset:40960
    ds_read_b128 v[52:55], v249 offset:43008
    v_mfma_f32_16x16x32_bf16 v[4:7], v[104:107], v[100:103], v[4:7]
    ds_read_b64_tr_b16 v[56:57], v251 offset:0
    ds_read_b64_tr_b16 v[58:59], v251 offset:768
    v_mfma_f32_16x16x32_bf16 v[8:11], v[108:111], v[96:99], v[8:11]
    ds_read_b64_tr_b16 v[60:61], v252 offset:0
    ds_read_b64_tr_b16 v[62:63], v252 offset:768
    v_mfma_f32_16x16x32_bf16 v[12:15], v[108:111], v[100:103], v[12:15]
    ds_read_b64_tr_b16 v[64:65], v247 offset:0
    ds_read_b64_tr_b16 v[66:67], v247 offset:768
    s_add_u32 m0, s69, 20480
    s_lshl_b32 s71, s67, 7
    s_add_u32 s71, s71, s64
    buffer_load_dwordx4 v254, s[40:43], s71 offen lds
    v_mfma_f32_16x16x32_bf16 v[16:19], v[112:115], v[96:99], v[16:19]
    ds_read_b128 v[68:71], v250 offset:40960
    ds_read_b128 v[72:75], v250 offset:43008
    v_mfma_f32_16x16x32_bf16 v[20:23], v[112:115], v[100:103], v[20:23]
    ds_read_b64_tr_b16 v[76:77], v251 offset:6144
    ds_read_b64_tr_b16 v[78:79], v251 offset:6912
    s_mul_i32 s72, s67, 81920
    buffer_load_dwordx4 v253, s[40:43], s71 offen offset:1024 lds
    v_mfma_f32_16x16x32_bf16 v[0:3], v[124:127], v[116:119], v[0:3]
    ds_read_b64_tr_b16 v[80:81], v252 offset:6144
    ds_read_b64_tr_b16 v[82:83], v252 offset:6912
    v_mfma_f32_16x16x32_bf16 v[4:7], v[124:127], v[120:123], v[4:7]
    ds_read_b64_tr_b16 v[84:85], v247 offset:6144
    ds_read_b64_tr_b16 v[86:87], v247 offset:6912
    s_add_u32 m0, s70, 20480
    s_add_u32 s72, s72, s65
    s_nop 0
    buffer_load_dwordx4 v186, s[44:47], s72 offen lds
    v_mfma_f32_16x16x32_bf16 v[8:11], v[128:131], v[116:119], v[8:11]
    v_mfma_f32_16x16x32_bf16 v[12:15], v[128:131], v[120:123], v[12:15]
    s_add_u32 s67, s67, 1
    s_cmp_eq_u32 s67, 10
    buffer_load_dwordx4 v187, s[44:47], s72 offen offset:1024 lds
    v_mfma_f32_16x16x32_bf16 v[16:19], v[132:135], v[116:119], v[16:19]
    v_mfma_f32_16x16x32_bf16 v[20:23], v[132:135], v[120:123], v[20:23]
    s_cselect_b32 s67, 0, s67
    buffer_load_dwordx4 v188, s[44:47], s72 offen offset:2048 lds
    s_waitcnt vmcnt(10) lgkmcnt(0)
    s_barrier
    s_nop 0
    v_mfma_f32_16x16x32_bf16 v[0:3], v[56:59], v[48:51], v[0:3]
    ds_read_b128 v[96:99], v249 offset:61440
    ds_read_b128 v[100:103], v249 offset:63488
    v_mfma_f32_16x16x32_bf16 v[4:7], v[56:59], v[52:55], v[4:7]
    ds_read_b64_tr_b16 v[104:105], v251 offset:20480
    ds_read_b64_tr_b16 v[106:107], v251 offset:21248
    v_mfma_f32_16x16x32_bf16 v[8:11], v[60:63], v[48:51], v[8:11]
    ds_read_b64_tr_b16 v[108:109], v252 offset:20480
    ds_read_b64_tr_b16 v[110:111], v252 offset:21248
    v_mfma_f32_16x16x32_bf16 v[12:15], v[60:63], v[52:55], v[12:15]
    ds_read_b64_tr_b16 v[112:113], v247 offset:20480
    ds_read_b64_tr_b16 v[114:115], v247 offset:21248
    s_add_u32 m0, s69, 40960
    s_lshl_b32 s71, s67, 7
    s_add_u32 s71, s71, s64
    buffer_load_dwordx4 v254, s[40:43], s71 offen lds
    v_mfma_f32_16x16x32_bf16 v[16:19], v[64:67], v[48:51], v[16:19]
    ds_read_b128 v[116:119], v250 offset:61440
    ds_read_b128 v[120:123], v250 offset:63488
    v_mfma_f32_16x16x32_bf16 v[20:23], v[64:67], v[52:55], v[20:23]
    ds_read_b64_tr_b16 v[124:125], v251 offset:26624
    ds_read_b64_tr_b16 v[126:127], v251 offset:27392
    s_mul_i32 s72, s67, 81920
    buffer_load_dwordx4 v253, s[40:43], s71 offen offset:1024 lds
    v_mfma_f32_16x16x32_bf16 v[0:3], v[76:79], v[68:71], v[0:3]
    ds_read_b64_tr_b16 v[128:129], v252 offset:26624
    ds_read_b64_tr_b16 v[130:131], v252 offset:27392
    v_mfma_f32_16x16x32_bf16 v[4:7], v[76:79], v[72:75], v[4:7]
    ds_read_b64_tr_b16 v[132:133], v247 offset:26624
    ds_read_b64_tr_b16 v[134:135], v247 offset:27392
    s_add_u32 m0, s70, 40960
    s_add_u32 s72, s72, s65
    s_nop 0
    buffer_load_dwordx4 v186, s[44:47], s72 offen lds
    v_mfma_f32_16x16x32_bf16 v[8:11], v[80:83], v[68:71], v[8:11]
    v_mfma_f32_16x16x32_bf16 v[12:15], v[80:83], v[72:75], v[12:15]
    s_add_u32 s67, s67, 1
    s_cmp_eq_u32 s67, 10
    buffer_load_dwordx4 v187, s[44:47], s72 offen offset:1024 lds
    v_mfma_f32_16x16x32_bf16 v[16:19], v[84:87], v[68:71], v[16:19]
    v_mfma_f32_16x16x32_bf16 v[20:23], v[84:87], v[72:75], v[20:23]
    s_cselect_b32 s67, 0, s67
    buffer_load_dwordx4 v188, s[44:47], s72 offen offset:2048 lds
    s_waitcnt vmcnt(10) lgkmcnt(0)
    s_barrier
    s_nop 0
    v_mfma_f32_16x16x32_bf16 v[0:3], v[104:107], v[96:99], v[0:3]
    ds_read_b128 v[48:51], v249 offset:0
    ds_read_b128 v[52:55], v249 offset:2048
    v_mfma_f32_16x16x32_bf16 v[4:7], v[104:107], v[100:103], v[4:7]
    ds_read_b64_tr_b16 v[56:57], v189 offset:0
    ds_read_b64_tr_b16 v[58:59], v189 offset:768
    v_mfma_f32_16x16x32_bf16 v[8:11], v[108:111], v[96:99], v[8:11]
    ds_read_b64_tr_b16 v[60:61], v190 offset:0
    ds_read_b64_tr_b16 v[62:63], v190 offset:768
    v_mfma_f32_16x16x32_bf16 v[12:15], v[108:111], v[100:103], v[12:15]
    ds_read_b64_tr_b16 v[64:65], v191 offset:0
    ds_read_b64_tr_b16 v[66:67], v191 offset:768
    s_add_u32 m0, s69, 61440
    s_lshl_b32 s71, s67, 7
    s_add_u32 s71, s71, s64
    buffer_load_dwordx4 v254, s[40:43], s71 offen lds
    v_mfma_f32_16x16x32_bf16 v[16:19], v[112:115], v[96:99], v[16:19]
    ds_read_b128 v[68:71], v250 offset:0
    ds_read_b128 v[72:75], v250 offset:2048
    v_mfma_f32_16x16x32_bf16 v[20:23], v[112:115], v[100:103], v[20:23]
    ds_read_b64_tr_b16 v[76:77], v189 offset:6144
    ds_read_b64_tr_b16 v[78:79], v189 offset:6912
    s_mul_i32 s72, s67, 81920
    buffer_load_dwordx4 v253, s[40:43], s71 offen offset:1024 lds
    v_mfma_f32_16x16x32_bf16 v[0:3], v[124:127], v[116:119], v[0:3]
    ds_read_b64_tr_b16 v[80:81], v190 offset:6144
    ds_read_b64_tr_b16 v[82:83], v190 offset:6912
    v_mfma_f32_16x16x32_bf16 v[4:7], v[124:127], v[120:123], v[4:7]
    ds_read_b64_tr_b16 v[84:85], v191 offset:6144
    ds_read_b64_tr_b16 v[86:87], v191 offset:6912
    s_add_u32 m0, s70, 61440
    s_add_u32 s72, s72, s65
    s_nop 0
    buffer_load_dwordx4 v186, s[44:47], s72 offen lds
    v_mfma_f32_16x16x32_bf16 v[8:11], v[128:131], v[116:119], v[8:11]
    v_mfma_f32_16x16x32_bf16 v[12:15], v[128:131], v[120:123], v[12:15]
    s_add_u32 s67, s67, 1
    s_cmp_eq_u32 s67, 10
    buffer_load_dwordx4 v187, s[44:47], s72 offen offset:1024 lds
    v_mfma_f32_16x16x32_bf16 v[16:19], v[132:135], v[116:119], v[16:19]
    v_mfma_f32_16x16x32_bf16 v[20:23], v[132:135], v[120:123], v[20:23]
    s_cselect_b32 s67, 0, s67
    buffer_load_dwordx4 v188, s[44:47], s72 offen offset:2048 lds
    s_cmp_lg_u32 s38, 0
    s_cbranch_scc1 L_w0_dbg
    buffer_load_dword v41, v45, s[56:59], 0 offen sc1
L_w0_dbg:
    s_waitcnt vmcnt(10) lgkmcnt(0)
    s_barrier
    s_nop 0
    v_mfma_f32_16x16x32_bf16 v[0:3], v[56:59], v[48:51], v[0:3]
    ds_read_b128 v[96:99], v249 offset:20480
    ds_read_b128 v[100:103], v249 offset:22528
    v_mfma_f32_16x16x32_bf16 v[4:7], v[56:59], v[52:55], v[4:7]
    ds_read_b64_tr_b16 v[104:105], v189 offset:20480
    ds_read_b64_tr_b16 v[106:107], v189 offset:21248
    v_mfma_f32_16x16x32_bf16 v[8:11], v[60:63], v[48:51], v[8:11]
    ds_read_b64_tr_b16 v[108:109], v190 offset:20480
    ds_read_b64_tr_b16 v[110:111], v190 offset:21248
    v_mfma_f32_16x16x32_bf16 v[12:15], v[60:63], v[52:55], v[12:15]
    ds_read_b64_tr_b16 v[112:113], v191 offset:20480
    ds_read_b64_tr_b16 v[114:115], v191 offset:21248
    s_add_u32 m0, s69, 0
    s_lshl_b32 s71, s67, 7
    s_add_u32 s71, s71, s64
    s_nop 0
    buffer_load_dwordx4 v254, s[40:43], s71 offen lds
    v_mfma_f32_16x16x32_bf16 v[16:19], v[64:67], v[48:51], v[16:19]
    ds_read_b128 v[116:119], v250 offset:20480
    ds_read_b128 v[120:123], v250 offset:22528
    v_mfma_f32_16x16x32_bf16 v[20:23], v[64:67], v[52:55], v[20:23]
    ds_read_b64_tr_b16 v[124:125], v189 offset:26624
    ds_read_b64_tr_b16 v[126:127], v189 offset:27392
    s_mul_i32 s72, s67, 81920
    buffer_load_dwordx4 v253, s[40:43], s71 offen offset:1024 lds
    v_mfma_f32_16x16x32_bf16 v[0:3], v[76:79], v[68:71], v[0:3]
    ds_read_b64_tr_b16 v[128:129], v190 offset:26624
    ds_read_b64_tr_b16 v[130:131], v190 offset:27392
    v_mfma_f32_16x16x32_bf16 v[4:7], v[76:79], v[72:75], v[4:7]
    ds_read_b64_tr_b16 v[132:133], v191 offset:26624
    ds_read_b64_tr_b16 v[134:135], v191 offset:27392
    s_add_u32 m0, s70, 0
    s_add_u32 s72, s72, s65
    buffer_load_dwordx4 v186, s[44:47], s72 offen lds
    v_mfma_f32_16x16x32_bf16 v[8:11], v[80:83], v[68:71], v[8:11]
    v_mfma_f32_16x16x32_bf16 v[12:15], v[80:83], v[72:75], v[12:15]
    s_add_u32 s67, s67, 1
    s_cmp_eq_u32 s67, 10
    buffer_load_dwordx4 v187, s[44:47], s72 offen offset:1024 lds
    v_mfma_f32_16x16x32_bf16 v[16:19], v[84:87], v[68:71], v[16:19]
    v_mfma_f32_16x16x32_bf16 v[20:23], v[84:87], v[72:75], v[20:23]
    s_cselect_b32 s67, 0, s67
    buffer_load_dwordx4 v188, s[44:47], s72 offen offset:2048 lds
    s_waitcnt vmcnt(10) lgkmcnt(0)
    s_barrier
    s_nop 0
    v_mfma_f32_16x16x32_bf16 v[0:3], v[104:107], v[96:99], v[0:3]
    ds_read_b128 v[48:51], v249 offset:40960
    ds_read_b128 v[52:55], v249 offset:43008
    v_mfma_f32_16x16x32_bf16 v[4:7], v[104:107], v[100:103], v[4:7]
    ds_read_b64_tr_b16 v[56:57], v251 offset:0
    ds_read_b64_tr_b16 v[58:59], v251 offset:768
    v_mfma_f32_16x16x32_bf16 v[8:11], v[108:111], v[96:99], v[8:11]
    ds_read_b64_tr_b16 v[60:61], v252 offset:0
    ds_read_b64_tr_b16 v[62:63], v252 offset:768
    v_mfma_f32_16x16x32_bf16 v[12:15], v[108:111], v[100:103], v[12:15]
    ds_read_b64_tr_b16 v[64:65], v247 offset:0
    ds_read_b64_tr_b16 v[66:67], v247 offset:768
    s_add_u32 m0, s69, 20480
    s_lshl_b32 s71, s67, 7
    s_add_u32 s71, s71, s64
    buffer_load_dwordx4 v254, s[40:43], s71 offen lds
    v_mfma_f32_16x16x32_bf16 v[16:19], v[112:115], v[96:99], v[16:19]
    ds_read_b128 v[68:71], v250 offset:40960
    ds_read_b128 v[72:75], v250 offset:43008
    v_mfma_f32_16x16x32_bf16 v[20:23], v[112:115], v[100:103], v[20:23]
    ds_read_b64_tr_b16 v[76:77], v251 offset:6144
    ds_read_b64_tr_b16 v[78:79], v251 offset:6912
    s_mul_i32 s72, s67, 81920
    buffer_load_dwordx4 v253, s[40:43], s71 offen offset:1024 lds
    v_mfma_f32_16x16x32_bf16 v[0:3], v[124:127], v[116:119], v[0:3]
    ds_read_b64_tr_b16 v[80:81], v252 offset:6144
    ds_read_b64_tr_b16 v[82:83], v252 offset:6912
    v_mfma_f32_16x16x32_bf16 v[4:7], v[124:127], v[120:123], v[4:7]
    ds_read_b64_tr_b16 v[84:85], v247 offset:6144
    ds_read_b64_tr_b16 v[86:87], v247 offset:6912
    s_add_u32 m0, s70, 20480
    s_add_u32 s72, s72, s65
    s_nop 0
    buffer_load_dwordx4 v186, s[44:47], s72 offen lds
    v_mfma_f32_16x16x32_bf16 v[8:11], v[128:131], v[116:119], v[8:11]
    v_mfma_f32_16x16x32_bf16 v[12:15], v[128:131], v[120:123], v[12:15]
    s_add_u32 s67, s67, 1
    s_cmp_eq_u32 s67, 10
    buffer_load_dwordx4 v187, s[44:47], s72 offen offset:1024 lds
    v_mfma_f32_16x16x32_bf16 v[16:19], v[132:135], v[116:119], v[16:19]
    v_mfma_f32_16x16x32_bf16 v[20:23], v[132:135], v[120:123], v[20:23]
    s_cselect_b32 s67, 0, s67
    buffer_load_dwordx4 v188, s[44:47], s72 offen offset:2048 lds
    s_waitcnt vmcnt(10) lgkmcnt(0)
    s_barrier
    s_cmp_lg_u32 s38, 0
    s_cbranch_scc1 L_w0_flg
    v_cmp_gt_u32 vcc, 4, v41
    s_cbranch_vccz L_q_flg2
    s_mov_b64 exec, 1
    v_mov_b32_e64 v45, 0
    s_mov_b32 s39, 40000
L_poll_21:
    buffer_load_dword v41, v45, s[56:59], 0 offen sc1
    s_sub_u32 s39, s39, 1
    s_cbranch_scc1 L_polled_22
    s_waitcnt vmcnt(0)
    v_cmp_gt_u32 vcc, 4, v41
    s_cbranch_vccz L_polled_22
    s_branch L_poll_21
L_polled_22:
    s_waitcnt vmcnt(0)
    s_mov_b64 exec, -1
L_q_flg2:
    buffer_load_dwordx4 v[32:35], v40, s[52:55], 0 offen sc1
L_w0_flg:
    v_mfma_f32_16x16x32_bf16 v[0:3], v[56:59], v[48:51], v[0:3]
    ds_read_b128 v[96:99], v249 offset:61440
    ds_read_b128 v[100:103], v249 offset:63488
    v_mfma_f32_16x16x32_bf16 v[4:7], v[56:59], v[52:55], v[4:7]
    ds_read_b64_tr_b16 v[104:105], v251 offset:20480
    ds_read_b64_tr_b16 v[106:107], v251 offset:21248
    v_mfma_f32_16x16x32_bf16 v[8:11], v[60:63], v[48:51], v[8:11]
    ds_read_b64_tr_b16 v[108:109], v252 offset:20480
    ds_read_b64_tr_b16 v[110:111], v252 offset:21248
    v_mfma_f32_16x16x32_bf16 v[12:15], v[60:63], v[52:55], v[12:15]
    ds_read_b64_tr_b16 v[112:113], v247 offset:20480
    ds_read_b64_tr_b16 v[114:115], v247 offset:21248
    v_mfma_f32_16x16x32_bf16 v[16:19], v[64:67], v[48:51], v[16:19]
    ds_read_b128 v[116:119], v250 offset:61440
    ds_read_b128 v[120:123], v250 offset:63488
    v_mfma_f32_16x16x32_bf16 v[20:23], v[64:67], v[52:55], v[20:23]
    ds_read_b64_tr_b16 v[124:125], v251 offset:26624
    ds_read_b64_tr_b16 v[126:127], v251 offset:27392
    v_mfma_f32_16x16x32_bf16 v[0:3], v[76:79], v[68:71], v[0:3]
    ds_read_b64_tr_b16 v[128:129], v252 offset:26624
    ds_read_b64_tr_b16 v[130:131], v252 offset:27392
    v_mfma_f32_16x16x32_bf16 v[4:7], v[76:79], v[72:75], v[4:7]
    ds_read_b64_tr_b16 v[132:133], v247 offset:26624
    ds_read_b64_tr_b16 v[134:135], v247 offset:27392
    v_mfma_f32_16x16x32_bf16 v[8:11], v[80:83], v[68:71], v[8:11]
    v_mfma_f32_16x16x32_bf16 v[12:15], v[80:83], v[72:75], v[12:15]
    v_mfma_f32_16x16x32_bf16 v[16:19], v[84:87], v[68:71], v[16:19]
    v_mfma_f32_16x16x32_bf16 v[20:23], v[84:87], v[72:75], v[20:23]
    s_waitcnt vmcnt(5) lgkmcnt(0)
    s_barrier
    v_mfma_f32_16x16x32_bf16 v[0:3], v[104:107], v[96:99], v[0:3]
    ds_read_b128 v[48:51], v249 offset:0
    ds_read_b128 v[52:55], v249 offset:2048
    v_mfma_f32_16x16x32_bf16 v[4:7], v[104:107], v[100:103], v[4:7]
    ds_read_b64_tr_b16 v[56:57], v189 offset:0
    ds_read_b64_tr_b16 v[58:59], v189 offset:768
    v_mfma_f32_16x16x32_bf16 v[8:11], v[108:111], v[96:99], v[8:11]
    ds_read_b64_tr_b16 v[60:61], v190 offset:0
    ds_read_b64_tr_b16 v[62:63], v190 offset:768
    v_mfma_f32_16x16x32_bf16 v[12:15], v[108:111], v[100:103], v[12:15]
    ds_read_b64_tr_b16 v[64:65], v191 offset:0
    ds_read_b64_tr_b16 v[66:67], v191 offset:768
    v_mfma_f32_16x16x32_bf16 v[16:19], v[112:115], v[96:99], v[16:19]
    ds_read_b128 v[68:71], v250 offset:0
    ds_read_b128 v[72:75], v250 offset:2048
    v_mfma_f32_16x16x32_bf16 v[20:23], v[112:115], v[100:103], v[20:23]
    ds_read_b64_tr_b16 v[76:77], v189 offset:6144
    ds_read_b64_tr_b16 v[78:79], v189 offset:6912
    v_mfma_f32_16x16x32_bf16 v[0:3], v[124:127], v[116:119], v[0:3]
    ds_read_b64_tr_b16 v[80:81], v190 offset:6144
    ds_read_b64_tr_b16 v[82:83], v190 offset:6912
    v_mfma_f32_16x16x32_bf16 v[4:7], v[124:127], v[120:123], v[4:7]
    ds_read_b64_tr_b16 v[84:85], v191 offset:6144
    ds_read_b64_tr_b16 v[86:87], v191 offset:6912
    v_mfma_f32_16x16x32_bf16 v[8:11], v[128:131], v[116:119], v[8:11]
    v_mfma_f32_16x16x32_bf16 v[12:15], v[128:131], v[120:123], v[12:15]
    v_mfma_f32_16x16x32_bf16 v[16:19], v[132:135], v[116:119], v[16:19]
    v_mfma_f32_16x16x32_bf16 v[20:23], v[132:135], v[120:123], v[20:23]
    s_mul_i32 s72, s61, 52
    s_lshr_b32 s72, s72, 8
    s_mul_i32 s72, s72, 5
    s_sub_u32 s72, s61, s72
    s_mul_i32 s64, s72, 32256
    s_lshl_b32 s65, s38, 13
    s_add_u32 s69, s65, 49152
    s_add_u32 s65, s65, 5376
    s_lshl_b32 s68, s69, 1
    s_sub_u32 s68, s68, 0x8000
    s_and_b32 s72, s61, 1
    s_mul_i32 s73, s72, 166656
    s_sub_u32 s67, 166656, s73
    s_waitcnt vmcnt(0)
    s_cmp_lg_u32 s38, 0
    s_cbranch_scc1 L_w0_try
    v_bitop3_b32 v44, v32, v33, v34 bitop3:0x80
    v_and_b32 v44, v44, v35
    v_cmp_eq_u32 vcc, 0, v44
    v_mov_b32_e64 v42, 0
    s_cbranch_vccnz L_q_flg3
    s_lshl_b32 s72, s60, 5
    s_add_u32 s72, s72, s61
    s_lshl_b32 s72, s72, 5
    s_add_u32 s72, s72, 8192
    s_mov_b64 exec, 1
    buffer_store_dword v44, v45, s[52:55], s72 offen sc1
    s_mov_b64 exec, -1
    v_max3_u32 v42, v32, v33, v34
    v_max_u32 v42, v42, v35
    s_nop 1
    v_max_u32_dpp v42, v42, v42 row_ror:8 row_mask:0xf bank_mask:0xf
    s_nop 1
    v_max_u32_dpp v42, v42, v42 row_ror:4 row_mask:0xf bank_mask:0xf
    s_nop 1
    v_max_u32_dpp v42, v42, v42 row_ror:2 row_mask:0xf bank_mask:0xf
    s_nop 1
    v_max_u32_dpp v42, v42, v42 row_ror:1 row_mask:0xf bank_mask:0xf
    v_mov_b32 v43, v42
    s_nop 1
    v_permlane16_swap_b32 v42, v43
    v_max_u32 v42, v42, v43
    v_mov_b32 v43, v42
    s_nop 1
    v_permlane32_swap_b32 v42, v43
    v_max_u32 v42, v42, v43
L_q_flg3:
    ds_write_b32 v46, v42
L_w0_try:
    s_waitcnt lgkmcnt(0)
    s_barrier
    s_nop 0
    ds_read_b32 v47, v46
    v_mfma_f32_16x16x32_bf16 v[0:3], v[56:59], v[48:51], v[0:3]
    ds_read_b128 v[96:99], v249 offset:20480
    ds_read_b128 v[100:103], v249 offset:22528
    v_mfma_f32_16x16x32_bf16 v[4:7], v[56:59], v[52:55], v[4:7]
    ds_read_b64_tr_b16 v[104:105], v189 offset:20480
    ds_read_b64_tr_b16 v[106:107], v189 offset:21248
    s_waitcnt lgkmcnt(4)
    v_readfirstlane_b32 s66, v47
    s_nop 0
    s_cmp_eq_u32 s66, 0
    s_cbranch_scc1 L_q_notyet
    s_nop 0
    v_mfma_f32_16x16x32_bf16 v[8:11], v[60:63], v[48:51], v[8:11]
    ds_read_b64_tr_b16 v[108:109], v190 offset:20480
    ds_read_b64_tr_b16 v[110:111], v190 offset:21248
    s_mul_i32 s72, s38, 1344
    s_add_u32 m0, s72, 41216
    s_add_u32 s73, s73, s72
    s_nop 0
    buffer_load_dwordx4 v248, s[48:51], s73 offen sc1 lds
    v_mfma_f32_16x16x32_bf16 v[12:15], v[60:63], v[52:55], v[12:15]
    ds_read_b64_tr_b16 v[112:113], v191 offset:20480
    ds_read_b64_tr_b16 v[114:115], v191 offset:21248
    s_mov_b64 exec, 0xfffff
    buffer_load_dwordx4 v248, s[48:51], s73 offen offset:1024 sc1 lds
    s_mov_b64 exec, -1
    s_nop 0
    v_mfma_f32_16x16x32_bf16 v[16:19], v[64:67], v[48:51], v[16:19]
    ds_read_b128 v[116:119], v250 offset:20480
    ds_read_b128 v[120:123], v250 offset:22528
    s_mov_b32 m0, s69
    s_add_u32 s71, s64, s65
    buffer_load_dwordx4 v248, s[48:51], s71 offen sc1 lds
    v_mfma_f32_16x16x32_bf16 v[20:23], v[64:67], v[52:55], v[20:23]
    ds_read_b64_tr_b16 v[124:125], v189 offset:26624
    ds_read_b64_tr_b16 v[126:127], v189 offset:27392
    buffer_load_dwordx4 v248, s[48:51], s71 offen offset:1024 sc1 lds
    v_mfma_f32_16x16x32_bf16 v[0:3], v[76:79], v[68:71], v[0:3]
    ds_read_b64_tr_b16 v[128:129], v190 offset:26624
    ds_read_b64_tr_b16 v[130:131], v190 offset:27392
    buffer_load_dwordx4 v248, s[48:51], s71 offen offset:2048 sc1 lds
    v_mfma_f32_16x16x32_bf16 v[4:7], v[76:79], v[72:75], v[4:7]
    ds_read_b64_tr_b16 v[132:133], v191 offset:26624
    ds_read_b64_tr_b16 v[134:135], v191 offset:27392
    buffer_load_dwordx4 v248, s[48:51], s71 offen offset:3072 sc1 lds
    v_mfma_f32_16x16x32_bf16 v[8:11], v[80:83], v[68:71], v[8:11]
    s_add_u32 m0, s69, 4096
    s_add_u32 s71, s71, 4096
    buffer_load_dwordx4 v248, s[48:51], s71 offen sc1 lds
    v_mfma_f32_16x16x32_bf16 v[12:15], v[80:83], v[72:75], v[12:15]
    buffer_load_dwordx4 v248, s[48:51], s71 offen offset:1024 sc1 lds
    v_mfma_f32_16x16x32_bf16 v[16:19], v[84:87], v[68:71], v[16:19]
    buffer_load_dwordx4 v248, s[48:51], s71 offen offset:2048 sc1 lds
    v_mfma_f32_16x16x32_bf16 v[20:23], v[84:87], v[72:75], v[20:23]
    buffer_load_dwordx4 v248, s[48:51], s71 offen offset:3072 sc1 lds
    s_branch L_q_rest
L_q_notyet:
    s_nop 0
    v_mfma_f32_16x16x32_bf16 v[8:11], v[60:63], v[48:51], v[8:11]
    ds_read_b64_tr_b16 v[108:109], v190 offset:20480
    ds_read_b64_tr_b16 v[110:111], v190 offset:21248
    v_mfma_f32_16x16x32_bf16 v[12:15], v[60:63], v[52:55], v[12:15]
    ds_read_b64_tr_b16 v[112:113], v191 offset:20480
    ds_read_b64_tr_b16 v[114:115], v191 offset:21248
    v_mfma_f32_16x16x32_bf16 v[16:19], v[64:67], v[48:51], v[16:19]
    ds_read_b128 v[116:119], v250 offset:20480
    ds_read_b128 v[120:123], v250 offset:22528
    v_mfma_f32_16x16x32_bf16 v[20:23], v[64:67], v[52:55], v[20:23]
    ds_read_b64_tr_b16 v[124:125], v189 offset:26624
    ds_read_b64_tr_b16 v[126:127], v189 offset:27392
    v_mfma_f32_16x16x32_bf16 v[0:3], v[76:79], v[68:71], v[0:3]
    ds_read_b64_tr_b16 v[128:129], v190 offset:26624
    ds_read_b64_tr_b16 v[130:131], v190 offset:27392
    v_mfma_f32_16x16x32_bf16 v[4:7], v[76:79], v[72:75], v[4:7]
    ds_read_b64_tr_b16 v[132:133], v191 offset:26624
    ds_read_b64_tr_b16 v[134:135], v191 offset:27392
    v_mfma_f32_16x16x32_bf16 v[8:11], v[80:83], v[68:71], v[8:11]
    v_mfma_f32_16x16x32_bf16 v[12:15], v[80:83], v[72:75], v[12:15]
    v_mfma_f32_16x16x32_bf16 v[16:19], v[84:87], v[68:71], v[16:19]
    v_mfma_f32_16x16x32_bf16 v[20:23], v[84:87], v[72:75], v[20:23]
L_q_rest:
    s_add_u32 s72, s66, s38
    s_cmp_lg_u32 s72, 0
    s_cbranch_scc1 L_q_noagain
    buffer_load_dwordx4 v[32:35], v40, s[52:55], 0 offen sc1
L_q_noagain:
    s_waitcnt lgkmcnt(0)
    s_and_b32 s70, s38, 1
    s_lshl_b32 s72, s62, 1
    s_add_u32 s70, s70, s72
    s_mul_i32 s70, s70, 40960
    s_lshr_b32 s72, s38, 1
    s_lshl_b32 s39, s63, 1
    s_add_u32 s72, s72, s39
    s_mul_i32 s72, s72, 1280
    s_add_u32 s70, s70, s72
    s_add_u32 s70, s70, 1572864
    v_mfma_f32_16x16x32_bf16 v[0:3], v[104:107], v[96:99], v[0:3]
    v_mov_b64 v[48:49], 0
    v_mov_b64 v[50:51], 0
    v_mfma_f32_16x16x32_bf16 v[4:7], v[104:107], v[100:103], v[4:7]
    v_mov_b64 v[52:53], 0
    v_mov_b64 v[54:55], 0
    v_mfma_f32_16x16x32_bf16 v[8:11], v[108:111], v[96:99], v[8:11]
    v_mov_b64 v[56:57], 0
    v_mov_b64 v[58:59], 0
    v_mfma_f32_16x16x32_bf16 v[12:15], v[108:111], v[100:103], v[12:15]
    v_mov_b64 v[60:61], 0
    v_mov_b64 v[62:63], 0
    v_mfma_f32_16x16x32_bf16 v[16:19], v[112:115], v[96:99], v[16:19]
    v_mov_b64 v[64:65], 0
    v_mov_b64 v[66:67], 0
    v_mfma_f32_16x16x32_bf16 v[20:23], v[112:115], v[100:103], v[20:23]
    v_mov_b64 v[68:69], 0
    v_mov_b64 v[70:71], 0
    v_mfma_f32_16x16x32_bf16 v[0:3], v[124:127], v[116:119], v[0:3]
    v_mov_b64 v[72:73], 0
    v_mov_b64 v[74:75], 0
    v_mfma_f32_16x16x32_bf16 v[4:7], v[124:127], v[120:123], v[4:7]
    v_mov_b64 v[76:77], 0
    v_mov_b64 v[78:79], 0
    v_mfma_f32_16x16x32_bf16 v[8:11], v[128:131], v[116:119], v[8:11]
    v_mov_b64 v[80:81], 0
    v_mov_b64 v[82:83], 0
    v_mfma_f32_16x16x32_bf16 v[12:15], v[128:131], v[120:123], v[12:15]
    v_mov_b64 v[84:85], 0
    v_mov_b64 v[86:87], 0
    v_mfma_f32_16x16x32_bf16 v[16:19], v[132:135], v[116:119], v[16:19]
    v_mov_b64 v[88:89], 0
    v_mov_b64 v[90:91], 0
    v_mfma_f32_16x16x32_bf16 v[20:23], v[132:135], v[120:123], v[20:23]
    v_mov_b64 v[92:93], 0
    v_mov_b64 v[94:95], 0
    v_cmp_lt_u32 vcc, 31, v255
    v_mov_b32 v137, 0
    v_mov_b32 v138, 0
    v_mov_b32 v141, 0
    v_mov_b32 v142, 0
    v_pk_mul_f32 v[0:1], v[0:1], v[36:37]
    v_pk_mul_f32 v[2:3], v[2:3], v[36:37]
    v_pk_mul_f32 v[4:5], v[4:5], v[36:37]
    v_pk_mul_f32 v[6:7], v[6:7], v[36:37]
    v_pk_mul_f32 v[8:9], v[8:9], v[36:37]
    v_pk_mul_f32 v[10:11], v[10:11], v[36:37]
    v_pk_mul_f32 v[12:13], v[12:13], v[36:37]
    v_pk_mul_f32 v[14:15], v[14:15], v[36:37]
    v_pk_mul_f32 v[16:17], v[16:17], v[36:37]
    v_pk_mul_f32 v[18:19], v[18:19], v[36:37]
    v_pk_mul_f32 v[20:21], v[20:21], v[36:37]
    v_pk_mul_f32 v[22:23], v[22:23], v[36:37]
    v_cvt_pk_bf16_f32 v128, v0, v1
    v_cvt_pk_bf16_f32 v129, v2, v3
    v_cvt_pk_bf16_f32 v130, v4, v5
    v_cvt_pk_bf16_f32 v131, v6, v7
    v_cvt_pk_bf16_f32 v132, v8, v9
    v_cvt_pk_bf16_f32 v133, v10, v11
    v_cvt_pk_bf16_f32 v134, v12, v13
    v_cvt_pk_bf16_f32 v135, v14, v15
    v_cvt_pk_bf16_f32 v24, v16, v17
    v_cvt_pk_bf16_f32 v25, v18, v19
    v_cvt_pk_bf16_f32 v26, v20, v21
    v_cvt_pk_bf16_f32 v27, v22, v23
    v_permlane16_swap_b32 v128, v130
    v_permlane16_swap_b32 v129, v131
    v_permlane16_swap_b32 v132, v134
    v_permlane16_swap_b32 v133, v135
    v_permlane16_swap_b32 v24, v26
    v_permlane16_swap_b32 v25, v27
    v_cndmask_b32 v136, v24, v25, vcc
    v_cndmask_b32 v139, v24, v25, vcc
    v_cndmask_b32 v140, v26, v27, vcc
    v_cndmask_b32 v143, v26, v27, vcc
    v_dot2_f32_bf16 v184, v128, v128, 0
    v_dot2_f32_bf16 v185, v132, v132, 0
    v_dot2_f32_bf16 v184, v129, v129, v184
    v_dot2_f32_bf16 v185, v133, v133, v185
    v_dot2_f32_bf16 v184, v130, v130, v184
    v_dot2_f32_bf16 v185, v134, v134, v185
    v_dot2_f32_bf16 v184, v131, v131, v184
    v_dot2_f32_bf16 v185, v135, v135, v185
    v_dot2_f32_bf16 v184, v136, v136, v184
    v_dot2_f32_bf16 v185, v140, v140, v185
    s_nop 2
    v_permlane32_swap_b32 v184, v185
    v_add_f32_e64 v184, v184, v185
    s_cmp_lg_u32 s66, 0
    s_cbranch_scc1 L_q_loaded
    s_cmp_lg_u32 s38, 0
    s_cbranch_scc1 L_w0_kvw
    s_mov_b32 s39, 40000
L_poll_23:
    s_waitcnt vmcnt(0)
    v_bitop3_b32 v44, v32, v33, v34 bitop3:0x80
    v_and_b32 v44, v44, v35
    v_cmp_eq_u32 vcc, 0, v44
    s_cbranch_vccz L_polled_24
    s_sub_u32 s39, s39, 1
    s_cbranch_scc1 L_polled_24
    buffer_load_dwordx4 v[32:35], v40, s[52:55], 0 offen sc1
    s_branch L_poll_23
L_polled_24:
    s_lshl_b32 s72, s60, 5
    s_add_u32 s72, s72, s61
    s_lshl_b32 s72, s72, 5
    s_add_u32 s72, s72, 8192
    s_mov_b64 exec, 1
    buffer_store_dword v44, v45, s[52:55], s72 offen sc1
    s_mov_b64 exec, -1
    v_max3_u32 v42, v32, v33, v34
    v_max_u32 v42, v42, v35
    s_nop 1
    v_max_u32_dpp v42, v42, v42 row_ror:8 row_mask:0xf bank_mask:0xf
    s_nop 1
    v_max_u32_dpp v42, v42, v42 row_ror:4 row_mask:0xf bank_mask:0xf
    s_nop 1
    v_max_u32_dpp v42, v42, v42 row_ror:2 row_mask:0xf bank_mask:0xf
    s_nop 1
    v_max_u32_dpp v42, v42, v42 row_ror:1 row_mask:0xf bank_mask:0xf
    v_mov_b32 v43, v42
    s_nop 1
    v_permlane16_swap_b32 v42, v43
    v_max_u32 v42, v42, v43
    v_mov_b32 v43, v42
    s_nop 1
    v_permlane32_swap_b32 v42, v43
    v_max_u32_e64 v42, v42, v43
    ds_write_b32 v46, v42 offset:4
L_w0_kvw:
    s_waitcnt lgkmcnt(0)
    s_barrier
    s_mul_i32 s72, s38, 1344
    s_add_u32 m0, s72, 41216
    s_add_u32 s73, s73, s72
    s_nop 0
    buffer_load_dwordx4 v248, s[48:51], s73 offen sc1 lds
    s_mov_b64 exec, 0xfffff
    buffer_load_dwordx4 v248, s[48:51], s73 offen offset:1024 sc1 lds
    s_mov_b64 exec, -1
    s_mov_b32 m0, s69
    s_add_u32 s71, s64, s65
    s_nop 0
    buffer_load_dwordx4 v248, s[48:51], s71 offen sc1 lds
    buffer_load_dwordx4 v248, s[48:51], s71 offen offset:1024 sc1 lds
    buffer_load_dwordx4 v248, s[48:51], s71 offen offset:2048 sc1 lds
    buffer_load_dwordx4 v248, s[48:51], s71 offen offset:3072 sc1 lds
    s_add_u32 m0, s69, 4096
    s_add_u32 s71, s71, 4096
    buffer_load_dwordx4 v248, s[48:51], s71 offen sc1 lds
    buffer_load_dwordx4 v248, s[48:51], s71 offen offset:1024 sc1 lds
    buffer_load_dwordx4 v248, s[48:51], s71 offen offset:2048 sc1 lds
    buffer_load_dwordx4 v248, s[48:51], s71 offen offset:3072 sc1 lds
    ds_read_b32 v47, v46 offset:4
L_q_loaded:
    s_mov_b32 s72, 0x45800000
    s_waitcnt vmcnt(8) lgkmcnt(0)
    s_barrier
    ds_read_b128 v[144:147], v248 offset:41216
    ds_read2st64_b32 v[154:155], v244 offset0:169 offset1:170
    ds_read_b128 v[148:151], v248 offset:42240
    ds_read_b128 v[164:167], v245 offset:41216
    ds_read_b128 v[168:171], v245 offset:41920
    ds_read_b128 v[172:175], v245 offset:42624
    ds_read_b128 v[176:179], v245 offset:43328
    v_mul_f32 v47, v47, v184
    s_setprio 2
    v_cmp_nle_f32 vcc, v47, s72
    s_mov_b32 s66, 0
    s_cbranch_vccnz L_rowmax
    s_waitcnt lgkmcnt(5)
    v_mfma_f32_32x32x16_bf16 v[0:15], v[144:147], v[128:131], 0
    v_mfma_f32_32x32x8_bf16 v[0:15], v[154:155], v[136:137], v[0:15]
    v_mfma_f32_32x32x16_bf16 v[16:31], v[144:147], v[132:135], 0
    v_mfma_f32_32x32x8_bf16 v[16:31], v[154:155], v[140:141], v[16:31]
    s_nop 4
    s_waitcnt vmcnt(0) lgkmcnt(0)
    s_barrier
    s_branch L_a_p0f
.p2align 6
L_a_loopf:
    s_waitcnt vmcnt(0) lgkmcnt(0)
    s_barrier
    v_exp_f32 v59, v59
    v_exp_f32 v60, v60
    v_exp_f32 v61, v61
    v_exp_f32 v62, v62
    v_exp_f32 v63, v63
    v_xor_b32 v181, 0x8000, v181
    v_xor_b32 v182, 0x8000, v182
    v_xor_b32 v183, 0x8000, v183
L_a_p0f:
    v_mfma_f32_32x32x16_bf16 v[32:47], v[148:151], v[128:131], 0
    ds_read_b128 v[144:147], v181 offset:0
    v_exp_f32 v0, v0
    v_exp_f32 v1, v1
    v_exp_f32 v2, v2
    v_smfmac_f32_32x32x32_bf16 v[80:95], v[156:159], v[48:55], v180
    ds_read2st64_b32 v[152:153], v182 offset0:8 offset1:9
    v_exp_f32 v3, v3
    v_exp_f32 v4, v4
    v_exp_f32 v5, v5
    v_exp_f32 v6, v6
    v_mfma_f32_32x32x8_bf16 v[32:47], v[154:155], v[138:139], v[32:47]
    v_exp_f32 v7, v7
    v_exp_f32 v8, v8
    v_exp_f32 v9, v9
    v_exp_f32 v10, v10
    v_smfmac_f32_32x32x32_bf16 v[80:95], v[160:163], v[56:63], v180
    s_sub_u32 s69, s68, s69
    s_add_u32 s64, s64, 32256
    v_exp_f32 v11, v11
    v_exp_f32 v12, v12
    v_exp_f32 v13, v13
    v_exp_f32 v14, v14
    v_exp_f32 v15, v15
    v_mfma_f32_32x32x16_bf16 v[48:63], v[148:151], v[132:135], 0
    ds_read_b128 v[156:159], v183 offset:2560
    s_cmp_eq_u32 s64, 161280
    v_exp_f32 v16, v16
    v_exp_f32 v17, v17
    v_exp_f32 v18, v18
    v_smfmac_f32_32x32x32_bf16 v[64:79], v[164:167], v[0:7], v180
    ds_read_b128 v[160:163], v183 offset:3264
    s_cselect_b32 s64, 0, s64
    s_add_u32 s71, s64, s65
    v_exp_f32 v19, v19
    v_exp_f32 v20, v20
    v_exp_f32 v21, v21
    v_exp_f32 v22, v22
    v_mfma_f32_32x32x8_bf16 v[48:63], v[154:155], v[142:143], v[48:63]
    v_exp_f32 v23, v23
    v_exp_f32 v24, v24
    v_exp_f32 v25, v25
    v_exp_f32 v26, v26
    v_smfmac_f32_32x32x32_bf16 v[64:79], v[168:171], v[8:15], v180
    s_waitcnt lgkmcnt(2)
    s_mov_b32 m0, s69
    v_exp_f32 v27, v27
    v_exp_f32 v28, v28
    v_exp_f32 v29, v29
    v_exp_f32 v30, v30
    v_exp_f32 v31, v31
    v_mfma_f32_32x32x16_bf16 v[0:15], v[144:147], v[128:131], 0
    ds_read_b128 v[148:151], v181 offset:1024
    v_exp_f32 v32, v32
    v_exp_f32 v33, v33
    v_exp_f32 v34, v34
    v_smfmac_f32_32x32x32_bf16 v[80:95], v[164:167], v[16:23], v180
    v_exp_f32 v35, v35
    v_exp_f32 v36, v36
    v_exp_f32 v37, v37
    v_exp_f32 v38, v38
    v_mfma_f32_32x32x8_bf16 v[0:15], v[152:153], v[136:137], v[0:15]
    v_exp_f32 v39, v39
    v_exp_f32 v40, v40
    v_exp_f32 v41, v41
    v_exp_f32 v42, v42
    v_smfmac_f32_32x32x32_bf16 v[80:95], v[168:171], v[24:31], v180
    buffer_load_dwordx4 v248, s[48:51], s71 offen sc1 lds
    v_exp_f32 v43, v43
    v_exp_f32 v44, v44
    v_exp_f32 v45, v45
    v_exp_f32 v46, v46
    v_exp_f32 v47, v47
    v_mfma_f32_32x32x16_bf16 v[16:31], v[144:147], v[132:135], 0
    ds_read_b128 v[164:167], v183 offset:3968
    v_exp_f32 v48, v48
    v_exp_f32 v49, v49
    v_exp_f32 v50, v50
    v_smfmac_f32_32x32x32_bf16 v[64:79], v[172:175], v[32:39], v180
    ds_read_b128 v[168:171], v183 offset:4672
    v_exp_f32 v51, v51
    v_exp_f32 v52, v52
    v_exp_f32 v53, v53
    v_exp_f32 v54, v54
    v_mfma_f32_32x32x8_bf16 v[16:31], v[152:153], v[140:141], v[16:31]
    v_exp_f32 v55, v55
    v_exp_f32 v56, v56
    v_exp_f32 v57, v57
    v_exp_f32 v58, v58
    v_smfmac_f32_32x32x32_bf16 v[64:79], v[176:179], v[40:47], v180
    s_waitcnt lgkmcnt(2)
    v_exp_f32 v59, v59
    v_exp_f32 v60, v60
    v_exp_f32 v61, v61
    v_exp_f32 v62, v62
    v_exp_f32 v63, v63
    v_mfma_f32_32x32x16_bf16 v[32:47], v[148:151], v[128:131], 0
    ds_read_b128 v[144:147], v181 offset:5376
    v_exp_f32 v0, v0
    v_exp_f32 v1, v1
    v_exp_f32 v2, v2
    v_smfmac_f32_32x32x32_bf16 v[80:95], v[172:175], v[48:55], v180
    ds_read2st64_b32 v[154:155], v182 offset0:29 offset1:30
    v_exp_f32 v3, v3
    v_exp_f32 v4, v4
    v_exp_f32 v5, v5
    v_exp_f32 v6, v6
    v_mfma_f32_32x32x8_bf16 v[32:47], v[152:153], v[138:139], v[32:47]
    v_exp_f32 v7, v7
    v_exp_f32 v8, v8
    v_exp_f32 v9, v9
    v_exp_f32 v10, v10
    v_smfmac_f32_32x32x32_bf16 v[80:95], v[176:179], v[56:63], v180
    buffer_load_dwordx4 v248, s[48:51], s71 offen offset:1024 sc1 lds
    v_exp_f32 v11, v11
    v_exp_f32 v12, v12
    v_exp_f32 v13, v13
    v_exp_f32 v14, v14
    v_exp_f32 v15, v15
    v_mfma_f32_32x32x16_bf16 v[48:63], v[148:151], v[132:135], 0
    ds_read_b128 v[172:175], v183 offset:7936
    v_exp_f32 v16, v16
    v_exp_f32 v17, v17
    v_exp_f32 v18, v18
    v_smfmac_f32_32x32x32_bf16 v[64:79], v[156:159], v[0:7], v180
    ds_read_b128 v[176:179], v183 offset:8640
    v_exp_f32 v19, v19
    v_exp_f32 v20, v20
    v_exp_f32 v21, v21
    v_exp_f32 v22, v22
    v_mfma_f32_32x32x8_bf16 v[48:63], v[152:153], v[142:143], v[48:63]
    v_exp_f32 v23, v23
    v_exp_f32 v24, v24
    v_exp_f32 v25, v25
    v_exp_f32 v26, v26
    v_smfmac_f32_32x32x32_bf16 v[64:79], v[160:163], v[8:15], v180
    s_waitcnt lgkmcnt(2)
    v_exp_f32 v27, v27
    v_exp_f32 v28, v28
    v_exp_f32 v29, v29
    v_exp_f32 v30, v30
    v_exp_f32 v31, v31
    v_mfma_f32_32x32x16_bf16 v[0:15], v[144:147], v[128:131], 0
    ds_read_b128 v[148:151], v181 offset:6400
    v_exp_f32 v32, v32
    v_exp_f32 v33, v33
    v_exp_f32 v34, v34
    v_smfmac_f32_32x32x32_bf16 v[80:95], v[156:159], v[16:23], v180
    v_exp_f32 v35, v35
    v_exp_f32 v36, v36
    v_exp_f32 v37, v37
    v_exp_f32 v38, v38
    v_mfma_f32_32x32x8_bf16 v[0:15], v[154:155], v[136:137], v[0:15]
    v_exp_f32 v39, v39
    v_exp_f32 v40, v40
    v_exp_f32 v41, v41
    v_exp_f32 v42, v42
    v_smfmac_f32_32x32x32_bf16 v[80:95], v[160:163], v[24:31], v180
    buffer_load_dwordx4 v248, s[48:51], s71 offen offset:2048 sc1 lds
    v_exp_f32 v43, v43
    v_exp_f32 v44, v44
    v_exp_f32 v45, v45
    v_exp_f32 v46, v46
    v_exp_f32 v47, v47
    v_mfma_f32_32x32x16_bf16 v[16:31], v[144:147], v[132:135], 0
    ds_read_b128 v[156:159], v183 offset:9344
    v_exp_f32 v48, v48
    v_exp_f32 v49, v49
    v_exp_f32 v50, v50
    v_smfmac_f32_32x32x32_bf16 v[64:79], v[164:167], v[32:39], v180
    ds_read_b128 v[160:163], v183 offset:10048
    v_exp_f32 v51, v51
    v_exp_f32 v52, v52
    v_exp_f32 v53, v53
    v_exp_f32 v54, v54
    v_mfma_f32_32x32x8_bf16 v[16:31], v[154:155], v[140:141], v[16:31]
    v_exp_f32 v55, v55
    v_exp_f32 v56, v56
    v_exp_f32 v57, v57
    v_exp_f32 v58, v58
    v_smfmac_f32_32x32x32_bf16 v[64:79], v[168:171], v[40:47], v180
    s_waitcnt lgkmcnt(2)
    v_exp_f32 v59, v59
    v_exp_f32 v60, v60
    v_exp_f32 v61, v61
    v_exp_f32 v62, v62
    v_exp_f32 v63, v63
    v_mfma_f32_32x32x16_bf16 v[32:47], v[148:151], v[128:131], 0
    ds_read_b128 v[144:147], v181 offset:10752
    v_exp_f32 v0, v0
    v_exp_f32 v1, v1
    v_exp_f32 v2, v2
    v_smfmac_f32_32x32x32_bf16 v[80:95], v[164:167], v[48:55], v180
    ds_read2st64_b32 v[152:153], v182 offset0:50 offset1:51
    v_exp_f32 v3, v3
    v_exp_f32 v4, v4
    v_exp_f32 v5, v5
    v_exp_f32 v6, v6
    v_mfma_f32_32x32x8_bf16 v[32:47], v[154:155], v[138:139], v[32:47]
    v_exp_f32 v7, v7
    v_exp_f32 v8, v8
    v_exp_f32 v9, v9
    v_exp_f32 v10, v10
    v_smfmac_f32_32x32x32_bf16 v[80:95], v[168:171], v[56:63], v180
    buffer_load_dwordx4 v248, s[48:51], s71 offen offset:3072 sc1 lds
    v_exp_f32 v11, v11
    v_exp_f32 v12, v12
    v_exp_f32 v13, v13
    v_exp_f32 v14, v14
    v_exp_f32 v15, v15
    v_mfma_f32_32x32x16_bf16 v[48:63], v[148:151], v[132:135], 0
    ds_read_b128 v[164:167], v183 offset:13312
    v_exp_f32 v16, v16
    v_exp_f32 v17, v17
    v_exp_f32 v18, v18
    v_smfmac_f32_32x32x32_bf16 v[64:79], v[172:175], v[0:7], v180
    ds_read_b128 v[168:171], v183 offset:14016
    s_add_u32 s71, s71, 4096
    v_exp_f32 v19, v19
    v_exp_f32 v20, v20
    v_exp_f32 v21, v21
    v_exp_f32 v22, v22
    v_mfma_f32_32x32x8_bf16 v[48:63], v[154:155], v[142:143], v[48:63]
    v_exp_f32 v23, v23
    v_exp_f32 v24, v24
    v_exp_f32 v25, v25
    v_exp_f32 v26, v26
    v_smfmac_f32_32x32x32_bf16 v[64:79], v[176:179], v[8:15], v180
    s_waitcnt lgkmcnt(2)
    s_add_u32 m0, s69, 4096
    v_exp_f32 v27, v27
    v_exp_f32 v28, v28
    v_exp_f32 v29, v29
    v_exp_f32 v30, v30
    v_exp_f32 v31, v31
    v_mfma_f32_32x32x16_bf16 v[0:15], v[144:147], v[128:131], 0
    ds_read_b128 v[148:151], v181 offset:11776
    v_exp_f32 v32, v32
    v_exp_f32 v33, v33
    v_exp_f32 v34, v34
    v_smfmac_f32_32x32x32_bf16 v[80:95], v[172:175], v[16:23], v180
    v_exp_f32 v35, v35
    v_exp_f32 v36, v36
    v_exp_f32 v37, v37
    v_exp_f32 v38, v38
    v_mfma_f32_32x32x8_bf16 v[0:15], v[152:153], v[136:137], v[0:15]
    v_exp_f32 v39, v39
    v_exp_f32 v40, v40
    v_exp_f32 v41, v41
    v_exp_f32 v42, v42
    v_smfmac_f32_32x32x32_bf16 v[80:95], v[176:179], v[24:31], v180
    buffer_load_dwordx4 v248, s[48:51], s71 offen sc1 lds
    v_exp_f32 v43, v43
    v_exp_f32 v44, v44
    v_exp_f32 v45, v45
    v_exp_f32 v46, v46
    v_exp_f32 v47, v47
    v_mfma_f32_32x32x16_bf16 v[16:31], v[144:147], v[132:135], 0
    ds_read_b128 v[172:175], v183 offset:14720
    v_exp_f32 v48, v48
    v_exp_f32 v49, v49
    v_exp_f32 v50, v50
    v_smfmac_f32_32x32x32_bf16 v[64:79], v[156:159], v[32:39], v180
    ds_read_b128 v[176:179], v183 offset:15424
    v_exp_f32 v51, v51
    v_exp_f32 v52, v52
    v_exp_f32 v53, v53
    v_exp_f32 v54, v54
    v_mfma_f32_32x32x8_bf16 v[16:31], v[152:153], v[140:141], v[16:31]
    v_exp_f32 v55, v55
    v_exp_f32 v56, v56
    v_exp_f32 v57, v57
    v_exp_f32 v58, v58
    v_smfmac_f32_32x32x32_bf16 v[64:79], v[160:163], v[40:47], v180
    s_waitcnt lgkmcnt(2)
    v_exp_f32 v59, v59
    v_exp_f32 v60, v60
    v_exp_f32 v61, v61
    v_exp_f32 v62, v62
    v_exp_f32 v63, v63
    v_mfma_f32_32x32x16_bf16 v[32:47], v[148:151], v[128:131], 0
    ds_read_b128 v[144:147], v181 offset:16128
    v_exp_f32 v0, v0
    v_exp_f32 v1, v1
    v_exp_f32 v2, v2
    v_smfmac_f32_32x32x32_bf16 v[80:95], v[156:159], v[48:55], v180
    ds_read2st64_b32 v[154:155], v182 offset0:71 offset1:72
    v_exp_f32 v3, v3
    v_exp_f32 v4, v4
    v_exp_f32 v5, v5
    v_exp_f32 v6, v6
    v_mfma_f32_32x32x8_bf16 v[32:47], v[152:153], v[138:139], v[32:47]
    v_exp_f32 v7, v7
    v_exp_f32 v8, v8
    v_exp_f32 v9, v9
    v_exp_f32 v10, v10
    v_smfmac_f32_32x32x32_bf16 v[80:95], v[160:163], v[56:63], v180
    buffer_load_dwordx4 v248, s[48:51], s71 offen offset:1024 sc1 lds
    v_exp_f32 v11, v11
    v_exp_f32 v12, v12
    v_exp_f32 v13, v13
    v_exp_f32 v14, v14
    v_exp_f32 v15, v15
    v_mfma_f32_32x32x16_bf16 v[48:63], v[148:151], v[132:135], 0
    ds_read_b128 v[156:159], v183 offset:18688
    v_exp_f32 v16, v16
    v_exp_f32 v17, v17
    v_exp_f32 v18, v18
    v_smfmac_f32_32x32x32_bf16 v[64:79], v[164:167], v[0:7], v180
    ds_read_b128 v[160:163], v183 offset:19392
    v_exp_f32 v19, v19
    v_exp_f32 v20, v20
    v_exp_f32 v21, v21
    v_exp_f32 v22, v22
    v_mfma_f32_32x32x8_bf16 v[48:63], v[152:153], v[142:143], v[48:63]
    v_exp_f32 v23, v23
    v_exp_f32 v24, v24
    v_exp_f32 v25, v25
    v_exp_f32 v26, v26
    v_smfmac_f32_32x32x32_bf16 v[64:79], v[168:171], v[8:15], v180
    s_waitcnt lgkmcnt(2)
    v_exp_f32 v27, v27
    v_exp_f32 v28, v28
    v_exp_f32 v29, v29
    v_exp_f32 v30, v30
    v_exp_f32 v31, v31
    v_mfma_f32_32x32x16_bf16 v[0:15], v[144:147], v[128:131], 0
    ds_read_b128 v[148:151], v181 offset:17152
    v_exp_f32 v32, v32
    v_exp_f32 v33, v33
    v_exp_f32 v34, v34
    v_smfmac_f32_32x32x32_bf16 v[80:95], v[164:167], v[16:23], v180
    v_exp_f32 v35, v35
    v_exp_f32 v36, v36
    v_exp_f32 v37, v37
    v_exp_f32 v38, v38
    v_mfma_f32_32x32x8_bf16 v[0:15], v[154:155], v[136:137], v[0:15]
    v_exp_f32 v39, v39
    v_exp_f32 v40, v40
    v_exp_f32 v41, v41
    v_exp_f32 v42, v42
    v_smfmac_f32_32x32x32_bf16 v[80:95], v[168:171], v[24:31], v180
    buffer_load_dwordx4 v248, s[48:51], s71 offen offset:2048 sc1 lds
    v_exp_f32 v43, v43
    v_exp_f32 v44, v44
    v_exp_f32 v45, v45
    v_exp_f32 v46, v46
    v_exp_f32 v47, v47
    v_mfma_f32_32x32x16_bf16 v[16:31], v[144:147], v[132:135], 0
    ds_read_b128 v[164:167], v183 offset:20096
    v_exp_f32 v48, v48
    v_exp_f32 v49, v49
    v_exp_f32 v50, v50
    v_smfmac_f32_32x32x32_bf16 v[64:79], v[172:175], v[32:39], v180
    ds_read_b128 v[168:171], v183 offset:20800
    v_exp_f32 v51, v51
    v_exp_f32 v52, v52
    v_exp_f32 v53, v53
    v_exp_f32 v54, v54
    v_mfma_f32_32x32x8_bf16 v[16:31], v[154:155], v[140:141], v[16:31]
    v_exp_f32 v55, v55
    v_exp_f32 v56, v56
    v_exp_f32 v57, v57
    v_exp_f32 v58, v58
    v_smfmac_f32_32x32x32_bf16 v[64:79], v[176:179], v[40:47], v180
    s_waitcnt lgkmcnt(2)
    v_exp_f32 v59, v59
    v_exp_f32 v60, v60
    v_exp_f32 v61, v61
    v_exp_f32 v62, v62
    v_exp_f32 v63, v63
    v_mfma_f32_32x32x16_bf16 v[32:47], v[148:151], v[128:131], 0
    ds_read_b128 v[144:147], v181 offset:21504
    v_exp_f32 v0, v0
    v_exp_f32 v1, v1
    v_exp_f32 v2, v2
    v_smfmac_f32_32x32x32_bf16 v[80:95], v[172:175], v[48:55], v180
    ds_read2st64_b32 v[152:153], v182 offset0:92 offset1:93
    v_exp_f32 v3, v3
    v_exp_f32 v4, v4
    v_exp_f32 v5, v5
    v_exp_f32 v6, v6
    v_mfma_f32_32x32x8_bf16 v[32:47], v[154:155], v[138:139], v[32:47]
    v_exp_f32 v7, v7
    v_exp_f32 v8, v8
    v_exp_f32 v9, v9
    v_exp_f32 v10, v10
    v_smfmac_f32_32x32x32_bf16 v[80:95], v[176:179], v[56:63], v180
    buffer_load_dwordx4 v248, s[48:51], s71 offen offset:3072 sc1 lds
    v_exp_f32 v11, v11
    v_exp_f32 v12, v12
    v_exp_f32 v13, v13
    v_exp_f32 v14, v14
    v_exp_f32 v15, v15
    v_mfma_f32_32x32x16_bf16 v[48:63], v[148:151], v[132:135], 0
    ds_read_b128 v[172:175], v183 offset:24064
    v_exp_f32 v16, v16
    v_exp_f32 v17, v17
    v_exp_f32 v18, v18
    v_smfmac_f32_32x32x32_bf16 v[64:79], v[156:159], v[0:7], v180
    ds_read_b128 v[176:179], v183 offset:24768
    s_cmp_eq_u32 s66, 3
    v_exp_f32 v19, v19
    v_exp_f32 v20, v20
    v_exp_f32 v21, v21
    v_exp_f32 v22, v22
    v_mfma_f32_32x32x8_bf16 v[48:63], v[154:155], v[142:143], v[48:63]
    v_exp_f32 v23, v23
    v_exp_f32 v24, v24
    v_exp_f32 v25, v25
    v_exp_f32 v26, v26
    v_smfmac_f32_32x32x32_bf16 v[64:79], v[160:163], v[8:15], v180
    s_waitcnt lgkmcnt(2)
    s_cselect_b32 s72, 0, 0x7fff0000
    v_exp_f32 v27, v27
    v_exp_f32 v28, v28
    v_exp_f32 v29, v29
    v_exp_f32 v30, v30
    v_exp_f32 v31, v31
    v_mfma_f32_32x32x16_bf16 v[0:15], v[144:147], v[128:131], 0
    ds_read_b128 v[148:151], v181 offset:22528
    v_exp_f32 v32, v32
    v_exp_f32 v33, v33
    v_exp_f32 v34, v34
    v_smfmac_f32_32x32x32_bf16 v[80:95], v[156:159], v[16:23], v180
    v_exp_f32 v35, v35
    v_exp_f32 v36, v36
    v_exp_f32 v37, v37
    v_exp_f32 v38, v38
    v_mfma_f32_32x32x8_bf16 v[0:15], v[152:153], v[136:137], v[0:15]
    v_exp_f32 v39, v39
    v_exp_f32 v40, v40
    v_exp_f32 v41, v41
    v_exp_f32 v42, v42
    v_smfmac_f32_32x32x32_bf16 v[80:95], v[160:163], v[24:31], v180
    buffer_load_dword v194, v193, s[56:59], s72 offen offset:128 sc1
    v_exp_f32 v43, v43
    v_exp_f32 v44, v44
    v_exp_f32 v45, v45
    v_exp_f32 v46, v46
    v_exp_f32 v47, v47
    v_mfma_f32_32x32x16_bf16 v[16:31], v[144:147], v[132:135], 0
    ds_read_b128 v[156:159], v183 offset:25472
    v_exp_f32 v48, v48
    v_exp_f32 v49, v49
    v_exp_f32 v50, v50
    v_smfmac_f32_32x32x32_bf16 v[64:79], v[164:167], v[32:39], v180
    ds_read_b128 v[160:163], v183 offset:26176
    v_exp_f32 v51, v51
    v_exp_f32 v52, v52
    v_exp_f32 v53, v53
    v_exp_f32 v54, v54
    v_mfma_f32_32x32x8_bf16 v[16:31], v[152:153], v[140:141], v[16:31]
    v_exp_f32 v55, v55
    v_exp_f32 v56, v56
    v_exp_f32 v57, v57
    v_exp_f32 v58, v58
    v_smfmac_f32_32x32x32_bf16 v[64:79], v[168:171], v[40:47], v180
    s_waitcnt lgkmcnt(2)
    v_exp_f32 v59, v59
    v_exp_f32 v60, v60
    v_exp_f32 v61, v61
    v_exp_f32 v62, v62
    v_exp_f32 v63, v63
    v_mfma_f32_32x32x16_bf16 v[32:47], v[148:151], v[128:131], 0
    ds_read_b128 v[144:147], v181 offset:26880
    v_exp_f32 v0, v0
    v_exp_f32 v1, v1
    v_exp_f32 v2, v2
    v_smfmac_f32_32x32x32_bf16 v[80:95], v[164:167], v[48:55], v180
    ds_read2st64_b32 v[154:155], v182 offset0:113 offset1:114
    v_exp_f32 v3, v3
    v_exp_f32 v4, v4
    v_exp_f32 v5, v5
    v_exp_f32 v6, v6
    v_mfma_f32_32x32x8_bf16 v[32:47], v[152:153], v[138:139], v[32:47]
    v_exp_f32 v7, v7
    v_exp_f32 v8, v8
    v_exp_f32 v9, v9
    v_exp_f32 v10, v10
    v_smfmac_f32_32x32x32_bf16 v[80:95], v[168:171], v[56:63], v180
    v_exp_f32 v11, v11
    v_exp_f32 v12, v12
    v_exp_f32 v13, v13
    v_exp_f32 v14, v14
    v_exp_f32 v15, v15
    v_mfma_f32_32x32x16_bf16 v[48:63], v[148:151], v[132:135], 0
    ds_read_b128 v[164:167], v183 offset:29440
    v_exp_f32 v16, v16
    v_exp_f32 v17, v17
    v_exp_f32 v18, v18
    v_smfmac_f32_32x32x32_bf16 v[64:79], v[172:175], v[0:7], v180
    ds_read_b128 v[168:171], v183 offset:30144
    v_exp_f32 v19, v19
    v_exp_f32 v20, v20
    v_exp_f32 v21, v21
    v_exp_f32 v22, v22
    v_mfma_f32_32x32x8_bf16 v[48:63], v[152:153], v[142:143], v[48:63]
    v_exp_f32 v23, v23
    v_exp_f32 v24, v24
    v_exp_f32 v25, v25
    v_exp_f32 v26, v26
    v_smfmac_f32_32x32x32_bf16 v[64:79], v[176:179], v[8:15], v180
    s_waitcnt lgkmcnt(2)
    v_exp_f32 v27, v27
    v_exp_f32 v28, v28
    v_exp_f32 v29, v29
    v_exp_f32 v30, v30
    v_exp_f32 v31, v31
    v_mfma_f32_32x32x16_bf16 v[0:15], v[144:147], v[128:131], 0
    ds_read_b128 v[148:151], v181 offset:27904
    v_exp_f32 v32, v32
    v_exp_f32 v33, v33
    v_exp_f32 v34, v34
    v_smfmac_f32_32x32x32_bf16 v[80:95], v[172:175], v[16:23], v180
    s_add_u32 s66, s66, 1
    s_cmp_lt_u32 s66, 4
    v_exp_f32 v35, v35
    v_exp_f32 v36, v36
    v_exp_f32 v37, v37
    v_exp_f32 v38, v38
    v_mfma_f32_32x32x8_bf16 v[0:15], v[154:155], v[136:137], v[0:15]
    v_exp_f32 v39, v39
    v_exp_f32 v40, v40
    v_exp_f32 v41, v41
    v_exp_f32 v42, v42
    v_smfmac_f32_32x32x32_bf16 v[80:95], v[176:179], v[24:31], v180
    v_exp_f32 v43, v43
    v_exp_f32 v44, v44
    v_exp_f32 v45, v45
    v_exp_f32 v46, v46
    v_exp_f32 v47, v47
    v_mfma_f32_32x32x16_bf16 v[16:31], v[144:147], v[132:135], 0
    ds_read_b128 v[172:175], v183 offset:30848
    v_exp_f32 v48, v48
    v_exp_f32 v49, v49
    v_exp_f32 v50, v50
    v_smfmac_f32_32x32x32_bf16 v[64:79], v[156:159], v[32:39], v180
    ds_read_b128 v[176:179], v183 offset:31552
    v_exp_f32 v51, v51
    v_exp_f32 v52, v52
    v_exp_f32 v53, v53
    v_exp_f32 v54, v54
    v_mfma_f32_32x32x8_bf16 v[16:31], v[154:155], v[140:141], v[16:31]
    v_exp_f32 v55, v55
    v_exp_f32 v56, v56
    v_exp_f32 v57, v57
    v_exp_f32 v58, v58
    v_smfmac_f32_32x32x32_bf16 v[64:79], v[160:163], v[40:47], v180
    s_cbranch_scc1 L_a_loopf
    s_waitcnt vmcnt(0) lgkmcnt(0)
    s_barrier
    v_cmp_gt_u32 vcc, 36, v194
    s_cbranch_vccnz L_a_waitf
L_a_clearedf:
    v_mov_b32 v194, 1
    v_exp_f32 v59, v59
    v_exp_f32 v60, v60
    v_exp_f32 v61, v61
    v_exp_f32 v62, v62
    v_exp_f32 v63, v63
    v_xor_b32 v181, 0x8000, v181
    v_xor_b32 v182, 0x8000, v182
    v_xor_b32 v183, 0x8000, v183
    v_mfma_f32_32x32x16_bf16 v[32:47], v[148:151], v[128:131], 0
    ds_read_b128 v[144:147], v181 offset:0
    v_exp_f32 v0, v0
    v_exp_f32 v1, v1
    v_exp_f32 v2, v2
    v_smfmac_f32_32x32x32_bf16 v[80:95], v[156:159], v[48:55], v180
    ds_read2st64_b32 v[152:153], v182 offset0:8 offset1:9
    v_exp_f32 v3, v3
    v_exp_f32 v4, v4
    v_exp_f32 v5, v5
    v_exp_f32 v6, v6
    v_mfma_f32_32x32x8_bf16 v[32:47], v[154:155], v[138:139], v[32:47]
    v_exp_f32 v7, v7
    v_exp_f32 v8, v8
    v_exp_f32 v9, v9
    v_exp_f32 v10, v10
    v_smfmac_f32_32x32x32_bf16 v[80:95], v[160:163], v[56:63], v180
    v_exp_f32 v11, v11
    v_exp_f32 v12, v12
    v_exp_f32 v13, v13
    v_exp_f32 v14, v14
    v_exp_f32 v15, v15
    v_mfma_f32_32x32x16_bf16 v[48:63], v[148:151], v[132:135], 0
    ds_read_b128 v[156:159], v183 offset:2560
    v_exp_f32 v16, v16
    v_exp_f32 v17, v17
    v_exp_f32 v18, v18
    v_smfmac_f32_32x32x32_bf16 v[64:79], v[164:167], v[0:7], v180
    ds_read_b128 v[160:163], v183 offset:3264
    s_add_u32 s101, s74, 0
    v_exp_f32 v19, v19
    v_exp_f32 v20, v20
    v_exp_f32 v21, v21
    v_exp_f32 v22, v22
    v_mfma_f32_32x32x8_bf16 v[48:63], v[154:155], v[142:143], v[48:63]
    v_exp_f32 v23, v23
    v_exp_f32 v24, v24
    v_exp_f32 v25, v25
    v_exp_f32 v26, v26
    v_smfmac_f32_32x32x32_bf16 v[64:79], v[168:171], v[8:15], v180
    s_waitcnt lgkmcnt(2)
    s_add_u32 m0, s75, 0
    v_exp_f32 v27, v27
    v_exp_f32 v28, v28
    v_exp_f32 v29, v29
    v_exp_f32 v30, v30
    v_exp_f32 v31, v31
    v_mfma_f32_32x32x16_bf16 v[0:15], v[144:147], v[128:131], 0
    ds_read_b128 v[148:151], v181 offset:1024
    v_exp_f32 v32, v32
    v_exp_f32 v33, v33
    v_exp_f32 v34, v34
    v_smfmac_f32_32x32x32_bf16 v[80:95], v[164:167], v[16:23], v180
    buffer_store_dwordx4 v[196:199], v192, s[52:55], s70 offen offset:0 sc1
    v_exp_f32 v35, v35
    v_exp_f32 v36, v36
    v_exp_f32 v37, v37
    v_exp_f32 v38, v38
    v_mfma_f32_32x32x8_bf16 v[0:15], v[152:153], v[136:137], v[0:15]
    v_exp_f32 v39, v39
    v_exp_f32 v40, v40
    v_exp_f32 v41, v41
    v_exp_f32 v42, v42
    v_smfmac_f32_32x32x32_bf16 v[80:95], v[168:171], v[24:31], v180
    buffer_load_dwordx4 v248, s[52:55], s101 offen sc1 lds
    v_exp_f32 v43, v43
    v_exp_f32 v44, v44
    v_exp_f32 v45, v45
    v_exp_f32 v46, v46
    v_exp_f32 v47, v47
    v_mfma_f32_32x32x16_bf16 v[16:31], v[144:147], v[132:135], 0
    ds_read_b128 v[164:167], v183 offset:3968
    v_exp_f32 v48, v48
    v_exp_f32 v49, v49
    v_exp_f32 v50, v50
    v_smfmac_f32_32x32x32_bf16 v[64:79], v[172:175], v[32:39], v180
    ds_read_b128 v[168:171], v183 offset:4672
    v_exp_f32 v51, v51
    v_exp_f32 v52, v52
    v_exp_f32 v53, v53
    v_exp_f32 v54, v54
    v_mfma_f32_32x32x8_bf16 v[16:31], v[152:153], v[140:141], v[16:31]
    v_exp_f32 v55, v55
    v_exp_f32 v56, v56
    v_exp_f32 v57, v57
    v_exp_f32 v58, v58
    v_smfmac_f32_32x32x32_bf16 v[64:79], v[176:179], v[40:47], v180
    s_waitcnt lgkmcnt(2)
    buffer_store_dwordx4 v[196:199], v192, s[52:55], s70 offen offset:512 sc1
    v_exp_f32 v59, v59
    v_exp_f32 v60, v60
    v_exp_f32 v61, v61
    v_exp_f32 v62, v62
    v_exp_f32 v63, v63
    v_mfma_f32_32x32x16_bf16 v[32:47], v[148:151], v[128:131], 0
    ds_read_b128 v[144:147], v181 offset:5376
    v_exp_f32 v0, v0
    v_exp_f32 v1, v1
    v_exp_f32 v2, v2
    v_smfmac_f32_32x32x32_bf16 v[80:95], v[172:175], v[48:55], v180
    ds_read2st64_b32 v[154:155], v182 offset0:29 offset1:30
    v_exp_f32 v3, v3
    v_exp_f32 v4, v4
    v_exp_f32 v5, v5
    v_exp_f32 v6, v6
    v_mfma_f32_32x32x8_bf16 v[32:47], v[152:153], v[138:139], v[32:47]
    v_exp_f32 v7, v7
    v_exp_f32 v8, v8
    v_exp_f32 v9, v9
    v_exp_f32 v10, v10
    v_smfmac_f32_32x32x32_bf16 v[80:95], v[176:179], v[56:63], v180
    buffer_load_dwordx4 v248, s[52:55], s101 offen offset:1024 sc1 lds
    v_exp_f32 v11, v11
    v_exp_f32 v12, v12
    v_exp_f32 v13, v13
    v_exp_f32 v14, v14
    v_exp_f32 v15, v15
    v_mfma_f32_32x32x16_bf16 v[48:63], v[148:151], v[132:135], 0
    ds_read_b128 v[172:175], v183 offset:7936
    v_exp_f32 v16, v16
    v_exp_f32 v17, v17
    v_exp_f32 v18, v18
    v_smfmac_f32_32x32x32_bf16 v[64:79], v[156:159], v[0:7], v180
    ds_read_b128 v[176:179], v183 offset:8640
    v_exp_f32 v19, v19
    v_exp_f32 v20, v20
    v_exp_f32 v21, v21
    v_exp_f32 v22, v22
    v_mfma_f32_32x32x8_bf16 v[48:63], v[152:153], v[142:143], v[48:63]
    v_exp_f32 v23, v23
    v_exp_f32 v24, v24
    v_exp_f32 v25, v25
    v_exp_f32 v26, v26
    v_smfmac_f32_32x32x32_bf16 v[64:79], v[160:163], v[8:15], v180
    s_waitcnt lgkmcnt(2)
    s_mov_b32 exec_hi, 0
    buffer_store_dwordx4 v[196:199], v192, s[52:55], s70 offen offset:1024 sc1
    s_mov_b32 exec_hi, -1
    v_exp_f32 v27, v27
    v_exp_f32 v28, v28
    v_exp_f32 v29, v29
    v_exp_f32 v30, v30
    v_exp_f32 v31, v31
    v_mfma_f32_32x32x16_bf16 v[0:15], v[144:147], v[128:131], 0
    ds_read_b128 v[148:151], v181 offset:6400
    v_exp_f32 v32, v32
    v_exp_f32 v33, v33
    v_exp_f32 v34, v34
    v_smfmac_f32_32x32x32_bf16 v[80:95], v[156:159], v[16:23], v180
    buffer_load_dwordx4 v[216:219], v248, s[48:51], s67 offen offset:0 sc1
    v_exp_f32 v35, v35
    v_exp_f32 v36, v36
    v_exp_f32 v37, v37
    v_exp_f32 v38, v38
    v_mfma_f32_32x32x8_bf16 v[0:15], v[154:155], v[136:137], v[0:15]
    v_exp_f32 v39, v39
    v_exp_f32 v40, v40
    v_exp_f32 v41, v41
    v_exp_f32 v42, v42
    v_smfmac_f32_32x32x32_bf16 v[80:95], v[160:163], v[24:31], v180
    buffer_load_dwordx4 v248, s[52:55], s101 offen offset:2048 sc1 lds
    v_exp_f32 v43, v43
    v_exp_f32 v44, v44
    v_exp_f32 v45, v45
    v_exp_f32 v46, v46
    v_exp_f32 v47, v47
    v_mfma_f32_32x32x16_bf16 v[16:31], v[144:147], v[132:135], 0
    ds_read_b128 v[156:159], v183 offset:9344
    v_exp_f32 v48, v48
    v_exp_f32 v49, v49
    v_exp_f32 v50, v50
    v_smfmac_f32_32x32x32_bf16 v[64:79], v[164:167], v[32:39], v180
    ds_read_b128 v[160:163], v183 offset:10048
    v_exp_f32 v51, v51
    v_exp_f32 v52, v52
    v_exp_f32 v53, v53
    v_exp_f32 v54, v54
    v_mfma_f32_32x32x8_bf16 v[16:31], v[154:155], v[140:141], v[16:31]
    v_exp_f32 v55, v55
    v_exp_f32 v56, v56
    v_exp_f32 v57, v57
    v_exp_f32 v58, v58
    v_smfmac_f32_32x32x32_bf16 v[64:79], v[168:171], v[40:47], v180
    s_waitcnt lgkmcnt(2)
    buffer_load_dword v224, v244, s[48:51], s67 offen offset:2048 sc1
    v_exp_f32 v59, v59
    v_exp_f32 v60, v60
    v_exp_f32 v61, v61
    v_exp_f32 v62, v62
    v_exp_f32 v63, v63
    v_mfma_f32_32x32x16_bf16 v[32:47], v[148:151], v[128:131], 0
    ds_read_b128 v[144:147], v181 offset:10752
    v_exp_f32 v0, v0
    v_exp_f32 v1, v1
    v_exp_f32 v2, v2
    v_smfmac_f32_32x32x32_bf16 v[80:95], v[164:167], v[48:55], v180
    ds_read2st64_b32 v[152:153], v182 offset0:50 offset1:51
    v_exp_f32 v3, v3
    v_exp_f32 v4, v4
    v_exp_f32 v5, v5
    v_exp_f32 v6, v6
    v_mfma_f32_32x32x8_bf16 v[32:47], v[154:155], v[138:139], v[32:47]
    v_exp_f32 v7, v7
    v_exp_f32 v8, v8
    v_exp_f32 v9, v9
    v_exp_f32 v10, v10
    v_smfmac_f32_32x32x32_bf16 v[80:95], v[168:171], v[56:63], v180
    buffer_load_dwordx4 v248, s[52:55], s101 offen offset:3072 sc1 lds
    v_exp_f32 v11, v11
    v_exp_f32 v12, v12
    v_exp_f32 v13, v13
    v_exp_f32 v14, v14
    v_exp_f32 v15, v15
    v_mfma_f32_32x32x16_bf16 v[48:63], v[148:151], v[132:135], 0
    ds_read_b128 v[164:167], v183 offset:13312
    v_exp_f32 v16, v16
    v_exp_f32 v17, v17
    v_exp_f32 v18, v18
    v_smfmac_f32_32x32x32_bf16 v[64:79], v[172:175], v[0:7], v180
    ds_read_b128 v[168:171], v183 offset:14016
    s_add_u32 s101, s101, 4096
    v_exp_f32 v19, v19
    v_exp_f32 v20, v20
    v_exp_f32 v21, v21
    v_exp_f32 v22, v22
    v_mfma_f32_32x32x8_bf16 v[48:63], v[154:155], v[142:143], v[48:63]
    v_exp_f32 v23, v23
    v_exp_f32 v24, v24
    v_exp_f32 v25, v25
    v_exp_f32 v26, v26
    v_smfmac_f32_32x32x32_bf16 v[64:79], v[176:179], v[8:15], v180
    s_waitcnt lgkmcnt(2)
    s_add_u32 m0, s75, 4096
    v_exp_f32 v27, v27
    v_exp_f32 v28, v28
    v_exp_f32 v29, v29
    v_exp_f32 v30, v30
    v_exp_f32 v31, v31
    v_mfma_f32_32x32x16_bf16 v[0:15], v[144:147], v[128:131], 0
    ds_read_b128 v[148:151], v181 offset:11776
    v_exp_f32 v32, v32
    v_exp_f32 v33, v33
    v_exp_f32 v34, v34
    v_smfmac_f32_32x32x32_bf16 v[80:95], v[172:175], v[16:23], v180
    buffer_load_dword v225, v244, s[48:51], s67 offen offset:2304 sc1
    v_exp_f32 v35, v35
    v_exp_f32 v36, v36
    v_exp_f32 v37, v37
    v_exp_f32 v38, v38
    v_mfma_f32_32x32x8_bf16 v[0:15], v[152:153], v[136:137], v[0:15]
    v_exp_f32 v39, v39
    v_exp_f32 v40, v40
    v_exp_f32 v41, v41
    v_exp_f32 v42, v42
    v_smfmac_f32_32x32x32_bf16 v[80:95], v[176:179], v[24:31], v180
    buffer_load_dwordx4 v248, s[52:55], s101 offen sc1 lds
    v_exp_f32 v43, v43
    v_exp_f32 v44, v44
    v_exp_f32 v45, v45
    v_exp_f32 v46, v46
    v_exp_f32 v47, v47
    v_mfma_f32_32x32x16_bf16 v[16:31], v[144:147], v[132:135], 0
    ds_read_b128 v[172:175], v183 offset:14720
    v_exp_f32 v48, v48
    v_exp_f32 v49, v49
    v_exp_f32 v50, v50
    v_smfmac_f32_32x32x32_bf16 v[64:79], v[156:159], v[32:39], v180
    ds_read_b128 v[176:179], v183 offset:15424
    s_add_u32 s101, s74, 20480
    v_exp_f32 v51, v51
    v_exp_f32 v52, v52
    v_exp_f32 v53, v53
    v_exp_f32 v54, v54
    v_mfma_f32_32x32x8_bf16 v[16:31], v[152:153], v[140:141], v[16:31]
    v_exp_f32 v55, v55
    v_exp_f32 v56, v56
    v_exp_f32 v57, v57
    v_exp_f32 v58, v58
    v_smfmac_f32_32x32x32_bf16 v[64:79], v[160:163], v[40:47], v180
    s_waitcnt lgkmcnt(2)
    s_add_u32 m0, s75, 20480
    v_exp_f32 v59, v59
    v_exp_f32 v60, v60
    v_exp_f32 v61, v61
    v_exp_f32 v62, v62
    v_exp_f32 v63, v63
    v_mfma_f32_32x32x16_bf16 v[32:47], v[148:151], v[128:131], 0
    ds_read_b128 v[144:147], v181 offset:16128
    v_exp_f32 v0, v0
    v_exp_f32 v1, v1
    v_exp_f32 v2, v2
    v_smfmac_f32_32x32x32_bf16 v[80:95], v[156:159], v[48:55], v180
    ds_read2st64_b32 v[154:155], v182 offset0:71 offset1:72
    v_exp_f32 v3, v3
    v_exp_f32 v4, v4
    v_exp_f32 v5, v5
    v_exp_f32 v6, v6
    v_mfma_f32_32x32x8_bf16 v[32:47], v[152:153], v[138:139], v[32:47]
    v_exp_f32 v7, v7
    v_exp_f32 v8, v8
    v_exp_f32 v9, v9
    v_exp_f32 v10, v10
    v_smfmac_f32_32x32x32_bf16 v[80:95], v[160:163], v[56:63], v180
    buffer_load_dwordx4 v248, s[52:55], s101 offen sc1 lds
    v_exp_f32 v11, v11
    v_exp_f32 v12, v12
    v_exp_f32 v13, v13
    v_exp_f32 v14, v14
    v_exp_f32 v15, v15
    v_mfma_f32_32x32x16_bf16 v[48:63], v[148:151], v[132:135], 0
    ds_read_b128 v[156:159], v183 offset:18688
    v_exp_f32 v16, v16
    v_exp_f32 v17, v17
    v_exp_f32 v18, v18
    v_smfmac_f32_32x32x32_bf16 v[64:79], v[164:167], v[0:7], v180
    ds_read_b128 v[160:163], v183 offset:19392
    v_exp_f32 v19, v19
    v_exp_f32 v20, v20
    v_exp_f32 v21, v21
    v_exp_f32 v22, v22
    v_mfma_f32_32x32x8_bf16 v[48:63], v[152:153], v[142:143], v[48:63]
    v_exp_f32 v23, v23
    v_exp_f32 v24, v24
    v_exp_f32 v25, v25
    v_exp_f32 v26, v26
    v_smfmac_f32_32x32x32_bf16 v[64:79], v[168:171], v[8:15], v180
    s_waitcnt lgkmcnt(2)
    buffer_load_dwordx4 v[220:223], v248, s[48:51], s67 offen offset:1024 sc1
    v_exp_f32 v27, v27
    v_exp_f32 v28, v28
    v_exp_f32 v29, v29
    v_exp_f32 v30, v30
    v_exp_f32 v31, v31
    v_mfma_f32_32x32x16_bf16 v[0:15], v[144:147], v[128:131], 0
    ds_read_b128 v[148:151], v181 offset:17152
    v_exp_f32 v32, v32
    v_exp_f32 v33, v33
    v_exp_f32 v34, v34
    v_smfmac_f32_32x32x32_bf16 v[80:95], v[164:167], v[16:23], v180
    buffer_load_dwordx4 v[226:229], v245, s[48:51], s67 offen offset:0 sc1
    v_exp_f32 v35, v35
    v_exp_f32 v36, v36
    v_exp_f32 v37, v37
    v_exp_f32 v38, v38
    v_mfma_f32_32x32x8_bf16 v[0:15], v[154:155], v[136:137], v[0:15]
    v_exp_f32 v39, v39
    v_exp_f32 v40, v40
    v_exp_f32 v41, v41
    v_exp_f32 v42, v42
    v_smfmac_f32_32x32x32_bf16 v[80:95], v[168:171], v[24:31], v180
    buffer_load_dwordx4 v248, s[52:55], s101 offen offset:1024 sc1 lds
    v_exp_f32 v43, v43
    v_exp_f32 v44, v44
    v_exp_f32 v45, v45
    v_exp_f32 v46, v46
    v_exp_f32 v47, v47
    v_mfma_f32_32x32x16_bf16 v[16:31], v[144:147], v[132:135], 0
    ds_read_b128 v[164:167], v183 offset:20096
    v_exp_f32 v48, v48
    v_exp_f32 v49, v49
    v_exp_f32 v50, v50
    v_smfmac_f32_32x32x32_bf16 v[64:79], v[172:175], v[32:39], v180
    ds_read_b128 v[168:171], v183 offset:20800
    v_exp_f32 v51, v51
    v_exp_f32 v52, v52
    v_exp_f32 v53, v53
    v_exp_f32 v54, v54
    v_mfma_f32_32x32x8_bf16 v[16:31], v[154:155], v[140:141], v[16:31]
    v_exp_f32 v55, v55
    v_exp_f32 v56, v56
    v_exp_f32 v57, v57
    v_exp_f32 v58, v58
    v_smfmac_f32_32x32x32_bf16 v[64:79], v[176:179], v[40:47], v180
    s_waitcnt lgkmcnt(2)
    buffer_load_dwordx4 v[230:233], v245, s[48:51], s67 offen offset:704 sc1
    v_exp_f32 v59, v59
    v_exp_f32 v60, v60
    v_exp_f32 v61, v61
    v_exp_f32 v62, v62
    v_exp_f32 v63, v63
    v_mfma_f32_32x32x16_bf16 v[32:47], v[148:151], v[128:131], 0
    ds_read_b128 v[144:147], v181 offset:21504
    v_exp_f32 v0, v0
    v_exp_f32 v1, v1
    v_exp_f32 v2, v2
    v_smfmac_f32_32x32x32_bf16 v[80:95], v[172:175], v[48:55], v180
    ds_read2st64_b32 v[152:153], v182 offset0:92 offset1:93
    v_exp_f32 v3, v3
    v_exp_f32 v4, v4
    v_exp_f32 v5, v5
    v_exp_f32 v6, v6
    v_mfma_f32_32x32x8_bf16 v[32:47], v[154:155], v[138:139], v[32:47]
    v_exp_f32 v7, v7
    v_exp_f32 v8, v8
    v_exp_f32 v9, v9
    v_exp_f32 v10, v10
    v_smfmac_f32_32x32x32_bf16 v[80:95], v[176:179], v[56:63], v180
    buffer_load_dwordx4 v248, s[52:55], s101 offen offset:2048 sc1 lds
    v_exp_f32 v11, v11
    v_exp_f32 v12, v12
    v_exp_f32 v13, v13
    v_exp_f32 v14, v14
    v_exp_f32 v15, v15
    v_mfma_f32_32x32x16_bf16 v[48:63], v[148:151], v[132:135], 0
    ds_read_b128 v[172:175], v183 offset:24064
    v_exp_f32 v16, v16
    v_exp_f32 v17, v17
    v_exp_f32 v18, v18
    v_smfmac_f32_32x32x32_bf16 v[64:79], v[156:159], v[0:7], v180
    ds_read_b128 v[176:179], v183 offset:24768
    v_exp_f32 v19, v19
    v_exp_f32 v20, v20
    v_exp_f32 v21, v21
    v_exp_f32 v22, v22
    v_mfma_f32_32x32x8_bf16 v[48:63], v[154:155], v[142:143], v[48:63]
    v_exp_f32 v23, v23
    v_exp_f32 v24, v24
    v_exp_f32 v25, v25
    v_exp_f32 v26, v26
    v_smfmac_f32_32x32x32_bf16 v[64:79], v[160:163], v[8:15], v180
    s_waitcnt lgkmcnt(2)
    buffer_load_dwordx4 v[234:237], v245, s[48:51], s67 offen offset:1408 sc1
    v_exp_f32 v27, v27
    v_exp_f32 v28, v28
    v_exp_f32 v29, v29
    v_exp_f32 v30, v30
    v_exp_f32 v31, v31
    v_mfma_f32_32x32x16_bf16 v[0:15], v[144:147], v[128:131], 0
    ds_read_b128 v[148:151], v181 offset:22528
    v_exp_f32 v32, v32
    v_exp_f32 v33, v33
    v_exp_f32 v34, v34
    v_smfmac_f32_32x32x32_bf16 v[80:95], v[156:159], v[16:23], v180
    buffer_load_dwordx4 v[238:241], v245, s[48:51], s67 offen offset:2112 sc1
    v_exp_f32 v35, v35
    v_exp_f32 v36, v36
    v_exp_f32 v37, v37
    v_exp_f32 v38, v38
    v_mfma_f32_32x32x8_bf16 v[0:15], v[152:153], v[136:137], v[0:15]
    v_exp_f32 v39, v39
    v_exp_f32 v40, v40
    v_exp_f32 v41, v41
    v_exp_f32 v42, v42
    v_smfmac_f32_32x32x32_bf16 v[80:95], v[160:163], v[24:31], v180
    buffer_load_dwordx4 v248, s[52:55], s101 offen offset:3072 sc1 lds
    v_exp_f32 v43, v43
    v_exp_f32 v44, v44
    v_exp_f32 v45, v45
    v_exp_f32 v46, v46
    v_exp_f32 v47, v47
    v_mfma_f32_32x32x16_bf16 v[16:31], v[144:147], v[132:135], 0
    ds_read_b128 v[156:159], v183 offset:25472
    v_exp_f32 v48, v48
    v_exp_f32 v49, v49
    v_exp_f32 v50, v50
    v_smfmac_f32_32x32x32_bf16 v[64:79], v[164:167], v[32:39], v180
    ds_read_b128 v[160:163], v183 offset:26176
    s_add_u32 s101, s101, 4096
    v_exp_f32 v51, v51
    v_exp_f32 v52, v52
    v_exp_f32 v53, v53
    v_exp_f32 v54, v54
    v_mfma_f32_32x32x8_bf16 v[16:31], v[152:153], v[140:141], v[16:31]
    v_exp_f32 v55, v55
    v_exp_f32 v56, v56
    v_exp_f32 v57, v57
    v_exp_f32 v58, v58
    v_smfmac_f32_32x32x32_bf16 v[64:79], v[168:171], v[40:47], v180
    s_waitcnt lgkmcnt(2)
    s_add_u32 m0, s75, 24576
    v_exp_f32 v59, v59
    v_exp_f32 v60, v60
    v_exp_f32 v61, v61
    v_exp_f32 v62, v62
    v_exp_f32 v63, v63
    v_mfma_f32_32x32x16_bf16 v[32:47], v[148:151], v[128:131], 0
    ds_read_b128 v[144:147], v181 offset:26880
    v_exp_f32 v0, v0
    v_exp_f32 v1, v1
    v_exp_f32 v2, v2
    v_smfmac_f32_32x32x32_bf16 v[80:95], v[164:167], v[48:55], v180
    ds_read2st64_b32 v[154:155], v182 offset0:113 offset1:114
    v_exp_f32 v3, v3
    v_exp_f32 v4, v4
    v_exp_f32 v5, v5
    v_exp_f32 v6, v6
    v_mfma_f32_32x32x8_bf16 v[32:47], v[152:153], v[138:139], v[32:47]
    v_exp_f32 v7, v7
    v_exp_f32 v8, v8
    v_exp_f32 v9, v9
    v_exp_f32 v10, v10
    v_smfmac_f32_32x32x32_bf16 v[80:95], v[168:171], v[56:63], v180
    buffer_load_dwordx4 v248, s[52:55], s101 offen sc1 lds
    v_exp_f32 v11, v11
    v_exp_f32 v12, v12
    v_exp_f32 v13, v13
    v_exp_f32 v14, v14
    v_exp_f32 v15, v15
    v_mfma_f32_32x32x16_bf16 v[48:63], v[148:151], v[132:135], 0
    ds_read_b128 v[164:167], v183 offset:29440
    v_exp_f32 v16, v16
    v_exp_f32 v17, v17
    v_exp_f32 v18, v18
    v_smfmac_f32_32x32x32_bf16 v[64:79], v[172:175], v[0:7], v180
    ds_read_b128 v[168:171], v183 offset:30144
    v_exp_f32 v19, v19
    v_exp_f32 v20, v20
    v_exp_f32 v21, v21
    v_exp_f32 v22, v22
    v_mfma_f32_32x32x8_bf16 v[48:63], v[152:153], v[142:143], v[48:63]
    v_exp_f32 v23, v23
    v_exp_f32 v24, v24
    v_exp_f32 v25, v25
    v_exp_f32 v26, v26
    v_smfmac_f32_32x32x32_bf16 v[64:79], v[176:179], v[8:15], v180
    s_waitcnt lgkmcnt(2)
    v_exp_f32 v27, v27
    v_exp_f32 v28, v28
    v_exp_f32 v29, v29
    v_exp_f32 v30, v30
    v_exp_f32 v31, v31
    v_mfma_f32_32x32x16_bf16 v[0:15], v[144:147], v[128:131], 0
    ds_read_b128 v[148:151], v181 offset:27904
    v_exp_f32 v32, v32
    v_exp_f32 v33, v33
    v_exp_f32 v34, v34
    v_smfmac_f32_32x32x32_bf16 v[80:95], v[172:175], v[16:23], v180
    v_exp_f32 v35, v35
    v_exp_f32 v36, v36
    v_exp_f32 v37, v37
    v_exp_f32 v38, v38
    v_mfma_f32_32x32x8_bf16 v[0:15], v[154:155], v[136:137], v[0:15]
    v_exp_f32 v39, v39
    v_exp_f32 v40, v40
    v_exp_f32 v41, v41
    v_exp_f32 v42, v42
    v_smfmac_f32_32x32x32_bf16 v[80:95], v[176:179], v[24:31], v180
    v_exp_f32 v43, v43
    v_exp_f32 v44, v44
    v_exp_f32 v45, v45
    v_exp_f32 v46, v46
    v_exp_f32 v47, v47
    v_mfma_f32_32x32x16_bf16 v[16:31], v[144:147], v[132:135], 0
    ds_read_b128 v[172:175], v183 offset:30848
    v_exp_f32 v48, v48
    v_exp_f32 v49, v49
    v_exp_f32 v50, v50
    v_smfmac_f32_32x32x32_bf16 v[64:79], v[156:159], v[32:39], v180
    ds_read_b128 v[176:179], v183 offset:31552
    v_exp_f32 v51, v51
    v_exp_f32 v52, v52
    v_exp_f32 v53, v53
    v_exp_f32 v54, v54
    v_mfma_f32_32x32x8_bf16 v[16:31], v[154:155], v[140:141], v[16:31]
    v_exp_f32 v55, v55
    v_exp_f32 v56, v56
    v_exp_f32 v57, v57
    v_exp_f32 v58, v58
    v_smfmac_f32_32x32x32_bf16 v[64:79], v[160:163], v[40:47], v180
    s_waitcnt vmcnt(16) lgkmcnt(0)
    s_barrier
    v_exp_f32 v59, v59
    v_exp_f32 v60, v60
    v_exp_f32 v61, v61
    v_exp_f32 v62, v62
    v_exp_f32 v63, v63
    v_mfma_f32_32x32x16_bf16 v[32:47], v[148:151], v[128:131], 0
    v_exp_f32 v0, v0
    v_exp_f32 v1, v1
    v_exp_f32 v2, v2
    v_smfmac_f32_32x32x32_bf16 v[80:95], v[156:159], v[48:55], v180
    s_add_u32 m0, s75, 40960
    s_add_u32 s101, s74, 40960
    buffer_load_dwordx4 v248, s[52:55], s101 offen sc1 lds
    v_exp_f32 v3, v3
    v_exp_f32 v4, v4
    v_exp_f32 v5, v5
    v_exp_f32 v6, v6
    v_mfma_f32_32x32x8_bf16 v[32:47], v[154:155], v[138:139], v[32:47]
    v_exp_f32 v7, v7
    v_exp_f32 v8, v8
    v_exp_f32 v9, v9
    v_exp_f32 v10, v10
    v_smfmac_f32_32x32x32_bf16 v[80:95], v[160:163], v[56:63], v180
    s_mul_i32 s68, s38, 3840
    s_mul_i32 s71, s38, 1280
    buffer_load_dwordx4 v248, s[52:55], s101 offen offset:1024 sc1 lds
    v_exp_f32 v11, v11
    v_exp_f32 v12, v12
    v_exp_f32 v13, v13
    v_exp_f32 v14, v14
    v_exp_f32 v15, v15
    v_mfma_f32_32x32x16_bf16 v[48:63], v[148:151], v[132:135], 0
    v_exp_f32 v16, v16
    v_exp_f32 v17, v17
    v_exp_f32 v18, v18
    v_smfmac_f32_32x32x32_bf16 v[64:79], v[164:167], v[0:7], v180
    buffer_load_dwordx4 v248, s[52:55], s101 offen offset:2048 sc1 lds
    v_exp_f32 v19, v19
    v_exp_f32 v20, v20
    v_exp_f32 v21, v21
    v_exp_f32 v22, v22
    v_mfma_f32_32x32x8_bf16 v[48:63], v[154:155], v[142:143], v[48:63]
    v_exp_f32 v23, v23
    v_exp_f32 v24, v24
    v_exp_f32 v25, v25
    v_exp_f32 v26, v26
    v_smfmac_f32_32x32x32_bf16 v[64:79], v[168:171], v[8:15], v180
    buffer_load_dwordx4 v248, s[52:55], s101 offen offset:3072 sc1 lds
    s_waitcnt vmcnt(4)
    v_exp_f32 v27, v27
    v_exp_f32 v28, v28
    v_exp_f32 v29, v29
    v_exp_f32 v30, v30
    v_exp_f32 v31, v31
    v_mfma_f32_32x32x16_bf16 v[0:15], v[216:219], v[128:131], 0
    v_exp_f32 v32, v32
    v_exp_f32 v33, v33
    v_exp_f32 v34, v34
    v_smfmac_f32_32x32x32_bf16 v[80:95], v[164:167], v[16:23], v180
    s_add_u32 m0, s75, 45056
    s_add_u32 s101, s101, 4096
    buffer_load_dwordx4 v248, s[52:55], s101 offen sc1 lds
    v_exp_f32 v35, v35
    v_exp_f32 v36, v36
    v_exp_f32 v37, v37
    v_exp_f32 v38, v38
    v_mfma_f32_32x32x8_bf16 v[0:15], v[224:225], v[136:137], v[0:15]
    v_exp_f32 v39, v39
    v_exp_f32 v40, v40
    v_exp_f32 v41, v41
    v_exp_f32 v42, v42
    v_smfmac_f32_32x32x32_bf16 v[80:95], v[168:171], v[24:31], v180
    s_add_u32 m0, s68, 61440
    s_sub_u32 s101, s74, s71
    s_add_u32 s101, s101, 61440
    buffer_load_dwordx4 v248, s[52:55], s101 offen offset:0 sc1 lds
    v_exp_f32 v43, v43
    v_exp_f32 v44, v44
    v_exp_f32 v45, v45
    v_exp_f32 v46, v46
    v_exp_f32 v47, v47
    v_mfma_f32_32x32x16_bf16 v[16:31], v[216:219], v[132:135], 0
    v_exp_f32 v48, v48
    v_exp_f32 v49, v49
    v_exp_f32 v50, v50
    v_smfmac_f32_32x32x32_bf16 v[64:79], v[172:175], v[32:39], v180
    buffer_load_dwordx4 v248, s[52:55], s101 offen offset:1024 sc1 lds
    v_exp_f32 v51, v51
    v_exp_f32 v52, v52
    v_exp_f32 v53, v53
    v_exp_f32 v54, v54
    v_mfma_f32_32x32x8_bf16 v[16:31], v[224:225], v[140:141], v[16:31]
    v_exp_f32 v55, v55
    v_exp_f32 v56, v56
    v_exp_f32 v57, v57
    v_exp_f32 v58, v58
    v_smfmac_f32_32x32x32_bf16 v[64:79], v[176:179], v[40:47], v180
    buffer_load_dwordx4 v248, s[52:55], s101 offen offset:2048 sc1 lds
    v_exp_f32 v59, v59
    v_exp_f32 v60, v60
    v_exp_f32 v61, v61
    v_exp_f32 v62, v62
    v_exp_f32 v63, v63
    v_mfma_f32_32x32x16_bf16 v[32:47], v[220:223], v[128:131], 0
    v_exp_f32 v0, v0
    v_exp_f32 v1, v1
    v_exp_f32 v2, v2
    v_smfmac_f32_32x32x32_bf16 v[80:95], v[172:175], v[48:55], v180
    s_mov_b32 exec_hi, 0xffff
    buffer_load_dwordx4 v248, s[52:55], s101 offen offset:3072 sc1 lds
    s_mov_b32 exec_hi, -1
    v_exp_f32 v3, v3
    v_exp_f32 v4, v4
    v_exp_f32 v5, v5
    v_exp_f32 v6, v6
    v_mfma_f32_32x32x8_bf16 v[32:47], v[224:225], v[138:139], v[32:47]
    v_exp_f32 v7, v7
    v_exp_f32 v8, v8
    v_exp_f32 v9, v9
    v_exp_f32 v10, v10
    v_smfmac_f32_32x32x32_bf16 v[80:95], v[176:179], v[56:63], v180
    s_lshl_b32 s72, s62, 2
    s_add_u32 s72, s72, s38
    v_exp_f32 v11, v11
    v_exp_f32 v12, v12
    v_exp_f32 v13, v13
    v_exp_f32 v14, v14
    v_exp_f32 v15, v15
    v_mfma_f32_32x32x16_bf16 v[48:63], v[220:223], v[132:135], 0
    v_exp_f32 v16, v16
    v_exp_f32 v17, v17
    v_exp_f32 v18, v18
    v_smfmac_f32_32x32x32_bf16 v[64:79], v[226:229], v[0:7], v180
    s_mul_i32 s73, s72, 81920
    s_mul_i32 s69, s63, 320
    v_exp_f32 v19, v19
    v_exp_f32 v20, v20
    v_exp_f32 v21, v21
    v_exp_f32 v22, v22
    v_mfma_f32_32x32x8_bf16 v[48:63], v[224:225], v[142:143], v[48:63]
    v_exp_f32 v23, v23
    v_exp_f32 v24, v24
    v_exp_f32 v25, v25
    v_exp_f32 v26, v26
    v_smfmac_f32_32x32x32_bf16 v[64:79], v[230:233], v[8:15], v180
    s_add_u32 s73, s73, s69
    s_mul_i32 s64, s72, 20480
    v_exp_f32 v27, v27
    v_exp_f32 v28, v28
    v_exp_f32 v29, v29
    v_exp_f32 v30, v30
    v_exp_f32 v31, v31
    v_exp_f32 v32, v32
    v_exp_f32 v33, v33
    v_exp_f32 v34, v34
    v_smfmac_f32_32x32x32_bf16 v[80:95], v[226:229], v[16:23], v180
    s_add_u32 s64, s64, 1572864
    s_mov_b32 s48, s32
    v_exp_f32 v35, v35
    v_exp_f32 v36, v36
    v_exp_f32 v37, v37
    v_exp_f32 v38, v38
    v_exp_f32 v39, v39
    v_exp_f32 v40, v40
    v_exp_f32 v41, v41
    v_exp_f32 v42, v42
    v_smfmac_f32_32x32x32_bf16 v[80:95], v[230:233], v[24:31], v180
    s_mov_b32 s49, s33
    s_mov_b32 s50, 10485760
    v_exp_f32 v43, v43
    v_exp_f32 v44, v44
    v_exp_f32 v45, v45
    v_exp_f32 v46, v46
    v_exp_f32 v47, v47
    v_exp_f32 v48, v48
    v_exp_f32 v49, v49
    v_exp_f32 v50, v50
    v_smfmac_f32_32x32x32_bf16 v[64:79], v[234:237], v[32:39], v180
    s_lshl_b32 s72, s62, 7
    s_add_u32 s72, s72, 61440
    v_exp_f32 v51, v51
    v_exp_f32 v52, v52
    v_exp_f32 v53, v53
    v_exp_f32 v54, v54
    v_exp_f32 v55, v55
    v_exp_f32 v56, v56
    v_exp_f32 v57, v57
    v_exp_f32 v58, v58
    v_smfmac_f32_32x32x32_bf16 v[64:79], v[238:241], v[40:47], v180
    s_cmp_eq_u32 s38, 0
    s_cselect_b64 s[76:77], 1, 0
    v_exp_f32 v59, v59
    v_exp_f32 v60, v60
    v_exp_f32 v61, v61
    v_exp_f32 v62, v62
    v_exp_f32 v63, v63
    v_smfmac_f32_32x32x32_bf16 v[80:95], v[234:237], v[48:55], v180
    s_nop 0
    v_smfmac_f32_32x32x32_bf16 v[80:95], v[238:241], v[56:63], v180
L_a_done:
    s_mov_b64 exec, s[76:77]
    s_cbranch_execz L_a_nosig
    buffer_atomic_add v194, v193, s[52:55], s72 offen sc0
L_a_nosig:
    s_mov_b64 exec, -1
    v_rcp_f32 v77, v72
    v_rcp_f32 v76, v72
    s_nop 1
    v_permlane32_swap_b32 v77, v76
    v_mov_b32 v77, v76
    v_pk_mul_f32 v[64:65], v[64:65], v[76:77]
    v_pk_mul_f32 v[66:67], v[66:67], v[76:77]
    v_pk_mul_f32 v[68:69], v[68:69], v[76:77]
    v_pk_mul_f32 v[70:71], v[70:71], v[76:77]
    v_pk_mul_f32 v[72:73], v[72:73], v[76:77]
    v_pk_mul_f32 v[74:75], v[74:75], v[76:77]
    v_cvt_pk_bf16_f32 v0, v64, v65
    v_cvt_pk_bf16_f32 v1, v66, v67
    v_cvt_pk_bf16_f32 v2, v68, v69
    v_cvt_pk_bf16_f32 v3, v70, v71
    v_cvt_pk_bf16_f32 v8, v72, v73
    v_cvt_pk_bf16_f32 v9, v74, v75
    buffer_store_dwordx4 v[0:3], v192, s[52:55], s70 offen offset:0 sc1
    v_rcp_f32 v93, v88
    v_rcp_f32 v92, v88
    s_nop 1
    v_permlane32_swap_b32 v93, v92
    v_mov_b32 v93, v92
    v_pk_mul_f32 v[80:81], v[80:81], v[92:93]
    v_pk_mul_f32 v[82:83], v[82:83], v[92:93]
    v_pk_mul_f32 v[84:85], v[84:85], v[92:93]
    v_pk_mul_f32 v[86:87], v[86:87], v[92:93]
    v_pk_mul_f32 v[88:89], v[88:89], v[92:93]
    v_pk_mul_f32 v[90:91], v[90:91], v[92:93]
    v_cvt_pk_bf16_f32 v4, v80, v81
    v_cvt_pk_bf16_f32 v5, v82, v83
    v_cvt_pk_bf16_f32 v6, v84, v85
    v_cvt_pk_bf16_f32 v7, v86, v87
    v_cvt_pk_bf16_f32 v10, v88, v89
    v_cvt_pk_bf16_f32 v11, v90, v91
    buffer_store_dwordx4 v[4:7], v192, s[52:55], s70 offen offset:512 sc1
    s_mov_b32 exec_hi, 0
    buffer_store_dwordx4 v[8:11], v192, s[52:55], s70 offen offset:1024 sc1
    s_mov_b32 exec_hi, -1
    s_waitcnt vmcnt(12)
    s_barrier
    s_setprio 2
    v_mov_b32 v195, 81916
    ds_read_b128 v[0:3], v248 offset:0
    ds_read_b128 v[4:7], v248 offset:1024
    ds_read_b128 v[8:11], v248 offset:2048
    ds_read_b128 v[12:15], v248 offset:3072
    ds_read_b128 v[16:19], v248 offset:4096
    ds_read_b128 v[20:23], v248 offset:5120
    ds_read_b128 v[24:27], v248 offset:6144
    ds_read_b128 v[28:31], v248 offset:7168
    ds_read_b128 v[32:35], v248 offset:8192
    ds_read_b128 v[36:39], v248 offset:9216
    ds_read_b128 v[40:43], v248 offset:10240
    ds_read_b128 v[44:47], v248 offset:11264
    ds_read_b128 v[48:51], v248 offset:12288
    ds_read_b128 v[52:55], v248 offset:13312
    ds_read_b128 v[56:59], v248 offset:14336
    ds_read_b128 v[60:63], v248 offset:15360
    ds_read_b128 v[64:67], v248 offset:16384
    ds_read_b128 v[68:71], v248 offset:17408
    ds_read_b128 v[72:75], v248 offset:18432
    ds_read_b128 v[76:79], v248 offset:19456
    ds_read_b128 v[80:83], v248 offset:20480
    ds_read_b128 v[84:87], v248 offset:21504
    ds_read_b128 v[88:91], v248 offset:22528
    ds_read_b128 v[92:95], v248 offset:23552
    ds_read_b128 v[96:99], v248 offset:24576
    s_cmp_lg_u32 s38, 0
    s_cbranch_scc1 L_w0_25
    s_waitcnt vmcnt(3)
    s_mov_b64 exec, 1
    ds_write_b32 v195, v194
    s_mov_b64 exec, -1
L_w0_25:
    s_waitcnt vmcnt(3) lgkmcnt(0)
    s_barrier
    ds_read_b32 v194, v195
    s_add_u32 m0, s75, 0
    s_add_u32 s101, s74, 76800
    buffer_load_dwordx4 v248, s[52:55], s101 offen sc1 lds
    ds_read_b128 v[100:103], v248 offset:25600
    buffer_load_dwordx4 v248, s[52:55], s101 offen offset:1024 sc1 lds
    ds_read_b128 v[104:107], v248 offset:26624
    buffer_load_dwordx4 v248, s[52:55], s101 offen offset:2048 sc1 lds
    ds_read_b128 v[108:111], v248 offset:27648
    buffer_load_dwordx4 v248, s[52:55], s101 offen offset:3072 sc1 lds
    ds_read_b128 v[112:115], v248 offset:28672
    s_add_u32 m0, s75, 4096
    s_add_u32 s101, s101, 4096
    buffer_load_dwordx4 v248, s[52:55], s101 offen sc1 lds
    ds_read_b128 v[116:119], v248 offset:29696
    s_sub_u32 s101, s74, s68
    s_add_u32 m0, s71, 20480
    s_add_u32 s101, s101, 97280
    buffer_load_dwordx4 v248, s[52:55], s101 offen sc1 lds
    ds_read_b128 v[120:123], v248 offset:30720
    s_mov_b64 exec, 0xffff
    buffer_load_dwordx4 v248, s[52:55], s101 offen offset:1024 sc1 lds
    s_mov_b64 exec, -1
    ds_read_b128 v[124:127], v248 offset:31744
    ds_read_b128 v[128:131], v248 offset:32768
    ds_read_b128 v[132:135], v248 offset:33792
    ds_read_b128 v[136:139], v248 offset:34816
    ds_read_b128 v[140:143], v248 offset:35840
    ds_read_b128 v[144:147], v248 offset:36864
    ds_read_b128 v[148:151], v248 offset:37888
    ds_read_b128 v[152:155], v248 offset:38912
    ds_read_b128 v[156:159], v248 offset:39936
    s_waitcnt lgkmcnt(12)
    v_readfirstlane_b32 s70, v194
    s_nop 0
    s_cmp_ge_u32 s70, 7
    s_cbranch_scc1 L_o_seen
    s_cmp_lg_u32 s38, 0
    s_cbranch_scc1 L_w0_26
    s_mov_b64 exec, 1
    v_mov_b32 v193, 0
    s_mov_b32 s39, 40000
L_poll_27:
    buffer_load_dword v194, v193, s[52:55], s72 offen sc1
    s_sub_u32 s39, s39, 1
    s_cbranch_scc1 L_polled_28
    s_waitcnt vmcnt(0)
    v_cmp_gt_u32 vcc, 8, v194
    s_cbranch_vccz L_polled_28
    s_sleep 1
    s_branch L_poll_27
L_polled_28:
    s_waitcnt vmcnt(0)
    s_mov_b64 exec, -1
L_w0_26:
    s_barrier
L_o_seen:
    s_add_u32 s65, s64, 0
    buffer_load_dwordx4 v[160:163], v248, s[52:55], s65 offen sc1
    buffer_load_dwordx4 v[164:167], v248, s[52:55], s65 offen offset:1024 sc1
    buffer_load_dwordx4 v[168:171], v248, s[52:55], s65 offen offset:2048 sc1
    buffer_load_dwordx4 v[172:175], v248, s[52:55], s65 offen offset:3072 sc1
    s_add_u32 s65, s64, 4096
    buffer_load_dwordx4 v[176:179], v248, s[52:55], s65 offen sc1
    buffer_load_dwordx4 v[180:183], v248, s[52:55], s65 offen offset:1024 sc1
    buffer_load_dwordx4 v[184:187], v248, s[52:55], s65 offen offset:2048 sc1
    buffer_load_dwordx4 v[188:191], v248, s[52:55], s65 offen offset:3072 sc1
    s_add_u32 s65, s64, 8192
    buffer_load_dwordx4 v[192:195], v248, s[52:55], s65 offen sc1
    buffer_load_dwordx4 v[196:199], v248, s[52:55], s65 offen offset:1024 sc1
    s_waitcnt vmcnt(8) lgkmcnt(0)
    v_max3_u32 v236, v160, v161, v162
    v_max3_u32 v237, v163, v164, v165
    v_max3_u32 v236, v236, v166, v167
    v_max_u32 v236, v236, v237
    v_cmp_eq_u32 vcc, -1, v236
    s_setprio 2
    s_cbranch_vccnz L_o_fix0
L_o_ok0:
    v_mfma_f32_16x16x32_bf16 v[216:219], v[0:3], v[160:163], 0
    v_mfma_f32_16x16x32_bf16 v[220:223], v[4:7], v[160:163], 0
    ds_read_b128 v[0:3], v248 offset:40960
    v_mfma_f32_16x16x32_bf16 v[224:227], v[8:11], v[160:163], 0
    ds_read_b128 v[4:7], v248 offset:41984
    v_mfma_f32_16x16x32_bf16 v[228:231], v[12:15], v[160:163], 0
    v_mfma_f32_16x16x32_bf16 v[232:235], v[16:19], v[160:163], 0
    ds_read_b128 v[8:11], v248 offset:43008
    v_mfma_f32_16x16x32_bf16 v[216:219], v[20:23], v[164:167], v[216:219]
    ds_read_b128 v[12:15], v248 offset:44032
    s_waitcnt vmcnt(6)
    v_max3_u32 v236, v168, v169, v170
    v_mfma_f32_16x16x32_bf16 v[220:223], v[24:27], v[164:167], v[220:223]
    v_max3_u32 v237, v171, v172, v173
    v_mfma_f32_16x16x32_bf16 v[224:227], v[28:31], v[164:167], v[224:227]
    ds_read_b128 v[16:19], v248 offset:45056
    v_max3_u32 v236, v236, v174, v175
    v_mfma_f32_16x16x32_bf16 v[228:231], v[32:35], v[164:167], v[228:231]
    ds_read_b128 v[20:23], v248 offset:46080
    v_max_u32 v236, v236, v237
    v_mfma_f32_16x16x32_bf16 v[232:235], v[36:39], v[164:167], v[232:235]
    ds_read_b128 v[24:27], v248 offset:47104
    v_cmp_eq_u32 vcc, -1, v236
    s_cbranch_vccnz L_o_fix1
L_o_ok1:
    v_mfma_f32_16x16x32_bf16 v[216:219], v[40:43], v[168:171], v[216:219]
    buffer_load_dwordx4 v[160:163], v248, s[52:55], s65 offen offset:2048 sc1
    v_mfma_f32_16x16x32_bf16 v[220:223], v[44:47], v[168:171], v[220:223]
    ds_read_b128 v[28:31], v248 offset:48128
    v_mfma_f32_16x16x32_bf16 v[224:227], v[48:51], v[168:171], v[224:227]
    ds_read_b128 v[32:35], v248 offset:49152
    buffer_load_dwordx4 v[164:167], v248, s[52:55], s65 offen offset:3072 sc1
    v_mfma_f32_16x16x32_bf16 v[228:231], v[52:55], v[168:171], v[228:231]
    v_mfma_f32_16x16x32_bf16 v[232:235], v[56:59], v[168:171], v[232:235]
    ds_read_b128 v[36:39], v248 offset:50176
    v_mfma_f32_16x16x32_bf16 v[216:219], v[60:63], v[172:175], v[216:219]
    ds_read_b128 v[40:43], v210 offset:0
    s_waitcnt vmcnt(6)
    v_max3_u32 v236, v176, v177, v178
    v_mfma_f32_16x16x32_bf16 v[220:223], v[64:67], v[172:175], v[220:223]
    v_max3_u32 v237, v179, v180, v181
    v_mfma_f32_16x16x32_bf16 v[224:227], v[68:71], v[172:175], v[224:227]
    ds_read_b128 v[44:47], v210 offset:1024
    v_max3_u32 v236, v236, v182, v183
    v_mfma_f32_16x16x32_bf16 v[228:231], v[72:75], v[172:175], v[228:231]
    ds_read_b128 v[48:51], v210 offset:2048
    v_max_u32 v236, v236, v237
    v_mfma_f32_16x16x32_bf16 v[232:235], v[76:79], v[172:175], v[232:235]
    ds_read_b128 v[52:55], v210 offset:3072
    v_cmp_eq_u32 vcc, -1, v236
    s_cbranch_vccnz L_o_fix2
L_o_ok2:
    v_mfma_f32_16x16x32_bf16 v[216:219], v[80:83], v[176:179], v[216:219]
    s_add_u32 s65, s64, 12288
    buffer_load_dwordx4 v[168:171], v248, s[52:55], s65 offen sc1
    v_mfma_f32_16x16x32_bf16 v[220:223], v[84:87], v[176:179], v[220:223]
    ds_read_b128 v[56:59], v210 offset:4096
    v_mfma_f32_16x16x32_bf16 v[224:227], v[88:91], v[176:179], v[224:227]
    ds_read_b128 v[60:63], v210 offset:5120
    buffer_load_dwordx4 v[172:175], v248, s[52:55], s65 offen offset:1024 sc1
    v_mfma_f32_16x16x32_bf16 v[228:231], v[92:95], v[176:179], v[228:231]
    v_mfma_f32_16x16x32_bf16 v[232:235], v[96:99], v[176:179], v[232:235]
    ds_read_b128 v[64:67], v210 offset:6144
    v_mfma_f32_16x16x32_bf16 v[216:219], v[100:103], v[180:183], v[216:219]
    ds_read_b128 v[68:71], v210 offset:7168
    s_waitcnt vmcnt(6)
    v_max3_u32 v236, v184, v185, v186
    v_mfma_f32_16x16x32_bf16 v[220:223], v[104:107], v[180:183], v[220:223]
    v_max3_u32 v237, v187, v188, v189
    v_mfma_f32_16x16x32_bf16 v[224:227], v[108:111], v[180:183], v[224:227]
    ds_read_b128 v[72:75], v210 offset:8192
    v_max3_u32 v236, v236, v190, v191
    v_mfma_f32_16x16x32_bf16 v[228:231], v[112:115], v[180:183], v[228:231]
    ds_read_b128 v[76:79], v210 offset:9216
    v_max_u32 v236, v236, v237
    v_mfma_f32_16x16x32_bf16 v[232:235], v[116:119], v[180:183], v[232:235]
    ds_read_b128 v[80:83], v210 offset:10240
    v_cmp_eq_u32 vcc, -1, v236
    s_cbranch_vccnz L_o_fix3
L_o_ok3:
    s_waitcnt lgkmcnt(6)
    s_barrier
    v_mfma_f32_16x16x32_bf16 v[216:219], v[120:123], v[184:187], v[216:219]
    buffer_load_dwordx4 v[176:179], v248, s[52:55], s65 offen offset:2048 sc1
    v_mfma_f32_16x16x32_bf16 v[220:223], v[124:127], v[184:187], v[220:223]
    ds_read_b128 v[84:87], v210 offset:11264
    v_mfma_f32_16x16x32_bf16 v[224:227], v[128:131], v[184:187], v[224:227]
    ds_read_b128 v[88:91], v210 offset:12288
    buffer_load_dwordx4 v[180:183], v248, s[52:55], s65 offen offset:3072 sc1
    v_mfma_f32_16x16x32_bf16 v[228:231], v[132:135], v[184:187], v[228:231]
    v_mfma_f32_16x16x32_bf16 v[232:235], v[136:139], v[184:187], v[232:235]
    ds_read_b128 v[92:95], v210 offset:13312
    v_mfma_f32_16x16x32_bf16 v[216:219], v[140:143], v[188:191], v[216:219]
    ds_read_b128 v[96:99], v210 offset:14336
    s_waitcnt vmcnt(6)
    v_max3_u32 v236, v192, v193, v194
    v_mfma_f32_16x16x32_bf16 v[220:223], v[144:147], v[188:191], v[220:223]
    v_max3_u32 v237, v195, v196, v197
    v_mfma_f32_16x16x32_bf16 v[224:227], v[148:151], v[188:191], v[224:227]
    ds_read_b128 v[100:103], v210 offset:15360
    v_max3_u32 v236, v236, v198, v199
    v_mfma_f32_16x16x32_bf16 v[228:231], v[152:155], v[188:191], v[228:231]
    ds_read_b128 v[104:107], v210 offset:16384
    v_max_u32 v236, v236, v237
    v_mfma_f32_16x16x32_bf16 v[232:235], v[156:159], v[188:191], v[232:235]
    ds_read_b128 v[108:111], v210 offset:17408
    v_cmp_eq_u32 vcc, -1, v236
    s_cbranch_vccnz L_o_fix4
L_o_ok4:
    s_waitcnt lgkmcnt(12)
    v_mfma_f32_16x16x32_bf16 v[216:219], v[0:3], v[192:195], v[216:219]
    s_add_u32 s65, s64, 16384
    buffer_load_dwordx4 v[184:187], v248, s[52:55], s65 offen sc1
    v_mfma_f32_16x16x32_bf16 v[220:223], v[4:7], v[192:195], v[220:223]
    ds_read_b128 v[112:115], v210 offset:18432
    v_mfma_f32_16x16x32_bf16 v[224:227], v[8:11], v[192:195], v[224:227]
    ds_read_b128 v[116:119], v210 offset:19456
    buffer_load_dwordx4 v[188:191], v248, s[52:55], s65 offen offset:1024 sc1
    v_mfma_f32_16x16x32_bf16 v[228:231], v[12:15], v[192:195], v[228:231]
    v_mfma_f32_16x16x32_bf16 v[232:235], v[16:19], v[192:195], v[232:235]
    ds_read_b128 v[120:123], v210 offset:20480
    s_waitcnt lgkmcnt(12)
    v_mfma_f32_16x16x32_bf16 v[216:219], v[20:23], v[196:199], v[216:219]
    ds_read_b128 v[124:127], v210 offset:21504
    s_waitcnt vmcnt(6)
    v_max3_u32 v236, v160, v161, v162
    v_mfma_f32_16x16x32_bf16 v[220:223], v[24:27], v[196:199], v[220:223]
    v_max3_u32 v237, v163, v164, v165
    v_mfma_f32_16x16x32_bf16 v[224:227], v[28:31], v[196:199], v[224:227]
    ds_read_b128 v[128:131], v210 offset:22528
    v_max3_u32 v236, v236, v166, v167
    v_mfma_f32_16x16x32_bf16 v[228:231], v[32:35], v[196:199], v[228:231]
    ds_read_b128 v[132:135], v210 offset:23552
    v_max_u32 v236, v236, v237
    v_mfma_f32_16x16x32_bf16 v[232:235], v[36:39], v[196:199], v[232:235]
    ds_read_b128 v[136:139], v210 offset:24576
    v_cmp_eq_u32 vcc, -1, v236
    s_cbranch_vccnz L_o_fix5
L_o_ok5:
    s_waitcnt lgkmcnt(12)
    v_mfma_f32_16x16x32_bf16 v[216:219], v[40:43], v[160:163], v[216:219]
    buffer_load_dwordx4 v[192:195], v248, s[52:55], s65 offen offset:2048 sc1
    v_mfma_f32_16x16x32_bf16 v[220:223], v[44:47], v[160:163], v[220:223]
    ds_read_b128 v[140:143], v248 offset:0
    v_mfma_f32_16x16x32_bf16 v[224:227], v[48:51], v[160:163], v[224:227]
    ds_read_b128 v[144:147], v248 offset:1024
    buffer_load_dwordx4 v[196:199], v248, s[52:55], s65 offen offset:3072 sc1
    v_mfma_f32_16x16x32_bf16 v[228:231], v[52:55], v[160:163], v[228:231]
    v_mfma_f32_16x16x32_bf16 v[232:235], v[56:59], v[160:163], v[232:235]
    ds_read_b128 v[148:151], v248 offset:2048
    s_waitcnt lgkmcnt(12)
    v_mfma_f32_16x16x32_bf16 v[216:219], v[60:63], v[164:167], v[216:219]
    ds_read_b128 v[152:155], v248 offset:3072
    s_waitcnt vmcnt(6)
    v_max3_u32 v236, v168, v169, v170
    v_mfma_f32_16x16x32_bf16 v[220:223], v[64:67], v[164:167], v[220:223]
    v_max3_u32 v237, v171, v172, v173
    v_mfma_f32_16x16x32_bf16 v[224:227], v[68:71], v[164:167], v[224:227]
    ds_read_b128 v[156:159], v248 offset:4096
    v_max3_u32 v236, v236, v174, v175
    v_mfma_f32_16x16x32_bf16 v[228:231], v[72:75], v[164:167], v[228:231]
    ds_read_b128 v[0:3], v248 offset:5120
    v_max_u32 v236, v236, v237
    v_mfma_f32_16x16x32_bf16 v[232:235], v[76:79], v[164:167], v[232:235]
    ds_read_b128 v[4:7], v248 offset:6144
    v_cmp_eq_u32 vcc, -1, v236
    s_cbranch_vccnz L_o_fix6
L_o_ok6:
    s_waitcnt lgkmcnt(12)
    v_mfma_f32_16x16x32_bf16 v[216:219], v[80:83], v[168:171], v[216:219]
    v_mfma_f32_16x16x32_bf16 v[220:223], v[84:87], v[168:171], v[220:223]
    ds_read_b128 v[8:11], v248 offset:7168
    v_mfma_f32_16x16x32_bf16 v[224:227], v[88:91], v[168:171], v[224:227]
    ds_read_b128 v[12:15], v248 offset:8192
    v_mfma_f32_16x16x32_bf16 v[228:231], v[92:95], v[168:171], v[228:231]
    v_mfma_f32_16x16x32_bf16 v[232:235], v[96:99], v[168:171], v[232:235]
    ds_read_b128 v[16:19], v248 offset:9216
    s_waitcnt lgkmcnt(12)
    v_mfma_f32_16x16x32_bf16 v[216:219], v[100:103], v[172:175], v[216:219]
    ds_read_b128 v[20:23], v248 offset:10240
    s_waitcnt vmcnt(4)
    v_max3_u32 v236, v176, v177, v178
    v_mfma_f32_16x16x32_bf16 v[220:223], v[104:107], v[172:175], v[220:223]
    v_max3_u32 v237, v179, v180, v181
    v_mfma_f32_16x16x32_bf16 v[224:227], v[108:111], v[172:175], v[224:227]
    ds_read_b128 v[24:27], v248 offset:11264
    v_max3_u32 v236, v236, v182, v183
    v_mfma_f32_16x16x32_bf16 v[228:231], v[112:115], v[172:175], v[228:231]
    ds_read_b128 v[28:31], v248 offset:12288
    v_max_u32 v236, v236, v237
    v_mfma_f32_16x16x32_bf16 v[232:235], v[116:119], v[172:175], v[232:235]
    ds_read_b128 v[32:35], v248 offset:13312
    v_cmp_eq_u32 vcc, -1, v236
    s_cbranch_vccnz L_o_fix7
L_o_ok7:
    s_waitcnt lgkmcnt(12)
    v_mfma_f32_16x16x32_bf16 v[216:219], v[120:123], v[176:179], v[216:219]
    v_mfma_f32_16x16x32_bf16 v[220:223], v[124:127], v[176:179], v[220:223]
    ds_read_b128 v[36:39], v248 offset:14336
    v_mfma_f32_16x16x32_bf16 v[224:227], v[128:131], v[176:179], v[224:227]
    ds_read_b128 v[40:43], v248 offset:15360
    v_mfma_f32_16x16x32_bf16 v[228:231], v[132:135], v[176:179], v[228:231]
    v_mfma_f32_16x16x32_bf16 v[232:235], v[136:139], v[176:179], v[232:235]
    ds_read_b128 v[44:47], v248 offset:16384
    s_waitcnt lgkmcnt(12)
    v_mfma_f32_16x16x32_bf16 v[216:219], v[140:143], v[180:183], v[216:219]
    ds_read_b128 v[48:51], v248 offset:17408
    s_waitcnt vmcnt(2)
    v_max3_u32 v236, v184, v185, v186
    v_mfma_f32_16x16x32_bf16 v[220:223], v[144:147], v[180:183], v[220:223]
    v_max3_u32 v237, v187, v188, v189
    v_mfma_f32_16x16x32_bf16 v[224:227], v[148:151], v[180:183], v[224:227]
    ds_read_b128 v[52:55], v248 offset:18432
    v_max3_u32 v236, v236, v190, v191
    v_mfma_f32_16x16x32_bf16 v[228:231], v[152:155], v[180:183], v[228:231]
    ds_read_b128 v[56:59], v248 offset:19456
    v_max_u32 v236, v236, v237
    v_mfma_f32_16x16x32_bf16 v[232:235], v[156:159], v[180:183], v[232:235]
    ds_read_b128 v[60:63], v248 offset:20480
    v_cmp_eq_u32 vcc, -1, v236
    s_cbranch_vccnz L_o_fix8
L_o_ok8:
    s_waitcnt lgkmcnt(11)
    v_mfma_f32_16x16x32_bf16 v[216:219], v[0:3], v[184:187], v[216:219]
    v_mfma_f32_16x16x32_bf16 v[220:223], v[4:7], v[184:187], v[220:223]
    ds_read_b128 v[64:67], v248 offset:21504
    v_mfma_f32_16x16x32_bf16 v[224:227], v[8:11], v[184:187], v[224:227]
    ds_read_b128 v[68:71], v248 offset:22528
    v_mfma_f32_16x16x32_bf16 v[228:231], v[12:15], v[184:187], v[228:231]
    v_mfma_f32_16x16x32_bf16 v[232:235], v[16:19], v[184:187], v[232:235]
    ds_read_b128 v[72:75], v248 offset:23552
    s_waitcnt lgkmcnt(9)
    v_mfma_f32_16x16x32_bf16 v[216:219], v[20:23], v[188:191], v[216:219]
    ds_read_b128 v[76:79], v248 offset:24576
    s_waitcnt vmcnt(0)
    v_max3_u32 v236, v192, v193, v194
    v_mfma_f32_16x16x32_bf16 v[220:223], v[24:27], v[188:191], v[220:223]
    v_max3_u32 v237, v195, v196, v197
    v_mfma_f32_16x16x32_bf16 v[224:227], v[28:31], v[188:191], v[224:227]
    v_max3_u32 v236, v236, v198, v199
    v_mfma_f32_16x16x32_bf16 v[228:231], v[32:35], v[188:191], v[228:231]
    v_max_u32 v236, v236, v237
    v_mfma_f32_16x16x32_bf16 v[232:235], v[36:39], v[188:191], v[232:235]
    v_cmp_eq_u32 vcc, -1, v236
    s_cbranch_vccnz L_o_fix9
L_o_ok9:
    s_waitcnt lgkmcnt(5)
    v_mfma_f32_16x16x32_bf16 v[216:219], v[40:43], v[192:195], v[216:219]
    v_mfma_f32_16x16x32_bf16 v[220:223], v[44:47], v[192:195], v[220:223]
    v_mfma_f32_16x16x32_bf16 v[224:227], v[48:51], v[192:195], v[224:227]
    v_mfma_f32_16x16x32_bf16 v[228:231], v[52:55], v[192:195], v[228:231]
    v_mfma_f32_16x16x32_bf16 v[232:235], v[56:59], v[192:195], v[232:235]
    s_waitcnt lgkmcnt(0)
    v_mfma_f32_16x16x32_bf16 v[216:219], v[60:63], v[196:199], v[216:219]
    v_mfma_f32_16x16x32_bf16 v[220:223], v[64:67], v[196:199], v[220:223]
    v_mfma_f32_16x16x32_bf16 v[224:227], v[68:71], v[196:199], v[224:227]
    v_mfma_f32_16x16x32_bf16 v[228:231], v[72:75], v[196:199], v[228:231]
    v_mfma_f32_16x16x32_bf16 v[232:235], v[76:79], v[196:199], v[232:235]
    s_nop 3
    ds_write_b128 v242, v[216:219] offset:25600
    ds_write_b128 v242, v[220:223] offset:25664
    ds_write_b128 v242, v[224:227] offset:25728
    ds_write_b128 v242, v[228:231] offset:25792
    ds_write_b128 v242, v[232:235] offset:25856
    ds_read_b128 v[0:3], v200
    ds_read_b128 v[4:7], v201
    ds_read_b128 v[8:11], v202
    ds_read_b128 v[12:15], v203
    ds_read_b128 v[16:19], v204
    s_waitcnt lgkmcnt(4)
    buffer_store_dwordx4 v[0:3], v205, s[48:51], s73 offen sc1
    s_waitcnt lgkmcnt(3)
    buffer_store_dwordx4 v[4:7], v206, s[48:51], s73 offen sc1
    s_waitcnt lgkmcnt(2)
    buffer_store_dwordx4 v[8:11], v207, s[48:51], s73 offen sc1
    s_waitcnt lgkmcnt(1)
    buffer_store_dwordx4 v[12:15], v208, s[48:51], s73 offen sc1
    s_waitcnt lgkmcnt(0)
    buffer_store_dwordx4 v[16:19], v209, s[48:51], s73 offen sc1
    s_endpgm
L_rowmax:
    v_lshlrev_b32 v44, 2, v255
    v_mov_b32 v42, 0xff800000
    v_mov_b32 v43, 0xff800000
    s_mov_b32 s73, 0
L_rowmax_loop:
    buffer_load_dwordx4 v[32:35], v248, s[48:51], s73 offen sc1
    buffer_load_dwordx4 v[36:39], v248, s[48:51], s73 offen offset:1024 sc1
    buffer_load_dword v40, v44, s[48:51], s73 offen offset:2048 sc1
    buffer_load_dword v41, v44, s[48:51], s73 offen offset:2304 sc1
    s_add_u32 s73, s73, 5376
    s_waitcnt vmcnt(0)
    v_mfma_f32_32x32x16_bf16 v[0:15], v[32:35], v[128:131], 0
    v_mfma_f32_32x32x8_bf16 v[0:15], v[40:41], v[136:137], v[0:15]
    v_mfma_f32_32x32x16_bf16 v[16:31], v[32:35], v[132:135], 0
    v_mfma_f32_32x32x8_bf16 v[16:31], v[40:41], v[140:141], v[16:31]
    s_nop 9
    v_max3_f32 v42, v0, v1, v42
    v_max3_f32 v42, v2, v3, v42
    v_max3_f32 v42, v4, v5, v42
    v_max3_f32 v42, v6, v7, v42
    v_max3_f32 v42, v8, v9, v42
    v_max3_f32 v42, v10, v11, v42
    v_max3_f32 v42, v12, v13, v42
    v_max3_f32 v42, v14, v15, v42
    v_max3_f32 v43, v16, v17, v43
    v_max3_f32 v43, v18, v19, v43
    v_max3_f32 v43, v20, v21, v43
    v_max3_f32 v43, v22, v23, v43
    v_max3_f32 v43, v24, v25, v43
    v_max3_f32 v43, v26, v27, v43
    v_max3_f32 v43, v28, v29, v43
    v_max3_f32 v43, v30, v31, v43
    v_mfma_f32_32x32x16_bf16 v[0:15], v[36:39], v[128:131], 0
    v_mfma_f32_32x32x8_bf16 v[0:15], v[40:41], v[138:139], v[0:15]
    v_mfma_f32_32x32x16_bf16 v[16:31], v[36:39], v[132:135], 0
    v_mfma_f32_32x32x8_bf16 v[16:31], v[40:41], v[142:143], v[16:31]
    s_nop 9
    v_max3_f32 v42, v0, v1, v42
    v_max3_f32 v42, v2, v3, v42
    v_max3_f32 v42, v4, v5, v42
    v_max3_f32 v42, v6, v7, v42
    v_max3_f32 v42, v8, v9, v42
    v_max3_f32 v42, v10, v11, v42
    v_max3_f32 v42, v12, v13, v42
    v_max3_f32 v42, v14, v15, v42
    v_max3_f32 v43, v16, v17, v43
    v_max3_f32 v43, v18, v19, v43
    v_max3_f32 v43, v20, v21, v43
    v_max3_f32 v43, v22, v23, v43
    v_max3_f32 v43, v24, v25, v43
    v_max3_f32 v43, v26, v27, v43
    v_max3_f32 v43, v28, v29, v43
    v_max3_f32 v43, v30, v31, v43
    s_cmp_lt_u32 s73, 172032
    s_cbranch_scc1 L_rowmax_loop
    v_mov_b32 v44, v42
    s_nop 1
    v_permlane32_swap_b32 v42, v44
    v_max_f32 v42, v42, v44
    v_sub_f32 v96, 0, v42
    v_sub_f32 v97, 0, v42
    v_sub_f32 v98, 0, v42
    v_sub_f32 v99, 0, v42
    v_sub_f32 v100, 0, v42
    v_sub_f32 v101, 0, v42
    v_sub_f32 v102, 0, v42
    v_sub_f32 v103, 0, v42
    v_sub_f32 v104, 0, v42
    v_sub_f32 v105, 0, v42
    v_sub_f32 v106, 0, v42
    v_sub_f32 v107, 0, v42
    v_sub_f32 v108, 0, v42
    v_sub_f32 v109, 0, v42
    v_sub_f32 v110, 0, v42
    v_sub_f32 v111, 0, v42
    v_mov_b32 v44, v43
    s_nop 1
    v_permlane32_swap_b32 v43, v44
    v_max_f32 v43, v43, v44
    v_sub_f32 v112, 0, v43
    v_sub_f32 v113, 0, v43
    v_sub_f32 v114, 0, v43
    v_sub_f32 v115, 0, v43
    v_sub_f32 v116, 0, v43
    v_sub_f32 v117, 0, v43
    v_sub_f32 v118, 0, v43
    v_sub_f32 v119, 0, v43
    v_sub_f32 v120, 0, v43
    v_sub_f32 v121, 0, v43
    v_sub_f32 v122, 0, v43
    v_sub_f32 v123, 0, v43
    v_sub_f32 v124, 0, v43
    v_sub_f32 v125, 0, v43
    v_sub_f32 v126, 0, v43
    v_sub_f32 v127, 0, v43
    s_waitcnt lgkmcnt(5)
    v_mfma_f32_32x32x16_bf16 v[0:15], v[144:147], v[128:131], v[96:111]
    v_mfma_f32_32x32x8_bf16 v[0:15], v[154:155], v[136:137], v[0:15]
    v_mfma_f32_32x32x16_bf16 v[16:31], v[144:147], v[132:135], v[112:127]
    v_mfma_f32_32x32x8_bf16 v[16:31], v[154:155], v[140:141], v[16:31]
    s_nop 4
    s_waitcnt vmcnt(0) lgkmcnt(0)
    s_barrier
    s_branch L_a_p0s
.p2align 6
L_a_loops:
    s_waitcnt vmcnt(0) lgkmcnt(0)
    s_barrier
    v_exp_f32 v59, v59
    v_exp_f32 v60, v60
    v_exp_f32 v61, v61
    v_exp_f32 v62, v62
    v_exp_f32 v63, v63
    v_xor_b32 v181, 0x8000, v181
    v_xor_b32 v182, 0x8000, v182
    v_xor_b32 v183, 0x8000, v183
L_a_p0s:
    v_mfma_f32_32x32x16_bf16 v[32:47], v[148:151], v[128:131], v[96:111]
    ds_read_b128 v[144:147], v181 offset:0
    v_exp_f32 v0, v0
    v_exp_f32 v1, v1
    v_exp_f32 v2, v2
    v_smfmac_f32_32x32x32_bf16 v[80:95], v[156:159], v[48:55], v180
    ds_read2st64_b32 v[152:153], v182 offset0:8 offset1:9
    v_exp_f32 v3, v3
    v_exp_f32 v4, v4
    v_exp_f32 v5, v5
    v_exp_f32 v6, v6
    v_mfma_f32_32x32x8_bf16 v[32:47], v[154:155], v[138:139], v[32:47]
    v_exp_f32 v7, v7
    v_exp_f32 v8, v8
    v_exp_f32 v9, v9
    v_exp_f32 v10, v10
    v_smfmac_f32_32x32x32_bf16 v[80:95], v[160:163], v[56:63], v180
    s_sub_u32 s69, s68, s69
    s_add_u32 s64, s64, 32256
    v_exp_f32 v11, v11
    v_exp_f32 v12, v12
    v_exp_f32 v13, v13
    v_exp_f32 v14, v14
    v_exp_f32 v15, v15
    v_mfma_f32_32x32x16_bf16 v[48:63], v[148:151], v[132:135], v[112:127]
    ds_read_b128 v[156:159], v183 offset:2560
    s_cmp_eq_u32 s64, 161280
    v_exp_f32 v16, v16
    v_exp_f32 v17, v17
    v_exp_f32 v18, v18
    v_smfmac_f32_32x32x32_bf16 v[64:79], v[164:167], v[0:7], v180
    ds_read_b128 v[160:163], v183 offset:3264
    s_cselect_b32 s64, 0, s64
    s_add_u32 s71, s64, s65
    v_exp_f32 v19, v19
    v_exp_f32 v20, v20
    v_exp_f32 v21, v21
    v_exp_f32 v22, v22
    v_mfma_f32_32x32x8_bf16 v[48:63], v[154:155], v[142:143], v[48:63]
    v_exp_f32 v23, v23
    v_exp_f32 v24, v24
    v_exp_f32 v25, v25
    v_exp_f32 v26, v26
    v_smfmac_f32_32x32x32_bf16 v[64:79], v[168:171], v[8:15], v180
    s_waitcnt lgkmcnt(2)
    s_mov_b32 m0, s69
    v_exp_f32 v27, v27
    v_exp_f32 v28, v28
    v_exp_f32 v29, v29
    v_exp_f32 v30, v30
    v_exp_f32 v31, v31
    v_mfma_f32_32x32x16_bf16 v[0:15], v[144:147], v[128:131], v[96:111]
    ds_read_b128 v[148:151], v181 offset:1024
    v_exp_f32 v32, v32
    v_exp_f32 v33, v33
    v_exp_f32 v34, v34
    v_smfmac_f32_32x32x32_bf16 v[80:95], v[164:167], v[16:23], v180
    v_exp_f32 v35, v35
    v_exp_f32 v36, v36
    v_exp_f32 v37, v37
    v_exp_f32 v38, v38
    v_mfma_f32_32x32x8_bf16 v[0:15], v[152:153], v[136:137], v[0:15]
    v_exp_f32 v39, v39
    v_exp_f32 v40, v40
    v_exp_f32 v41, v41
    v_exp_f32 v42, v42
    v_smfmac_f32_32x32x32_bf16 v[80:95], v[168:171], v[24:31], v180
    buffer_load_dwordx4 v248, s[48:51], s71 offen sc1 lds
    v_exp_f32 v43, v43
    v_exp_f32 v44, v44
    v_exp_f32 v45, v45
    v_exp_f32 v46, v46
    v_exp_f32 v47, v47
    v_mfma_f32_32x32x16_bf16 v[16:31], v[144:147], v[132:135], v[112:127]
    ds_read_b128 v[164:167], v183 offset:3968
    v_exp_f32 v48, v48
    v_exp_f32 v49, v49
    v_exp_f32 v50, v50
    v_smfmac_f32_32x32x32_bf16 v[64:79], v[172:175], v[32:39], v180
    ds_read_b128 v[168:171], v183 offset:4672
    v_exp_f32 v51, v51
    v_exp_f32 v52, v52
    v_exp_f32 v53, v53
    v_exp_f32 v54, v54
    v_mfma_f32_32x32x8_bf16 v[16:31], v[152:153], v[140:141], v[16:31]
    v_exp_f32 v55, v55
    v_exp_f32 v56, v56
    v_exp_f32 v57, v57
    v_exp_f32 v58, v58
    v_smfmac_f32_32x32x32_bf16 v[64:79], v[176:179], v[40:47], v180
    s_waitcnt lgkmcnt(2)
    v_exp_f32 v59, v59
    v_exp_f32 v60, v60
    v_exp_f32 v61, v61
    v_exp_f32 v62, v62
    v_exp_f32 v63, v63
    v_mfma_f32_32x32x16_bf16 v[32:47], v[148:151], v[128:131], v[96:111]
    ds_read_b128 v[144:147], v181 offset:5376
    v_exp_f32 v0, v0
    v_exp_f32 v1, v1
    v_exp_f32 v2, v2
    v_smfmac_f32_32x32x32_bf16 v[80:95], v[172:175], v[48:55], v180
    ds_read2st64_b32 v[154:155], v182 offset0:29 offset1:30
    v_exp_f32 v3, v3
    v_exp_f32 v4, v4
    v_exp_f32 v5, v5
    v_exp_f32 v6, v6
    v_mfma_f32_32x32x8_bf16 v[32:47], v[152:153], v[138:139], v[32:47]
    v_exp_f32 v7, v7
    v_exp_f32 v8, v8
    v_exp_f32 v9, v9
    v_exp_f32 v10, v10
    v_smfmac_f32_32x32x32_bf16 v[80:95], v[176:179], v[56:63], v180
    buffer_load_dwordx4 v248, s[48:51], s71 offen offset:1024 sc1 lds
    v_exp_f32 v11, v11
    v_exp_f32 v12, v12
    v_exp_f32 v13, v13
    v_exp_f32 v14, v14
    v_exp_f32 v15, v15
    v_mfma_f32_32x32x16_bf16 v[48:63], v[148:151], v[132:135], v[112:127]
    ds_read_b128 v[172:175], v183 offset:7936
    v_exp_f32 v16, v16
    v_exp_f32 v17, v17
    v_exp_f32 v18, v18
    v_smfmac_f32_32x32x32_bf16 v[64:79], v[156:159], v[0:7], v180
    ds_read_b128 v[176:179], v183 offset:8640
    v_exp_f32 v19, v19
    v_exp_f32 v20, v20
    v_exp_f32 v21, v21
    v_exp_f32 v22, v22
    v_mfma_f32_32x32x8_bf16 v[48:63], v[152:153], v[142:143], v[48:63]
    v_exp_f32 v23, v23
    v_exp_f32 v24, v24
    v_exp_f32 v25, v25
    v_exp_f32 v26, v26
    v_smfmac_f32_32x32x32_bf16 v[64:79], v[160:163], v[8:15], v180
    s_waitcnt lgkmcnt(2)
    v_exp_f32 v27, v27
    v_exp_f32 v28, v28
    v_exp_f32 v29, v29
    v_exp_f32 v30, v30
    v_exp_f32 v31, v31
    v_mfma_f32_32x32x16_bf16 v[0:15], v[144:147], v[128:131], v[96:111]
    ds_read_b128 v[148:151], v181 offset:6400
    v_exp_f32 v32, v32
    v_exp_f32 v33, v33
    v_exp_f32 v34, v34
    v_smfmac_f32_32x32x32_bf16 v[80:95], v[156:159], v[16:23], v180
    v_exp_f32 v35, v35
    v_exp_f32 v36, v36
    v_exp_f32 v37, v37
    v_exp_f32 v38, v38
    v_mfma_f32_32x32x8_bf16 v[0:15], v[154:155], v[136:137], v[0:15]
    v_exp_f32 v39, v39
    v_exp_f32 v40, v40
    v_exp_f32 v41, v41
    v_exp_f32 v42, v42
    v_smfmac_f32_32x32x32_bf16 v[80:95], v[160:163], v[24:31], v180
    buffer_load_dwordx4 v248, s[48:51], s71 offen offset:2048 sc1 lds
    v_exp_f32 v43, v43
    v_exp_f32 v44, v44
    v_exp_f32 v45, v45
    v_exp_f32 v46, v46
    v_exp_f32 v47, v47
    v_mfma_f32_32x32x16_bf16 v[16:31], v[144:147], v[132:135], v[112:127]
    ds_read_b128 v[156:159], v183 offset:9344
    v_exp_f32 v48, v48
    v_exp_f32 v49, v49
    v_exp_f32 v50, v50
    v_smfmac_f32_32x32x32_bf16 v[64:79], v[164:167], v[32:39], v180
    ds_read_b128 v[160:163], v183 offset:10048
    v_exp_f32 v51, v51
    v_exp_f32 v52, v52
    v_exp_f32 v53, v53
    v_exp_f32 v54, v54
    v_mfma_f32_32x32x8_bf16 v[16:31], v[154:155], v[140:141], v[16:31]
    v_exp_f32 v55, v55
    v_exp_f32 v56, v56
    v_exp_f32 v57, v57
    v_exp_f32 v58, v58
    v_smfmac_f32_32x32x32_bf16 v[64:79], v[168:171], v[40:47], v180
    s_waitcnt lgkmcnt(2)
    v_exp_f32 v59, v59
    v_exp_f32 v60, v60
    v_exp_f32 v61, v61
    v_exp_f32 v62, v62
    v_exp_f32 v63, v63
    v_mfma_f32_32x32x16_bf16 v[32:47], v[148:151], v[128:131], v[96:111]
    ds_read_b128 v[144:147], v181 offset:10752
    v_exp_f32 v0, v0
    v_exp_f32 v1, v1
    v_exp_f32 v2, v2
    v_smfmac_f32_32x32x32_bf16 v[80:95], v[164:167], v[48:55], v180
    ds_read2st64_b32 v[152:153], v182 offset0:50 offset1:51
    v_exp_f32 v3, v3
    v_exp_f32 v4, v4
    v_exp_f32 v5, v5
    v_exp_f32 v6, v6
    v_mfma_f32_32x32x8_bf16 v[32:47], v[154:155], v[138:139], v[32:47]
    v_exp_f32 v7, v7
    v_exp_f32 v8, v8
    v_exp_f32 v9, v9
    v_exp_f32 v10, v10
    v_smfmac_f32_32x32x32_bf16 v[80:95], v[168:171], v[56:63], v180
    buffer_load_dwordx4 v248, s[48:51], s71 offen offset:3072 sc1 lds
    v_exp_f32 v11, v11
    v_exp_f32 v12, v12
    v_exp_f32 v13, v13
    v_exp_f32 v14, v14
    v_exp_f32 v15, v15
    v_mfma_f32_32x32x16_bf16 v[48:63], v[148:151], v[132:135], v[112:127]
    ds_read_b128 v[164:167], v183 offset:13312
    v_exp_f32 v16, v16
    v_exp_f32 v17, v17
    v_exp_f32 v18, v18
    v_smfmac_f32_32x32x32_bf16 v[64:79], v[172:175], v[0:7], v180
    ds_read_b128 v[168:171], v183 offset:14016
    s_add_u32 s71, s71, 4096
    v_exp_f32 v19, v19
    v_exp_f32 v20, v20
    v_exp_f32 v21, v21
    v_exp_f32 v22, v22
    v_mfma_f32_32x32x8_bf16 v[48:63], v[154:155], v[142:143], v[48:63]
    v_exp_f32 v23, v23
    v_exp_f32 v24, v24
    v_exp_f32 v25, v25
    v_exp_f32 v26, v26
    v_smfmac_f32_32x32x32_bf16 v[64:79], v[176:179], v[8:15], v180
    s_waitcnt lgkmcnt(2)
    s_add_u32 m0, s69, 4096
    v_exp_f32 v27, v27
    v_exp_f32 v28, v28
    v_exp_f32 v29, v29
    v_exp_f32 v30, v30
    v_exp_f32 v31, v31
    v_mfma_f32_32x32x16_bf16 v[0:15], v[144:147], v[128:131], v[96:111]
    ds_read_b128 v[148:151], v181 offset:11776
    v_exp_f32 v32, v32
    v_exp_f32 v33, v33
    v_exp_f32 v34, v34
    v_smfmac_f32_32x32x32_bf16 v[80:95], v[172:175], v[16:23], v180
    v_exp_f32 v35, v35
    v_exp_f32 v36, v36
    v_exp_f32 v37, v37
    v_exp_f32 v38, v38
    v_mfma_f32_32x32x8_bf16 v[0:15], v[152:153], v[136:137], v[0:15]
    v_exp_f32 v39, v39
    v_exp_f32 v40, v40
    v_exp_f32 v41, v41
    v_exp_f32 v42, v42
    v_smfmac_f32_32x32x32_bf16 v[80:95], v[176:179], v[24:31], v180
    buffer_load_dwordx4 v248, s[48:51], s71 offen sc1 lds
    v_exp_f32 v43, v43
    v_exp_f32 v44, v44
    v_exp_f32 v45, v45
    v_exp_f32 v46, v46
    v_exp_f32 v47, v47
    v_mfma_f32_32x32x16_bf16 v[16:31], v[144:147], v[132:135], v[112:127]
    ds_read_b128 v[172:175], v183 offset:14720
    v_exp_f32 v48, v48
    v_exp_f32 v49, v49
    v_exp_f32 v50, v50
    v_smfmac_f32_32x32x32_bf16 v[64:79], v[156:159], v[32:39], v180
    ds_read_b128 v[176:179], v183 offset:15424
    v_exp_f32 v51, v51
    v_exp_f32 v52, v52
    v_exp_f32 v53, v53
    v_exp_f32 v54, v54
    v_mfma_f32_32x32x8_bf16 v[16:31], v[152:153], v[140:141], v[16:31]
    v_exp_f32 v55, v55
    v_exp_f32 v56, v56
    v_exp_f32 v57, v57
    v_exp_f32 v58, v58
    v_smfmac_f32_32x32x32_bf16 v[64:79], v[160:163], v[40:47], v180
    s_waitcnt lgkmcnt(2)
    v_exp_f32 v59, v59
    v_exp_f32 v60, v60
    v_exp_f32 v61, v61
    v_exp_f32 v62, v62
    v_exp_f32 v63, v63
    v_mfma_f32_32x32x16_bf16 v[32:47], v[148:151], v[128:131], v[96:111]
    ds_read_b128 v[144:147], v181 offset:16128
    v_exp_f32 v0, v0
    v_exp_f32 v1, v1
    v_exp_f32 v2, v2
    v_smfmac_f32_32x32x32_bf16 v[80:95], v[156:159], v[48:55], v180
    ds_read2st64_b32 v[154:155], v182 offset0:71 offset1:72
    v_exp_f32 v3, v3
    v_exp_f32 v4, v4
    v_exp_f32 v5, v5
    v_exp_f32 v6, v6
    v_mfma_f32_32x32x8_bf16 v[32:47], v[152:153], v[138:139], v[32:47]
    v_exp_f32 v7, v7
    v_exp_f32 v8, v8
    v_exp_f32 v9, v9
    v_exp_f32 v10, v10
    v_smfmac_f32_32x32x32_bf16 v[80:95], v[160:163], v[56:63], v180
    buffer_load_dwordx4 v248, s[48:51], s71 offen offset:1024 sc1 lds
    v_exp_f32 v11, v11
    v_exp_f32 v12, v12
    v_exp_f32 v13, v13
    v_exp_f32 v14, v14
    v_exp_f32 v15, v15
    v_mfma_f32_32x32x16_bf16 v[48:63], v[148:151], v[132:135], v[112:127]
    ds_read_b128 v[156:159], v183 offset:18688
    v_exp_f32 v16, v16
    v_exp_f32 v17, v17
    v_exp_f32 v18, v18
    v_smfmac_f32_32x32x32_bf16 v[64:79], v[164:167], v[0:7], v180
    ds_read_b128 v[160:163], v183 offset:19392
    v_exp_f32 v19, v19
    v_exp_f32 v20, v20
    v_exp_f32 v21, v21
    v_exp_f32 v22, v22
    v_mfma_f32_32x32x8_bf16 v[48:63], v[152:153], v[142:143], v[48:63]
    v_exp_f32 v23, v23
    v_exp_f32 v24, v24
    v_exp_f32 v25, v25
    v_exp_f32 v26, v26
    v_smfmac_f32_32x32x32_bf16 v[64:79], v[168:171], v[8:15], v180
    s_waitcnt lgkmcnt(2)
    v_exp_f32 v27, v27
    v_exp_f32 v28, v28
    v_exp_f32 v29, v29
    v_exp_f32 v30, v30
    v_exp_f32 v31, v31
    v_mfma_f32_32x32x16_bf16 v[0:15], v[144:147], v[128:131], v[96:111]
    ds_read_b128 v[148:151], v181 offset:17152
    v_exp_f32 v32, v32
    v_exp_f32 v33, v33
    v_exp_f32 v34, v34
    v_smfmac_f32_32x32x32_bf16 v[80:95], v[164:167], v[16:23], v180
    v_exp_f32 v35, v35
    v_exp_f32 v36, v36
    v_exp_f32 v37, v37
    v_exp_f32 v38, v38
    v_mfma_f32_32x32x8_bf16 v[0:15], v[154:155], v[136:137], v[0:15]
    v_exp_f32 v39, v39
    v_exp_f32 v40, v40
    v_exp_f32 v41, v41
    v_exp_f32 v42, v42
    v_smfmac_f32_32x32x32_bf16 v[80:95], v[168:171], v[24:31], v180
    buffer_load_dwordx4 v248, s[48:51], s71 offen offset:2048 sc1 lds
    v_exp_f32 v43, v43
    v_exp_f32 v44, v44
    v_exp_f32 v45, v45
    v_exp_f32 v46, v46
    v_exp_f32 v47, v47
    v_mfma_f32_32x32x16_bf16 v[16:31], v[144:147], v[132:135], v[112:127]
    ds_read_b128 v[164:167], v183 offset:20096
    v_exp_f32 v48, v48
    v_exp_f32 v49, v49
    v_exp_f32 v50, v50
    v_smfmac_f32_32x32x32_bf16 v[64:79], v[172:175], v[32:39], v180
    ds_read_b128 v[168:171], v183 offset:20800
    v_exp_f32 v51, v51
    v_exp_f32 v52, v52
    v_exp_f32 v53, v53
    v_exp_f32 v54, v54
    v_mfma_f32_32x32x8_bf16 v[16:31], v[154:155], v[140:141], v[16:31]
    v_exp_f32 v55, v55
    v_exp_f32 v56, v56
    v_exp_f32 v57, v57
    v_exp_f32 v58, v58
    v_smfmac_f32_32x32x32_bf16 v[64:79], v[176:179], v[40:47], v180
    s_waitcnt lgkmcnt(2)
    v_exp_f32 v59, v59
    v_exp_f32 v60, v60
    v_exp_f32 v61, v61
    v_exp_f32 v62, v62
    v_exp_f32 v63, v63
    v_mfma_f32_32x32x16_bf16 v[32:47], v[148:151], v[128:131], v[96:111]
    ds_read_b128 v[144:147], v181 offset:21504
    v_exp_f32 v0, v0
    v_exp_f32 v1, v1
    v_exp_f32 v2, v2
    v_smfmac_f32_32x32x32_bf16 v[80:95], v[172:175], v[48:55], v180
    ds_read2st64_b32 v[152:153], v182 offset0:92 offset1:93
    v_exp_f32 v3, v3
    v_exp_f32 v4, v4
    v_exp_f32 v5, v5
    v_exp_f32 v6, v6
    v_mfma_f32_32x32x8_bf16 v[32:47], v[154:155], v[138:139], v[32:47]
    v_exp_f32 v7, v7
    v_exp_f32 v8, v8
    v_exp_f32 v9, v9
    v_exp_f32 v10, v10
    v_smfmac_f32_32x32x32_bf16 v[80:95], v[176:179], v[56:63], v180
    buffer_load_dwordx4 v248, s[48:51], s71 offen offset:3072 sc1 lds
    v_exp_f32 v11, v11
    v_exp_f32 v12, v12
    v_exp_f32 v13, v13
    v_exp_f32 v14, v14
    v_exp_f32 v15, v15
    v_mfma_f32_32x32x16_bf16 v[48:63], v[148:151], v[132:135], v[112:127]
    ds_read_b128 v[172:175], v183 offset:24064
    v_exp_f32 v16, v16
    v_exp_f32 v17, v17
    v_exp_f32 v18, v18
    v_smfmac_f32_32x32x32_bf16 v[64:79], v[156:159], v[0:7], v180
    ds_read_b128 v[176:179], v183 offset:24768
    s_cmp_eq_u32 s66, 3
    v_exp_f32 v19, v19
    v_exp_f32 v20, v20
    v_exp_f32 v21, v21
    v_exp_f32 v22, v22
    v_mfma_f32_32x32x8_bf16 v[48:63], v[154:155], v[142:143], v[48:63]
    v_exp_f32 v23, v23
    v_exp_f32 v24, v24
    v_exp_f32 v25, v25
    v_exp_f32 v26, v26
    v_smfmac_f32_32x32x32_bf16 v[64:79], v[160:163], v[8:15], v180
    s_waitcnt lgkmcnt(2)
    s_cselect_b32 s72, 0, 0x7fff0000
    v_exp_f32 v27, v27
    v_exp_f32 v28, v28
    v_exp_f32 v29, v29
    v_exp_f32 v30, v30
    v_exp_f32 v31, v31
    v_mfma_f32_32x32x16_bf16 v[0:15], v[144:147], v[128:131], v[96:111]
    ds_read_b128 v[148:151], v181 offset:22528
    v_exp_f32 v32, v32
    v_exp_f32 v33, v33
    v_exp_f32 v34, v34
    v_smfmac_f32_32x32x32_bf16 v[80:95], v[156:159], v[16:23], v180
    v_exp_f32 v35, v35
    v_exp_f32 v36, v36
    v_exp_f32 v37, v37
    v_exp_f32 v38, v38
    v_mfma_f32_32x32x8_bf16 v[0:15], v[152:153], v[136:137], v[0:15]
    v_exp_f32 v39, v39
    v_exp_f32 v40, v40
    v_exp_f32 v41, v41
    v_exp_f32 v42, v42
    v_smfmac_f32_32x32x32_bf16 v[80:95], v[160:163], v[24:31], v180
    buffer_load_dword v194, v193, s[56:59], s72 offen offset:128 sc1
    v_exp_f32 v43, v43
    v_exp_f32 v44, v44
    v_exp_f32 v45, v45
    v_exp_f32 v46, v46
    v_exp_f32 v47, v47
    v_mfma_f32_32x32x16_bf16 v[16:31], v[144:147], v[132:135], v[112:127]
    ds_read_b128 v[156:159], v183 offset:25472
    v_exp_f32 v48, v48
    v_exp_f32 v49, v49
    v_exp_f32 v50, v50
    v_smfmac_f32_32x32x32_bf16 v[64:79], v[164:167], v[32:39], v180
    ds_read_b128 v[160:163], v183 offset:26176
    v_exp_f32 v51, v51
    v_exp_f32 v52, v52
    v_exp_f32 v53, v53
    v_exp_f32 v54, v54
    v_mfma_f32_32x32x8_bf16 v[16:31], v[152:153], v[140:141], v[16:31]
    v_exp_f32 v55, v55
    v_exp_f32 v56, v56
    v_exp_f32 v57, v57
    v_exp_f32 v58, v58
    v_smfmac_f32_32x32x32_bf16 v[64:79], v[168:171], v[40:47], v180
    s_waitcnt lgkmcnt(2)
    v_exp_f32 v59, v59
    v_exp_f32 v60, v60
    v_exp_f32 v61, v61
    v_exp_f32 v62, v62
    v_exp_f32 v63, v63
    v_mfma_f32_32x32x16_bf16 v[32:47], v[148:151], v[128:131], v[96:111]
    ds_read_b128 v[144:147], v181 offset:26880
    v_exp_f32 v0, v0
    v_exp_f32 v1, v1
    v_exp_f32 v2, v2
    v_smfmac_f32_32x32x32_bf16 v[80:95], v[164:167], v[48:55], v180
    ds_read2st64_b32 v[154:155], v182 offset0:113 offset1:114
    v_exp_f32 v3, v3
    v_exp_f32 v4, v4
    v_exp_f32 v5, v5
    v_exp_f32 v6, v6
    v_mfma_f32_32x32x8_bf16 v[32:47], v[152:153], v[138:139], v[32:47]
    v_exp_f32 v7, v7
    v_exp_f32 v8, v8
    v_exp_f32 v9, v9
    v_exp_f32 v10, v10
    v_smfmac_f32_32x32x32_bf16 v[80:95], v[168:171], v[56:63], v180
    v_exp_f32 v11, v11
    v_exp_f32 v12, v12
    v_exp_f32 v13, v13
    v_exp_f32 v14, v14
    v_exp_f32 v15, v15
    v_mfma_f32_32x32x16_bf16 v[48:63], v[148:151], v[132:135], v[112:127]
    ds_read_b128 v[164:167], v183 offset:29440
    v_exp_f32 v16, v16
    v_exp_f32 v17, v17
    v_exp_f32 v18, v18
    v_smfmac_f32_32x32x32_bf16 v[64:79], v[172:175], v[0:7], v180
    ds_read_b128 v[168:171], v183 offset:30144
    v_exp_f32 v19, v19
    v_exp_f32 v20, v20
    v_exp_f32 v21, v21
    v_exp_f32 v22, v22
    v_mfma_f32_32x32x8_bf16 v[48:63], v[152:153], v[142:143], v[48:63]
    v_exp_f32 v23, v23
    v_exp_f32 v24, v24
    v_exp_f32 v25, v25
    v_exp_f32 v26, v26
    v_smfmac_f32_32x32x32_bf16 v[64:79], v[176:179], v[8:15], v180
    s_waitcnt lgkmcnt(2)
    v_exp_f32 v27, v27
    v_exp_f32 v28, v28
    v_exp_f32 v29, v29
    v_exp_f32 v30, v30
    v_exp_f32 v31, v31
    v_mfma_f32_32x32x16_bf16 v[0:15], v[144:147], v[128:131], v[96:111]
    ds_read_b128 v[148:151], v181 offset:27904
    v_exp_f32 v32, v32
    v_exp_f32 v33, v33
    v_exp_f32 v34, v34
    v_smfmac_f32_32x32x32_bf16 v[80:95], v[172:175], v[16:23], v180
    s_add_u32 s66, s66, 1
    s_cmp_lt_u32 s66, 4
    v_exp_f32 v35, v35
    v_exp_f32 v36, v36
    v_exp_f32 v37, v37
    v_exp_f32 v38, v38
    v_mfma_f32_32x32x8_bf16 v[0:15], v[154:155], v[136:137], v[0:15]
    v_exp_f32 v39, v39
    v_exp_f32 v40, v40
    v_exp_f32 v41, v41
    v_exp_f32 v42, v42
    v_smfmac_f32_32x32x32_bf16 v[80:95], v[176:179], v[24:31], v180
    v_exp_f32 v43, v43
    v_exp_f32 v44, v44
    v_exp_f32 v45, v45
    v_exp_f32 v46, v46
    v_exp_f32 v47, v47
    v_mfma_f32_32x32x16_bf16 v[16:31], v[144:147], v[132:135], v[112:127]
    ds_read_b128 v[172:175], v183 offset:30848
    v_exp_f32 v48, v48
    v_exp_f32 v49, v49
    v_exp_f32 v50, v50
    v_smfmac_f32_32x32x32_bf16 v[64:79], v[156:159], v[32:39], v180
    ds_read_b128 v[176:179], v183 offset:31552
    v_exp_f32 v51, v51
    v_exp_f32 v52, v52
    v_exp_f32 v53, v53
    v_exp_f32 v54, v54
    v_mfma_f32_32x32x8_bf16 v[16:31], v[154:155], v[140:141], v[16:31]
    v_exp_f32 v55, v55
    v_exp_f32 v56, v56
    v_exp_f32 v57, v57
    v_exp_f32 v58, v58
    v_smfmac_f32_32x32x32_bf16 v[64:79], v[160:163], v[40:47], v180
    s_cbranch_scc1 L_a_loops
    s_waitcnt vmcnt(0) lgkmcnt(0)
    s_barrier
    v_cmp_gt_u32 vcc, 36, v194
    s_cbranch_vccnz L_a_waits
L_a_cleareds:
    v_mov_b32 v194, 1
    v_exp_f32 v59, v59
    v_exp_f32 v60, v60
    v_exp_f32 v61, v61
    v_exp_f32 v62, v62
    v_exp_f32 v63, v63
    v_xor_b32 v181, 0x8000, v181
    v_xor_b32 v182, 0x8000, v182
    v_xor_b32 v183, 0x8000, v183
    v_mfma_f32_32x32x16_bf16 v[32:47], v[148:151], v[128:131], v[96:111]
    ds_read_b128 v[144:147], v181 offset:0
    v_exp_f32 v0, v0
    v_exp_f32 v1, v1
    v_exp_f32 v2, v2
    v_smfmac_f32_32x32x32_bf16 v[80:95], v[156:159], v[48:55], v180
    ds_read2st64_b32 v[152:153], v182 offset0:8 offset1:9
    v_exp_f32 v3, v3
    v_exp_f32 v4, v4
    v_exp_f32 v5, v5
    v_exp_f32 v6, v6
    v_mfma_f32_32x32x8_bf16 v[32:47], v[154:155], v[138:139], v[32:47]
    v_exp_f32 v7, v7
    v_exp_f32 v8, v8
    v_exp_f32 v9, v9
    v_exp_f32 v10, v10
    v_smfmac_f32_32x32x32_bf16 v[80:95], v[160:163], v[56:63], v180
    v_exp_f32 v11, v11
    v_exp_f32 v12, v12
    v_exp_f32 v13, v13
    v_exp_f32 v14, v14
    v_exp_f32 v15, v15
    v_mfma_f32_32x32x16_bf16 v[48:63], v[148:151], v[132:135], v[112:127]
    ds_read_b128 v[156:159], v183 offset:2560
    v_exp_f32 v16, v16
    v_exp_f32 v17, v17
    v_exp_f32 v18, v18
    v_smfmac_f32_32x32x32_bf16 v[64:79], v[164:167], v[0:7], v180
    ds_read_b128 v[160:163], v183 offset:3264
    s_add_u32 s101, s74, 0
    v_exp_f32 v19, v19
    v_exp_f32 v20, v20
    v_exp_f32 v21, v21
    v_exp_f32 v22, v22
    v_mfma_f32_32x32x8_bf16 v[48:63], v[154:155], v[142:143], v[48:63]
    v_exp_f32 v23, v23
    v_exp_f32 v24, v24
    v_exp_f32 v25, v25
    v_exp_f32 v26, v26
    v_smfmac_f32_32x32x32_bf16 v[64:79], v[168:171], v[8:15], v180
    s_waitcnt lgkmcnt(2)
    s_add_u32 m0, s75, 0
    v_exp_f32 v27, v27
    v_exp_f32 v28, v28
    v_exp_f32 v29, v29
    v_exp_f32 v30, v30
    v_exp_f32 v31, v31
    v_mfma_f32_32x32x16_bf16 v[0:15], v[144:147], v[128:131], v[96:111]
    ds_read_b128 v[148:151], v181 offset:1024
    v_exp_f32 v32, v32
    v_exp_f32 v33, v33
    v_exp_f32 v34, v34
    v_smfmac_f32_32x32x32_bf16 v[80:95], v[164:167], v[16:23], v180
    buffer_store_dwordx4 v[196:199], v192, s[52:55], s70 offen offset:0 sc1
    v_exp_f32 v35, v35
    v_exp_f32 v36, v36
    v_exp_f32 v37, v37
    v_exp_f32 v38, v38
    v_mfma_f32_32x32x8_bf16 v[0:15], v[152:153], v[136:137], v[0:15]
    v_exp_f32 v39, v39
    v_exp_f32 v40, v40
    v_exp_f32 v41, v41
    v_exp_f32 v42, v42
    v_smfmac_f32_32x32x32_bf16 v[80:95], v[168:171], v[24:31], v180
    buffer_load_dwordx4 v248, s[52:55], s101 offen sc1 lds
    v_exp_f32 v43, v43
    v_exp_f32 v44, v44
    v_exp_f32 v45, v45
    v_exp_f32 v46, v46
    v_exp_f32 v47, v47
    v_mfma_f32_32x32x16_bf16 v[16:31], v[144:147], v[132:135], v[112:127]
    ds_read_b128 v[164:167], v183 offset:3968
    v_exp_f32 v48, v48
    v_exp_f32 v49, v49
    v_exp_f32 v50, v50
    v_smfmac_f32_32x32x32_bf16 v[64:79], v[172:175], v[32:39], v180
    ds_read_b128 v[168:171], v183 offset:4672
    v_exp_f32 v51, v51
    v_exp_f32 v52, v52
    v_exp_f32 v53, v53
    v_exp_f32 v54, v54
    v_mfma_f32_32x32x8_bf16 v[16:31], v[152:153], v[140:141], v[16:31]
    v_exp_f32 v55, v55
    v_exp_f32 v56, v56
    v_exp_f32 v57, v57
    v_exp_f32 v58, v58
    v_smfmac_f32_32x32x32_bf16 v[64:79], v[176:179], v[40:47], v180
    s_waitcnt lgkmcnt(2)
    buffer_store_dwordx4 v[196:199], v192, s[52:55], s70 offen offset:512 sc1
    v_exp_f32 v59, v59
    v_exp_f32 v60, v60
    v_exp_f32 v61, v61
    v_exp_f32 v62, v62
    v_exp_f32 v63, v63
    v_mfma_f32_32x32x16_bf16 v[32:47], v[148:151], v[128:131], v[96:111]
    ds_read_b128 v[144:147], v181 offset:5376
    v_exp_f32 v0, v0
    v_exp_f32 v1, v1
    v_exp_f32 v2, v2
    v_smfmac_f32_32x32x32_bf16 v[80:95], v[172:175], v[48:55], v180
    ds_read2st64_b32 v[154:155], v182 offset0:29 offset1:30
    v_exp_f32 v3, v3
    v_exp_f32 v4, v4
    v_exp_f32 v5, v5
    v_exp_f32 v6, v6
    v_mfma_f32_32x32x8_bf16 v[32:47], v[152:153], v[138:139], v[32:47]
    v_exp_f32 v7, v7
    v_exp_f32 v8, v8
    v_exp_f32 v9, v9
    v_exp_f32 v10, v10
    v_smfmac_f32_32x32x32_bf16 v[80:95], v[176:179], v[56:63], v180
    buffer_load_dwordx4 v248, s[52:55], s101 offen offset:1024 sc1 lds
    v_exp_f32 v11, v11
    v_exp_f32 v12, v12
    v_exp_f32 v13, v13
    v_exp_f32 v14, v14
    v_exp_f32 v15, v15
    v_mfma_f32_32x32x16_bf16 v[48:63], v[148:151], v[132:135], v[112:127]
    ds_read_b128 v[172:175], v183 offset:7936
    v_exp_f32 v16, v16
    v_exp_f32 v17, v17
    v_exp_f32 v18, v18
    v_smfmac_f32_32x32x32_bf16 v[64:79], v[156:159], v[0:7], v180
    ds_read_b128 v[176:179], v183 offset:8640
    v_exp_f32 v19, v19
    v_exp_f32 v20, v20
    v_exp_f32 v21, v21
    v_exp_f32 v22, v22
    v_mfma_f32_32x32x8_bf16 v[48:63], v[152:153], v[142:143], v[48:63]
    v_exp_f32 v23, v23
    v_exp_f32 v24, v24
    v_exp_f32 v25, v25
    v_exp_f32 v26, v26
    v_smfmac_f32_32x32x32_bf16 v[64:79], v[160:163], v[8:15], v180
    s_waitcnt lgkmcnt(2)
    s_mov_b32 exec_hi, 0
    buffer_store_dwordx4 v[196:199], v192, s[52:55], s70 offen offset:1024 sc1
    s_mov_b32 exec_hi, -1
    v_exp_f32 v27, v27
    v_exp_f32 v28, v28
    v_exp_f32 v29, v29
    v_exp_f32 v30, v30
    v_exp_f32 v31, v31
    v_mfma_f32_32x32x16_bf16 v[0:15], v[144:147], v[128:131], v[96:111]
    ds_read_b128 v[148:151], v181 offset:6400
    v_exp_f32 v32, v32
    v_exp_f32 v33, v33
    v_exp_f32 v34, v34
    v_smfmac_f32_32x32x32_bf16 v[80:95], v[156:159], v[16:23], v180
    buffer_load_dwordx4 v[216:219], v248, s[48:51], s67 offen offset:0 sc1
    v_exp_f32 v35, v35
    v_exp_f32 v36, v36
    v_exp_f32 v37, v37
    v_exp_f32 v38, v38
    v_mfma_f32_32x32x8_bf16 v[0:15], v[154:155], v[136:137], v[0:15]
    v_exp_f32 v39, v39
    v_exp_f32 v40, v40
    v_exp_f32 v41, v41
    v_exp_f32 v42, v42
    v_smfmac_f32_32x32x32_bf16 v[80:95], v[160:163], v[24:31], v180
    buffer_load_dwordx4 v248, s[52:55], s101 offen offset:2048 sc1 lds
    v_exp_f32 v43, v43
    v_exp_f32 v44, v44
    v_exp_f32 v45, v45
    v_exp_f32 v46, v46
    v_exp_f32 v47, v47
    v_mfma_f32_32x32x16_bf16 v[16:31], v[144:147], v[132:135], v[112:127]
    ds_read_b128 v[156:159], v183 offset:9344
    v_exp_f32 v48, v48
    v_exp_f32 v49, v49
    v_exp_f32 v50, v50
    v_smfmac_f32_32x32x32_bf16 v[64:79], v[164:167], v[32:39], v180
    ds_read_b128 v[160:163], v183 offset:10048
    v_exp_f32 v51, v51
    v_exp_f32 v52, v52
    v_exp_f32 v53, v53
    v_exp_f32 v54, v54
    v_mfma_f32_32x32x8_bf16 v[16:31], v[154:155], v[140:141], v[16:31]
    v_exp_f32 v55, v55
    v_exp_f32 v56, v56
    v_exp_f32 v57, v57
    v_exp_f32 v58, v58
    v_smfmac_f32_32x32x32_bf16 v[64:79], v[168:171], v[40:47], v180
    s_waitcnt lgkmcnt(2)
    buffer_load_dword v224, v244, s[48:51], s67 offen offset:2048 sc1
    v_exp_f32 v59, v59
    v_exp_f32 v60, v60
    v_exp_f32 v61, v61
    v_exp_f32 v62, v62
    v_exp_f32 v63, v63
    v_mfma_f32_32x32x16_bf16 v[32:47], v[148:151], v[128:131], v[96:111]
    ds_read_b128 v[144:147], v181 offset:10752
    v_exp_f32 v0, v0
    v_exp_f32 v1, v1
    v_exp_f32 v2, v2
    v_smfmac_f32_32x32x32_bf16 v[80:95], v[164:167], v[48:55], v180
    ds_read2st64_b32 v[152:153], v182 offset0:50 offset1:51
    v_exp_f32 v3, v3
    v_exp_f32 v4, v4
    v_exp_f32 v5, v5
    v_exp_f32 v6, v6
    v_mfma_f32_32x32x8_bf16 v[32:47], v[154:155], v[138:139], v[32:47]
    v_exp_f32 v7, v7
    v_exp_f32 v8, v8
    v_exp_f32 v9, v9
    v_exp_f32 v10, v10
    v_smfmac_f32_32x32x32_bf16 v[80:95], v[168:171], v[56:63], v180
    buffer_load_dwordx4 v248, s[52:55], s101 offen offset:3072 sc1 lds
    v_exp_f32 v11, v11
    v_exp_f32 v12, v12
    v_exp_f32 v13, v13
    v_exp_f32 v14, v14
    v_exp_f32 v15, v15
    v_mfma_f32_32x32x16_bf16 v[48:63], v[148:151], v[132:135], v[112:127]
    ds_read_b128 v[164:167], v183 offset:13312
    v_exp_f32 v16, v16
    v_exp_f32 v17, v17
    v_exp_f32 v18, v18
    v_smfmac_f32_32x32x32_bf16 v[64:79], v[172:175], v[0:7], v180
    ds_read_b128 v[168:171], v183 offset:14016
    s_add_u32 s101, s101, 4096
    v_exp_f32 v19, v19
    v_exp_f32 v20, v20
    v_exp_f32 v21, v21
    v_exp_f32 v22, v22
    v_mfma_f32_32x32x8_bf16 v[48:63], v[154:155], v[142:143], v[48:63]
    v_exp_f32 v23, v23
    v_exp_f32 v24, v24
    v_exp_f32 v25, v25
    v_exp_f32 v26, v26
    v_smfmac_f32_32x32x32_bf16 v[64:79], v[176:179], v[8:15], v180
    s_waitcnt lgkmcnt(2)
    s_add_u32 m0, s75, 4096
    v_exp_f32 v27, v27
    v_exp_f32 v28, v28
    v_exp_f32 v29, v29
    v_exp_f32 v30, v30
    v_exp_f32 v31, v31
    v_mfma_f32_32x32x16_bf16 v[0:15], v[144:147], v[128:131], v[96:111]
    ds_read_b128 v[148:151], v181 offset:11776
    v_exp_f32 v32, v32
    v_exp_f32 v33, v33
    v_exp_f32 v34, v34
    v_smfmac_f32_32x32x32_bf16 v[80:95], v[172:175], v[16:23], v180
    buffer_load_dword v225, v244, s[48:51], s67 offen offset:2304 sc1
    v_exp_f32 v35, v35
    v_exp_f32 v36, v36
    v_exp_f32 v37, v37
    v_exp_f32 v38, v38
    v_mfma_f32_32x32x8_bf16 v[0:15], v[152:153], v[136:137], v[0:15]
    v_exp_f32 v39, v39
    v_exp_f32 v40, v40
    v_exp_f32 v41, v41
    v_exp_f32 v42, v42
    v_smfmac_f32_32x32x32_bf16 v[80:95], v[176:179], v[24:31], v180
    buffer_load_dwordx4 v248, s[52:55], s101 offen sc1 lds
    v_exp_f32 v43, v43
    v_exp_f32 v44, v44
    v_exp_f32 v45, v45
    v_exp_f32 v46, v46
    v_exp_f32 v47, v47
    v_mfma_f32_32x32x16_bf16 v[16:31], v[144:147], v[132:135], v[112:127]
    ds_read_b128 v[172:175], v183 offset:14720
    v_exp_f32 v48, v48
    v_exp_f32 v49, v49
    v_exp_f32 v50, v50
    v_smfmac_f32_32x32x32_bf16 v[64:79], v[156:159], v[32:39], v180
    ds_read_b128 v[176:179], v183 offset:15424
    s_add_u32 s101, s74, 20480
    v_exp_f32 v51, v51
    v_exp_f32 v52, v52
    v_exp_f32 v53, v53
    v_exp_f32 v54, v54
    v_mfma_f32_32x32x8_bf16 v[16:31], v[152:153], v[140:141], v[16:31]
    v_exp_f32 v55, v55
    v_exp_f32 v56, v56
    v_exp_f32 v57, v57
    v_exp_f32 v58, v58
    v_smfmac_f32_32x32x32_bf16 v[64:79], v[160:163], v[40:47], v180
    s_waitcnt lgkmcnt(2)
    s_add_u32 m0, s75, 20480
    v_exp_f32 v59, v59
    v_exp_f32 v60, v60
    v_exp_f32 v61, v61
    v_exp_f32 v62, v62
    v_exp_f32 v63, v63
    v_mfma_f32_32x32x16_bf16 v[32:47], v[148:151], v[128:131], v[96:111]
    ds_read_b128 v[144:147], v181 offset:16128
    v_exp_f32 v0, v0
    v_exp_f32 v1, v1
    v_exp_f32 v2, v2
    v_smfmac_f32_32x32x32_bf16 v[80:95], v[156:159], v[48:55], v180
    ds_read2st64_b32 v[154:155], v182 offset0:71 offset1:72
    v_exp_f32 v3, v3
    v_exp_f32 v4, v4
    v_exp_f32 v5, v5
    v_exp_f32 v6, v6
    v_mfma_f32_32x32x8_bf16 v[32:47], v[152:153], v[138:139], v[32:47]
    v_exp_f32 v7, v7
    v_exp_f32 v8, v8
    v_exp_f32 v9, v9
    v_exp_f32 v10, v10
    v_smfmac_f32_32x32x32_bf16 v[80:95], v[160:163], v[56:63], v180
    buffer_load_dwordx4 v248, s[52:55], s101 offen sc1 lds
    v_exp_f32 v11, v11
    v_exp_f32 v12, v12
    v_exp_f32 v13, v13
    v_exp_f32 v14, v14
    v_exp_f32 v15, v15
    v_mfma_f32_32x32x16_bf16 v[48:63], v[148:151], v[132:135], v[112:127]
    ds_read_b128 v[156:159], v183 offset:18688
    v_exp_f32 v16, v16
    v_exp_f32 v17, v17
    v_exp_f32 v18, v18
    v_smfmac_f32_32x32x32_bf16 v[64:79], v[164:167], v[0:7], v180
    ds_read_b128 v[160:163], v183 offset:19392
    v_exp_f32 v19, v19
    v_exp_f32 v20, v20
    v_exp_f32 v21, v21
    v_exp_f32 v22, v22
    v_mfma_f32_32x32x8_bf16 v[48:63], v[152:153], v[142:143], v[48:63]
    v_exp_f32 v23, v23
    v_exp_f32 v24, v24
    v_exp_f32 v25, v25
    v_exp_f32 v26, v26
    v_smfmac_f32_32x32x32_bf16 v[64:79], v[168:171], v[8:15], v180
    s_waitcnt lgkmcnt(2)
    buffer_load_dwordx4 v[220:223], v248, s[48:51], s67 offen offset:1024 sc1
    v_exp_f32 v27, v27
    v_exp_f32 v28, v28
    v_exp_f32 v29, v29
    v_exp_f32 v30, v30
    v_exp_f32 v31, v31
    v_mfma_f32_32x32x16_bf16 v[0:15], v[144:147], v[128:131], v[96:111]
    ds_read_b128 v[148:151], v181 offset:17152
    v_exp_f32 v32, v32
    v_exp_f32 v33, v33
    v_exp_f32 v34, v34
    v_smfmac_f32_32x32x32_bf16 v[80:95], v[164:167], v[16:23], v180
    buffer_load_dwordx4 v[226:229], v245, s[48:51], s67 offen offset:0 sc1
    v_exp_f32 v35, v35
    v_exp_f32 v36, v36
    v_exp_f32 v37, v37
    v_exp_f32 v38, v38
    v_mfma_f32_32x32x8_bf16 v[0:15], v[154:155], v[136:137], v[0:15]
    v_exp_f32 v39, v39
    v_exp_f32 v40, v40
    v_exp_f32 v41, v41
    v_exp_f32 v42, v42
    v_smfmac_f32_32x32x32_bf16 v[80:95], v[168:171], v[24:31], v180
    buffer_load_dwordx4 v248, s[52:55], s101 offen offset:1024 sc1 lds
    v_exp_f32 v43, v43
    v_exp_f32 v44, v44
    v_exp_f32 v45, v45
    v_exp_f32 v46, v46
    v_exp_f32 v47, v47
    v_mfma_f32_32x32x16_bf16 v[16:31], v[144:147], v[132:135], v[112:127]
    ds_read_b128 v[164:167], v183 offset:20096
    v_exp_f32 v48, v48
    v_exp_f32 v49, v49
    v_exp_f32 v50, v50
    v_smfmac_f32_32x32x32_bf16 v[64:79], v[172:175], v[32:39], v180
    ds_read_b128 v[168:171], v183 offset:20800
    v_exp_f32 v51, v51
    v_exp_f32 v52, v52
    v_exp_f32 v53, v53
    v_exp_f32 v54, v54
    v_mfma_f32_32x32x8_bf16 v[16:31], v[154:155], v[140:141], v[16:31]
    v_exp_f32 v55, v55
    v_exp_f32 v56, v56
    v_exp_f32 v57, v57
    v_exp_f32 v58, v58
    v_smfmac_f32_32x32x32_bf16 v[64:79], v[176:179], v[40:47], v180
    s_waitcnt lgkmcnt(2)
    buffer_load_dwordx4 v[230:233], v245, s[48:51], s67 offen offset:704 sc1
    v_exp_f32 v59, v59
    v_exp_f32 v60, v60
    v_exp_f32 v61, v61
    v_exp_f32 v62, v62
    v_exp_f32 v63, v63
    v_mfma_f32_32x32x16_bf16 v[32:47], v[148:151], v[128:131], v[96:111]
    ds_read_b128 v[144:147], v181 offset:21504
    v_exp_f32 v0, v0
    v_exp_f32 v1, v1
    v_exp_f32 v2, v2
    v_smfmac_f32_32x32x32_bf16 v[80:95], v[172:175], v[48:55], v180
    ds_read2st64_b32 v[152:153], v182 offset0:92 offset1:93
    v_exp_f32 v3, v3
    v_exp_f32 v4, v4
    v_exp_f32 v5, v5
    v_exp_f32 v6, v6
    v_mfma_f32_32x32x8_bf16 v[32:47], v[154:155], v[138:139], v[32:47]
    v_exp_f32 v7, v7
    v_exp_f32 v8, v8
    v_exp_f32 v9, v9
    v_exp_f32 v10, v10
    v_smfmac_f32_32x32x32_bf16 v[80:95], v[176:179], v[56:63], v180
    buffer_load_dwordx4 v248, s[52:55], s101 offen offset:2048 sc1 lds
    v_exp_f32 v11, v11
    v_exp_f32 v12, v12
    v_exp_f32 v13, v13
    v_exp_f32 v14, v14
    v_exp_f32 v15, v15
    v_mfma_f32_32x32x16_bf16 v[48:63], v[148:151], v[132:135], v[112:127]
    ds_read_b128 v[172:175], v183 offset:24064
    v_exp_f32 v16, v16
    v_exp_f32 v17, v17
    v_exp_f32 v18, v18
    v_smfmac_f32_32x32x32_bf16 v[64:79], v[156:159], v[0:7], v180
    ds_read_b128 v[176:179], v183 offset:24768
    v_exp_f32 v19, v19
    v_exp_f32 v20, v20
    v_exp_f32 v21, v21
    v_exp_f32 v22, v22
    v_mfma_f32_32x32x8_bf16 v[48:63], v[154:155], v[142:143], v[48:63]
    v_exp_f32 v23, v23
    v_exp_f32 v24, v24
    v_exp_f32 v25, v25
    v_exp_f32 v26, v26
    v_smfmac_f32_32x32x32_bf16 v[64:79], v[160:163], v[8:15], v180
    s_waitcnt lgkmcnt(2)
    buffer_load_dwordx4 v[234:237], v245, s[48:51], s67 offen offset:1408 sc1
    v_exp_f32 v27, v27
    v_exp_f32 v28, v28
    v_exp_f32 v29, v29
    v_exp_f32 v30, v30
    v_exp_f32 v31, v31
    v_mfma_f32_32x32x16_bf16 v[0:15], v[144:147], v[128:131], v[96:111]
    ds_read_b128 v[148:151], v181 offset:22528
    v_exp_f32 v32, v32
    v_exp_f32 v33, v33
    v_exp_f32 v34, v34
    v_smfmac_f32_32x32x32_bf16 v[80:95], v[156:159], v[16:23], v180
    buffer_load_dwordx4 v[238:241], v245, s[48:51], s67 offen offset:2112 sc1
    v_exp_f32 v35, v35
    v_exp_f32 v36, v36
    v_exp_f32 v37, v37
    v_exp_f32 v38, v38
    v_mfma_f32_32x32x8_bf16 v[0:15], v[152:153], v[136:137], v[0:15]
    v_exp_f32 v39, v39
    v_exp_f32 v40, v40
    v_exp_f32 v41, v41
    v_exp_f32 v42, v42
    v_smfmac_f32_32x32x32_bf16 v[80:95], v[160:163], v[24:31], v180
    buffer_load_dwordx4 v248, s[52:55], s101 offen offset:3072 sc1 lds
    v_exp_f32 v43, v43
    v_exp_f32 v44, v44
    v_exp_f32 v45, v45
    v_exp_f32 v46, v46
    v_exp_f32 v47, v47
    v_mfma_f32_32x32x16_bf16 v[16:31], v[144:147], v[132:135], v[112:127]
    ds_read_b128 v[156:159], v183 offset:25472
    v_exp_f32 v48, v48
    v_exp_f32 v49, v49
    v_exp_f32 v50, v50
    v_smfmac_f32_32x32x32_bf16 v[64:79], v[164:167], v[32:39], v180
    ds_read_b128 v[160:163], v183 offset:26176
    s_add_u32 s101, s101, 4096
    v_exp_f32 v51, v51
    v_exp_f32 v52, v52
    v_exp_f32 v53, v53
    v_exp_f32 v54, v54
    v_mfma_f32_32x32x8_bf16 v[16:31], v[152:153], v[140:141], v[16:31]
    v_exp_f32 v55, v55
    v_exp_f32 v56, v56
    v_exp_f32 v57, v57
    v_exp_f32 v58, v58
    v_smfmac_f32_32x32x32_bf16 v[64:79], v[168:171], v[40:47], v180
    s_waitcnt lgkmcnt(2)
    s_add_u32 m0, s75, 24576
    v_exp_f32 v59, v59
    v_exp_f32 v60, v60
    v_exp_f32 v61, v61
    v_exp_f32 v62, v62
    v_exp_f32 v63, v63
    v_mfma_f32_32x32x16_bf16 v[32:47], v[148:151], v[128:131], v[96:111]
    ds_read_b128 v[144:147], v181 offset:26880
    v_exp_f32 v0, v0
    v_exp_f32 v1, v1
    v_exp_f32 v2, v2
    v_smfmac_f32_32x32x32_bf16 v[80:95], v[164:167], v[48:55], v180
    ds_read2st64_b32 v[154:155], v182 offset0:113 offset1:114
    v_exp_f32 v3, v3
    v_exp_f32 v4, v4
    v_exp_f32 v5, v5
    v_exp_f32 v6, v6
    v_mfma_f32_32x32x8_bf16 v[32:47], v[152:153], v[138:139], v[32:47]
    v_exp_f32 v7, v7
    v_exp_f32 v8, v8
    v_exp_f32 v9, v9
    v_exp_f32 v10, v10
    v_smfmac_f32_32x32x32_bf16 v[80:95], v[168:171], v[56:63], v180
    buffer_load_dwordx4 v248, s[52:55], s101 offen sc1 lds
    v_exp_f32 v11, v11
    v_exp_f32 v12, v12
    v_exp_f32 v13, v13
    v_exp_f32 v14, v14
    v_exp_f32 v15, v15
    v_mfma_f32_32x32x16_bf16 v[48:63], v[148:151], v[132:135], v[112:127]
    ds_read_b128 v[164:167], v183 offset:29440
    v_exp_f32 v16, v16
    v_exp_f32 v17, v17
    v_exp_f32 v18, v18
    v_smfmac_f32_32x32x32_bf16 v[64:79], v[172:175], v[0:7], v180
    ds_read_b128 v[168:171], v183 offset:30144
    v_exp_f32 v19, v19
    v_exp_f32 v20, v20
    v_exp_f32 v21, v21
    v_exp_f32 v22, v22
    v_mfma_f32_32x32x8_bf16 v[48:63], v[152:153], v[142:143], v[48:63]
    v_exp_f32 v23, v23
    v_exp_f32 v24, v24
    v_exp_f32 v25, v25
    v_exp_f32 v26, v26
    v_smfmac_f32_32x32x32_bf16 v[64:79], v[176:179], v[8:15], v180
    s_waitcnt lgkmcnt(2)
    v_exp_f32 v27, v27
    v_exp_f32 v28, v28
    v_exp_f32 v29, v29
    v_exp_f32 v30, v30
    v_exp_f32 v31, v31
    v_mfma_f32_32x32x16_bf16 v[0:15], v[144:147], v[128:131], v[96:111]
    ds_read_b128 v[148:151], v181 offset:27904
    v_exp_f32 v32, v32
    v_exp_f32 v33, v33
    v_exp_f32 v34, v34
    v_smfmac_f32_32x32x32_bf16 v[80:95], v[172:175], v[16:23], v180
    v_exp_f32 v35, v35
    v_exp_f32 v36, v36
    v_exp_f32 v37, v37
    v_exp_f32 v38, v38
    v_mfma_f32_32x32x8_bf16 v[0:15], v[154:155], v[136:137], v[0:15]
    v_exp_f32 v39, v39
    v_exp_f32 v40, v40
    v_exp_f32 v41, v41
    v_exp_f32 v42, v42
    v_smfmac_f32_32x32x32_bf16 v[80:95], v[176:179], v[24:31], v180
    v_exp_f32 v43, v43
    v_exp_f32 v44, v44
    v_exp_f32 v45, v45
    v_exp_f32 v46, v46
    v_exp_f32 v47, v47
    v_mfma_f32_32x32x16_bf16 v[16:31], v[144:147], v[132:135], v[112:127]
    ds_read_b128 v[172:175], v183 offset:30848
    v_exp_f32 v48, v48
    v_exp_f32 v49, v49
    v_exp_f32 v50, v50
    v_smfmac_f32_32x32x32_bf16 v[64:79], v[156:159], v[32:39], v180
    ds_read_b128 v[176:179], v183 offset:31552
    v_exp_f32 v51, v51
    v_exp_f32 v52, v52
    v_exp_f32 v53, v53
    v_exp_f32 v54, v54
    v_mfma_f32_32x32x8_bf16 v[16:31], v[154:155], v[140:141], v[16:31]
    v_exp_f32 v55, v55
    v_exp_f32 v56, v56
    v_exp_f32 v57, v57
    v_exp_f32 v58, v58
    v_smfmac_f32_32x32x32_bf16 v[64:79], v[160:163], v[40:47], v180
    s_waitcnt vmcnt(16) lgkmcnt(0)
    s_barrier
    v_exp_f32 v59, v59
    v_exp_f32 v60, v60
    v_exp_f32 v61, v61
    v_exp_f32 v62, v62
    v_exp_f32 v63, v63
    v_mfma_f32_32x32x16_bf16 v[32:47], v[148:151], v[128:131], v[96:111]
    v_exp_f32 v0, v0
    v_exp_f32 v1, v1
    v_exp_f32 v2, v2
    v_smfmac_f32_32x32x32_bf16 v[80:95], v[156:159], v[48:55], v180
    s_add_u32 m0, s75, 40960
    s_add_u32 s101, s74, 40960
    buffer_load_dwordx4 v248, s[52:55], s101 offen sc1 lds
    v_exp_f32 v3, v3
    v_exp_f32 v4, v4
    v_exp_f32 v5, v5
    v_exp_f32 v6, v6
    v_mfma_f32_32x32x8_bf16 v[32:47], v[154:155], v[138:139], v[32:47]
    v_exp_f32 v7, v7
    v_exp_f32 v8, v8
    v_exp_f32 v9, v9
    v_exp_f32 v10, v10
    v_smfmac_f32_32x32x32_bf16 v[80:95], v[160:163], v[56:63], v180
    s_mul_i32 s68, s38, 3840
    s_mul_i32 s71, s38, 1280
    buffer_load_dwordx4 v248, s[52:55], s101 offen offset:1024 sc1 lds
    v_exp_f32 v11, v11
    v_exp_f32 v12, v12
    v_exp_f32 v13, v13
    v_exp_f32 v14, v14
    v_exp_f32 v15, v15
    v_mfma_f32_32x32x16_bf16 v[48:63], v[148:151], v[132:135], v[112:127]
    v_exp_f32 v16, v16
    v_exp_f32 v17, v17
    v_exp_f32 v18, v18
    v_smfmac_f32_32x32x32_bf16 v[64:79], v[164:167], v[0:7], v180
    buffer_load_dwordx4 v248, s[52:55], s101 offen offset:2048 sc1 lds
    v_exp_f32 v19, v19
    v_exp_f32 v20, v20
    v_exp_f32 v21, v21
    v_exp_f32 v22, v22
    v_mfma_f32_32x32x8_bf16 v[48:63], v[154:155], v[142:143], v[48:63]
    v_exp_f32 v23, v23
    v_exp_f32 v24, v24
    v_exp_f32 v25, v25
    v_exp_f32 v26, v26
    v_smfmac_f32_32x32x32_bf16 v[64:79], v[168:171], v[8:15], v180
    buffer_load_dwordx4 v248, s[52:55], s101 offen offset:3072 sc1 lds
    s_waitcnt vmcnt(4)
    v_exp_f32 v27, v27
    v_exp_f32 v28, v28
    v_exp_f32 v29, v29
    v_exp_f32 v30, v30
    v_exp_f32 v31, v31
    v_mfma_f32_32x32x16_bf16 v[0:15], v[216:219], v[128:131], v[96:111]
    v_exp_f32 v32, v32
    v_exp_f32 v33, v33
    v_exp_f32 v34, v34
    v_smfmac_f32_32x32x32_bf16 v[80:95], v[164:167], v[16:23], v180
    s_add_u32 m0, s75, 45056
    s_add_u32 s101, s101, 4096
    buffer_load_dwordx4 v248, s[52:55], s101 offen sc1 lds
    v_exp_f32 v35, v35
    v_exp_f32 v36, v36
    v_exp_f32 v37, v37
    v_exp_f32 v38, v38
    v_mfma_f32_32x32x8_bf16 v[0:15], v[224:225], v[136:137], v[0:15]
    v_exp_f32 v39, v39
    v_exp_f32 v40, v40
    v_exp_f32 v41, v41
    v_exp_f32 v42, v42
    v_smfmac_f32_32x32x32_bf16 v[80:95], v[168:171], v[24:31], v180
    s_add_u32 m0, s68, 61440
    s_sub_u32 s101, s74, s71
    s_add_u32 s101, s101, 61440
    buffer_load_dwordx4 v248, s[52:55], s101 offen offset:0 sc1 lds
    v_exp_f32 v43, v43
    v_exp_f32 v44, v44
    v_exp_f32 v45, v45
    v_exp_f32 v46, v46
    v_exp_f32 v47, v47
    v_mfma_f32_32x32x16_bf16 v[16:31], v[216:219], v[132:135], v[112:127]
    v_exp_f32 v48, v48
    v_exp_f32 v49, v49
    v_exp_f32 v50, v50
    v_smfmac_f32_32x32x32_bf16 v[64:79], v[172:175], v[32:39], v180
    buffer_load_dwordx4 v248, s[52:55], s101 offen offset:1024 sc1 lds
    v_exp_f32 v51, v51
    v_exp_f32 v52, v52
    v_exp_f32 v53, v53
    v_exp_f32 v54, v54
    v_mfma_f32_32x32x8_bf16 v[16:31], v[224:225], v[140:141], v[16:31]
    v_exp_f32 v55, v55
    v_exp_f32 v56, v56
    v_exp_f32 v57, v57
    v_exp_f32 v58, v58
    v_smfmac_f32_32x32x32_bf16 v[64:79], v[176:179], v[40:47], v180
    buffer_load_dwordx4 v248, s[52:55], s101 offen offset:2048 sc1 lds
    v_exp_f32 v59, v59
    v_exp_f32 v60, v60
    v_exp_f32 v61, v61
    v_exp_f32 v62, v62
    v_exp_f32 v63, v63
    v_mfma_f32_32x32x16_bf16 v[32:47], v[220:223], v[128:131], v[96:111]
    v_exp_f32 v0, v0
    v_exp_f32 v1, v1
    v_exp_f32 v2, v2
    v_smfmac_f32_32x32x32_bf16 v[80:95], v[172:175], v[48:55], v180
    s_mov_b32 exec_hi, 0xffff
    buffer_load_dwordx4 v248, s[52:55], s101 offen offset:3072 sc1 lds
    s_mov_b32 exec_hi, -1
    v_exp_f32 v3, v3
    v_exp_f32 v4, v4
    v_exp_f32 v5, v5
    v_exp_f32 v6, v6
    v_mfma_f32_32x32x8_bf16 v[32:47], v[224:225], v[138:139], v[32:47]
    v_exp_f32 v7, v7
    v_exp_f32 v8, v8
    v_exp_f32 v9, v9
    v_exp_f32 v10, v10
    v_smfmac_f32_32x32x32_bf16 v[80:95], v[176:179], v[56:63], v180
    s_lshl_b32 s72, s62, 2
    s_add_u32 s72, s72, s38
    v_exp_f32 v11, v11
    v_exp_f32 v12, v12
    v_exp_f32 v13, v13
    v_exp_f32 v14, v14
    v_exp_f32 v15, v15
    v_mfma_f32_32x32x16_bf16 v[48:63], v[220:223], v[132:135], v[112:127]
    v_exp_f32 v16, v16
    v_exp_f32 v17, v17
    v_exp_f32 v18, v18
    v_smfmac_f32_32x32x32_bf16 v[64:79], v[226:229], v[0:7], v180
    s_mul_i32 s73, s72, 81920
    s_mul_i32 s69, s63, 320
    v_exp_f32 v19, v19
    v_exp_f32 v20, v20
    v_exp_f32 v21, v21
    v_exp_f32 v22, v22
    v_mfma_f32_32x32x8_bf16 v[48:63], v[224:225], v[142:143], v[48:63]
    v_exp_f32 v23, v23
    v_exp_f32 v24, v24
    v_exp_f32 v25, v25
    v_exp_f32 v26, v26
    v_smfmac_f32_32x32x32_bf16 v[64:79], v[230:233], v[8:15], v180
    s_add_u32 s73, s73, s69
    s_mul_i32 s64, s72, 20480
    v_exp_f32 v27, v27
    v_exp_f32 v28, v28
    v_exp_f32 v29, v29
    v_exp_f32 v30, v30
    v_exp_f32 v31, v31
    v_exp_f32 v32, v32
    v_exp_f32 v33, v33
    v_exp_f32 v34, v34
    v_smfmac_f32_32x32x32_bf16 v[80:95], v[226:229], v[16:23], v180
    s_add_u32 s64, s64, 1572864
    s_mov_b32 s48, s32
    v_exp_f32 v35, v35
    v_exp_f32 v36, v36
    v_exp_f32 v37, v37
    v_exp_f32 v38, v38
    v_exp_f32 v39, v39
    v_exp_f32 v40, v40
    v_exp_f32 v41, v41
    v_exp_f32 v42, v42
    v_smfmac_f32_32x32x32_bf16 v[80:95], v[230:233], v[24:31], v180
    s_mov_b32 s49, s33
    s_mov_b32 s50, 10485760
    v_exp_f32 v43, v43
    v_exp_f32 v44, v44
    v_exp_f32 v45, v45
    v_exp_f32 v46, v46
    v_exp_f32 v47, v47
    v_exp_f32 v48, v48
    v_exp_f32 v49, v49
    v_exp_f32 v50, v50
    v_smfmac_f32_32x32x32_bf16 v[64:79], v[234:237], v[32:39], v180
    s_lshl_b32 s72, s62, 7
    s_add_u32 s72, s72, 61440
    v_exp_f32 v51, v51
    v_exp_f32 v52, v52
    v_exp_f32 v53, v53
    v_exp_f32 v54, v54
    v_exp_f32 v55, v55
    v_exp_f32 v56, v56
    v_exp_f32 v57, v57
    v_exp_f32 v58, v58
    v_smfmac_f32_32x32x32_bf16 v[64:79], v[238:241], v[40:47], v180
    s_cmp_eq_u32 s38, 0
    s_cselect_b64 s[76:77], 1, 0
    v_exp_f32 v59, v59
    v_exp_f32 v60, v60
    v_exp_f32 v61, v61
    v_exp_f32 v62, v62
    v_exp_f32 v63, v63
    v_smfmac_f32_32x32x32_bf16 v[80:95], v[234:237], v[48:55], v180
    s_nop 0
    v_smfmac_f32_32x32x32_bf16 v[80:95], v[238:241], v[56:63], v180
    s_branch L_a_done
L_a_waitf:
    s_movk_i32 s72, 128
    s_mov_b64 exec, 1
    v_mov_b32 v193, 0
    s_mov_b32 s39, 40000
L_poll_29:
    buffer_load_dword v194, v193, s[56:59], s72 offen sc1
    s_sub_u32 s39, s39, 1
    s_cbranch_scc1 L_polled_30
    s_waitcnt vmcnt(0)
    v_cmp_gt_u32 vcc, 36, v194
    s_cbranch_vccz L_polled_30
    s_sleep 8
    s_branch L_poll_29
L_polled_30:
    s_waitcnt vmcnt(0)
    s_mov_b64 exec, -1
    s_branch L_a_clearedf
L_o_fix0:
    s_mov_b32 s39, 40000
    s_add_u32 s70, s64, 0
    s_waitcnt vmcnt(0)
L_o_fixl0:
    buffer_load_dwordx4 v[160:163], v248, s[52:55], s70 offen offset:0 sc1
    buffer_load_dwordx4 v[164:167], v248, s[52:55], s70 offen offset:1024 sc1
    buffer_load_dwordx4 v[168:171], v248, s[52:55], s70 offen offset:2048 sc1
    buffer_load_dwordx4 v[172:175], v248, s[52:55], s70 offen offset:3072 sc1
    s_sub_u32 s39, s39, 1
    s_waitcnt vmcnt(0)
    s_cbranch_scc1 L_o_ok0
    v_max3_u32 v236, v160, v161, v162
    v_max3_u32 v237, v163, v164, v165
    v_max3_u32 v236, v236, v166, v167
    v_max_u32 v236, v236, v237
    v_cmp_eq_u32 vcc, -1, v236
    s_cbranch_vccz L_o_ok0
    s_sleep 2
    s_branch L_o_fixl0
L_o_fix1:
    s_mov_b32 s39, 40000
    s_add_u32 s70, s64, 2048
    s_waitcnt vmcnt(0)
L_o_fixl1:
    buffer_load_dwordx4 v[168:171], v248, s[52:55], s70 offen offset:0 sc1
    buffer_load_dwordx4 v[172:175], v248, s[52:55], s70 offen offset:1024 sc1
    buffer_load_dwordx4 v[176:179], v248, s[52:55], s70 offen offset:2048 sc1
    buffer_load_dwordx4 v[180:183], v248, s[52:55], s70 offen offset:3072 sc1
    s_sub_u32 s39, s39, 1
    s_waitcnt vmcnt(0)
    s_cbranch_scc1 L_o_ok1
    v_max3_u32 v236, v168, v169, v170
    v_max3_u32 v237, v171, v172, v173
    v_max3_u32 v236, v236, v174, v175
    v_max_u32 v236, v236, v237
    v_cmp_eq_u32 vcc, -1, v236
    s_cbranch_vccz L_o_ok1
    s_sleep 2
    s_branch L_o_fixl1
L_o_fix2:
    s_mov_b32 s39, 40000
    s_add_u32 s70, s64, 4096
    s_waitcnt vmcnt(0)
L_o_fixl2:
    buffer_load_dwordx4 v[176:179], v248, s[52:55], s70 offen offset:0 sc1
    buffer_load_dwordx4 v[180:183], v248, s[52:55], s70 offen offset:1024 sc1
    buffer_load_dwordx4 v[184:187], v248, s[52:55], s70 offen offset:2048 sc1
    buffer_load_dwordx4 v[188:191], v248, s[52:55], s70 offen offset:3072 sc1
    s_sub_u32 s39, s39, 1
    s_waitcnt vmcnt(0)
    s_cbranch_scc1 L_o_ok2
    v_max3_u32 v236, v176, v177, v178
    v_max3_u32 v237, v179, v180, v181
    v_max3_u32 v236, v236, v182, v183
    v_max_u32 v236, v236, v237
    v_cmp_eq_u32 vcc, -1, v236
    s_cbranch_vccz L_o_ok2
    s_sleep 2
    s_branch L_o_fixl2
L_o_fix3:
    s_mov_b32 s39, 40000
    s_add_u32 s70, s64, 6144
    s_waitcnt vmcnt(0)
L_o_fixl3:
    buffer_load_dwordx4 v[184:187], v248, s[52:55], s70 offen offset:0 sc1
    buffer_load_dwordx4 v[188:191], v248, s[52:55], s70 offen offset:1024 sc1
    buffer_load_dwordx4 v[192:195], v248, s[52:55], s70 offen offset:2048 sc1
    buffer_load_dwordx4 v[196:199], v248, s[52:55], s70 offen offset:3072 sc1
    s_sub_u32 s39, s39, 1
    s_waitcnt vmcnt(0)
    s_cbranch_scc1 L_o_ok3
    v_max3_u32 v236, v184, v185, v186
    v_max3_u32 v237, v187, v188, v189
    v_max3_u32 v236, v236, v190, v191
    v_max_u32 v236, v236, v237
    v_cmp_eq_u32 vcc, -1, v236
    s_cbranch_vccz L_o_ok3
    s_sleep 2
    s_branch L_o_fixl3
L_o_fix4:
    s_mov_b32 s39, 40000
    s_add_u32 s70, s64, 8192
    s_waitcnt vmcnt(0)
L_o_fixl4:
    buffer_load_dwordx4 v[192:195], v248, s[52:55], s70 offen offset:0 sc1
    buffer_load_dwordx4 v[196:199], v248, s[52:55], s70 offen offset:1024 sc1
    buffer_load_dwordx4 v[160:163], v248, s[52:55], s70 offen offset:2048 sc1
    buffer_load_dwordx4 v[164:167], v248, s[52:55], s70 offen offset:3072 sc1
    s_sub_u32 s39, s39, 1
    s_waitcnt vmcnt(0)
    s_cbranch_scc1 L_o_ok4
    v_max3_u32 v236, v192, v193, v194
    v_max3_u32 v237, v195, v196, v197
    v_max3_u32 v236, v236, v198, v199
    v_max_u32 v236, v236, v237
    v_cmp_eq_u32 vcc, -1, v236
    s_cbranch_vccz L_o_ok4
    s_sleep 2
    s_branch L_o_fixl4
L_o_fix5:
    s_mov_b32 s39, 40000
    s_add_u32 s70, s64, 10240
    s_waitcnt vmcnt(0)
L_o_fixl5:
    buffer_load_dwordx4 v[160:163], v248, s[52:55], s70 offen offset:0 sc1
    buffer_load_dwordx4 v[164:167], v248, s[52:55], s70 offen offset:1024 sc1
    buffer_load_dwordx4 v[168:171], v248, s[52:55], s70 offen offset:2048 sc1
    buffer_load_dwordx4 v[172:175], v248, s[52:55], s70 offen offset:3072 sc1
    s_sub_u32 s39, s39, 1
    s_waitcnt vmcnt(0)
    s_cbranch_scc1 L_o_ok5
    v_max3_u32 v236, v160, v161, v162
    v_max3_u32 v237, v163, v164, v165
    v_max3_u32 v236, v236, v166, v167
    v_max_u32 v236, v236, v237
    v_cmp_eq_u32 vcc, -1, v236
    s_cbranch_vccz L_o_ok5
    s_sleep 2
    s_branch L_o_fixl5
L_o_fix6:
    s_mov_b32 s39, 40000
    s_add_u32 s70, s64, 12288
    s_waitcnt vmcnt(0)
L_o_fixl6:
    buffer_load_dwordx4 v[168:171], v248, s[52:55], s70 offen offset:0 sc1
    buffer_load_dwordx4 v[172:175], v248, s[52:55], s70 offen offset:1024 sc1
    buffer_load_dwordx4 v[176:179], v248, s[52:55], s70 offen offset:2048 sc1
    buffer_load_dwordx4 v[180:183], v248, s[52:55], s70 offen offset:3072 sc1
    s_sub_u32 s39, s39, 1
    s_waitcnt vmcnt(0)
    s_cbranch_scc1 L_o_ok6
    v_max3_u32 v236, v168, v169, v170
    v_max3_u32 v237, v171, v172, v173
    v_max3_u32 v236, v236, v174, v175
    v_max_u32 v236, v236, v237
    v_cmp_eq_u32 vcc, -1, v236
    s_cbranch_vccz L_o_ok6
    s_sleep 2
    s_branch L_o_fixl6
L_o_fix7:
    s_mov_b32 s39, 40000
    s_add_u32 s70, s64, 14336
    s_waitcnt vmcnt(0)
L_o_fixl7:
    buffer_load_dwordx4 v[176:179], v248, s[52:55], s70 offen offset:0 sc1
    buffer_load_dwordx4 v[180:183], v248, s[52:55], s70 offen offset:1024 sc1
    buffer_load_dwordx4 v[184:187], v248, s[52:55], s70 offen offset:2048 sc1
    buffer_load_dwordx4 v[188:191], v248, s[52:55], s70 offen offset:3072 sc1
    s_sub_u32 s39, s39, 1
    s_waitcnt vmcnt(0)
    s_cbranch_scc1 L_o_ok7
    v_max3_u32 v236, v176, v177, v178
    v_max3_u32 v237, v179, v180, v181
    v_max3_u32 v236, v236, v182, v183
    v_max_u32 v236, v236, v237
    v_cmp_eq_u32 vcc, -1, v236
    s_cbranch_vccz L_o_ok7
    s_sleep 2
    s_branch L_o_fixl7
L_o_fix8:
    s_mov_b32 s39, 40000
    s_add_u32 s70, s64, 16384
    s_waitcnt vmcnt(0)
L_o_fixl8:
    buffer_load_dwordx4 v[184:187], v248, s[52:55], s70 offen offset:0 sc1
    buffer_load_dwordx4 v[188:191], v248, s[52:55], s70 offen offset:1024 sc1
    buffer_load_dwordx4 v[192:195], v248, s[52:55], s70 offen offset:2048 sc1
    buffer_load_dwordx4 v[196:199], v248, s[52:55], s70 offen offset:3072 sc1
    s_sub_u32 s39, s39, 1
    s_waitcnt vmcnt(0)
    s_cbranch_scc1 L_o_ok8
    v_max3_u32 v236, v184, v185, v186
    v_max3_u32 v237, v187, v188, v189
    v_max3_u32 v236, v236, v190, v191
    v_max_u32 v236, v236, v237
    v_cmp_eq_u32 vcc, -1, v236
    s_cbranch_vccz L_o_ok8
    s_sleep 2
    s_branch L_o_fixl8
L_o_fix9:
    s_mov_b32 s39, 40000
    s_add_u32 s70, s64, 18432
    s_waitcnt vmcnt(0)
L_o_fixl9:
    buffer_load_dwordx4 v[192:195], v248, s[52:55], s70 offen offset:0 sc1
    buffer_load_dwordx4 v[196:199], v248, s[52:55], s70 offen offset:1024 sc1
    s_sub_u32 s39, s39, 1
    s_waitcnt vmcnt(0)
    s_cbranch_scc1 L_o_ok9
    v_max3_u32 v236, v192, v193, v194
    v_max3_u32 v237, v195, v196, v197
    v_max3_u32 v236, v236, v198, v199
    v_max_u32 v236, v236, v237
    v_cmp_eq_u32 vcc, -1, v236
    s_cbranch_vccz L_o_ok9
    s_sleep 2
    s_branch L_o_fixl9
L_a_waits:
    s_movk_i32 s72, 128
    s_mov_b64 exec, 1
    v_mov_b32 v193, 0
    s_mov_b32 s39, 40000
L_poll_31:
    buffer_load_dword v194, v193, s[56:59], s72 offen sc1
    s_sub_u32 s39, s39, 1
    s_cbranch_scc1 L_polled_32
    s_waitcnt vmcnt(0)
    v_cmp_gt_u32 vcc, 36, v194
    s_cbranch_vccz L_polled_32
    s_sleep 8
    s_branch L_poll_31
L_polled_32:
    s_waitcnt vmcnt(0)
    s_mov_b64 exec, -1
    s_branch L_a_cleareds
L_exit:
    s_endpgm
.section .rodata,"a"
.p2align 6
.amdhsa_kernel concat_heads__grouped_kv_mqa__ssm_conv_s5__prompt_kernel
  .amdhsa_next_free_vgpr 256
  .amdhsa_next_free_sgpr 102
  .amdhsa_accum_offset 256
  .amdhsa_group_segment_fixed_size 0
  .amdhsa_kernarg_size 136
  .amdhsa_user_sgpr_count 2
  .amdhsa_user_sgpr_kernarg_segment_ptr 1
  .amdhsa_system_sgpr_workgroup_id_x 1
.end_amdhsa_kernel
```
